```python
import torch

def _softmax(x, axis=-1):
    return torch.softmax(x, dim=axis)
def _gelu(x):
    return torch.nn.functional.gelu(x, approximate="tanh")
def _silu(x):
    return torch.nn.functional.silu(x)
def _sigmoid(x):
    return torch.sigmoid(x)
def _layernorm(x, axis=-1, eps=1e-5):
    m = x.mean(dim=axis, keepdim=True)
    v = x.var(dim=axis, keepdim=True, unbiased=False)
    return (x - m) / torch.sqrt(v + eps)
def _scatter_add(tgt, idx, src, axis=0):
    return tgt.clone().index_add_(axis, idx, src)
def _segment_sum(src, seg, n):
    out = torch.zeros((n,) + src.shape[1:], dtype=src.dtype)
    return out.index_add_(0, seg, src)
def _pad(x, pw):
    flat = tuple(v for pair in reversed(pw) for v in pair)
    return torch.nn.functional.pad(x, flat)

kernel_name = 'sequential_preLN__softmax_full_mha__dense_activation_silu__prompt'

def setup_inputs():

    _w = (lambda a: (lambda t: t.to(torch.bfloat16) if t.is_floating_point() else t)(torch.as_tensor(a)))
    def _A_setup():
        B, S, D = 1, 2048, 448
        return {
            "x": _w((lambda *s: torch.randn(*s, dtype=torch.bfloat16) * 0.05)(B, S, D)),
            "wqkv": _w((lambda *s: torch.randn(*s, dtype=torch.bfloat16) * 0.05)(D, 3 * D)),
            "wo": _w((lambda *s: torch.randn(*s, dtype=torch.bfloat16) * 0.05)(D, D)),
        }
    _A_in = _A_setup()

    def _B_setup():
        B, S, D, F = 1, 2048, 448, 1792
        return {
            "x": _w((lambda *s: torch.randn(*s, dtype=torch.bfloat16) * 0.05)(B, S, D)),
            "w1": _w((lambda *s: torch.randn(*s, dtype=torch.bfloat16) * 0.8)(D, F) * (D ** -0.5)),
            "w2": _w((lambda *s: torch.randn(*s, dtype=torch.bfloat16) * 0.2)(F, D) * (F ** -0.5)),
        }
    _B_in = _B_setup()

    return {
        "A_x": _A_in["x"],
        "A_wqkv": _A_in["wqkv"],
        "A_wo": _A_in["wo"],
        "B_x": _B_in["x"],
        "B_w1": _B_in["w1"],
        "B_w2": _B_in["w2"],
    }

def reference(A_x, A_wqkv, A_wo, B_x, B_w1, B_w2):
    def _A_ref(x, wqkv, wo):
        B, S, D = x.shape
        H = 16; Dh = D // H
        qkv = (lambda x, *d: x.permute(*d))((x @ wqkv).reshape(B, S, 3, H, Dh), 2, 0, 3, 1, 4)
        q, k, v = qkv[0], qkv[1], qkv[2]
        scale = Dh ** -0.5
        scores = torch.einsum("bhqd,bhkd->bhqk", q, k) * scale
        p = _softmax(scores, axis=-1)
        o = torch.einsum("bhqk,bhkd->bhqd", p, v)
        return (lambda x, *d: x.permute(*d))(o, 0, 2, 1, 3).reshape(B, S, D) @ wo

    def _B_ref(x, w1, w2):
        h = torch.einsum("bsd,df->bsf", x, w1)
        h = _silu(h)
        out = torch.einsum("bsf,fd->bsd", h, w2)
        return out

    x = A_x
    h = x + _A_ref(_layernorm(x, axis=-1), A_wqkv, A_wo)
    h2 = h + _B_ref(_layernorm(h, axis=-1), B_w1, B_w2)
    return h2
```

```asm
; @launch kernel=qkv_kernel grid=(256,1,1) block=(768,1,1) lds=162304
; @launch kernel=fused_kernel grid=(256,1,1) block=(256,1,1) lds=149504
.amdgcn_target "amdgcn-amd-amdhsa--gfx950"
.text
.globl qkv_kernel
.p2align 8
.type qkv_kernel,@function
qkv_kernel:
    s_cmp_ge_u32 s2, 256
    s_cbranch_scc1 L_qkv_kernel_done
    s_load_dwordx4 s[4:7], s[0:1], 0
    s_load_dwordx2 s[24:25], s[0:1], 64
    s_load_dwordx2 s[46:47], s[0:1], 16
    s_load_dwordx4 s[48:51], s[0:1], 32
    v_lshrrev_b32 v1, 6, v0
    v_lshlrev_b32 v4, 4, v0
    s_getpc_b64 s[20:21]
L_pc1:
    s_sub_u32 s20, s20, L_pc1-qkv_kernel
    s_subb_u32 s21, s21, 0
    s_mov_b32 s22, L_code_end-qkv_kernel
    s_mov_b32 s23, 0x00020000
    s_lshr_b32 s26, s2, 3
    s_and_b32 s26, s26, 3
    s_mul_i32 s26, s26, 12288
    v_and_b32 v0, 63, v0
    v_readfirstlane_b32 s31, v1
    buffer_load_dword v1, v4, s[20:23], s26 offen
    s_and_b32 s26, s2, 7
    s_lshr_b32 s27, s2, 3
    s_lshr_b32 s28, s26, 1
    s_lshl_b32 s28, s28, 2
    s_and_b32 s29, s27, 3
    s_add_u32 s28, s28, s29
    s_and_b32 s29, s26, 1
    s_lshl_b32 s29, s29, 3
    s_lshr_b32 s27, s27, 2
    s_add_u32 s29, s29, s27
    s_and_b32 s30, s31, 3
    s_lshl_b32 s32, s28, 2
    s_add_u32 s32, s32, s30
    v_and_b32 v2, 31, v0
    v_lshrrev_b32 v3, 5, v0
    s_cmp_eq_u32 s29, 15
    s_cselect_b32 s3, 8, 0
    s_lshl_b32 s39, s30, 12
    s_add_u32 s39, s39, 64000
    s_cmp_ge_u32 s31, 8
    s_cbranch_scc1 L_k1_stats
    s_cmp_ge_u32 s31, 4
    s_cbranch_scc1 L_k1_mfma
    s_setprio 3
    v_lshrrev_b32 v20, 3, v0
    v_and_b32 v21, 7, v0
    v_lshrrev_b32 v22, 4, v0
    v_xor_b32 v23, v21, v22
    v_xor_b32 v24, 4, v23
    v_mul_u32_u24 v20, 896, v20
    v_lshl_add_u32 v4, v23, 4, v20
    v_lshl_add_u32 v5, v24, 4, v20
    v_add_u32 v5, 7168, v5
    v_add_u32 v6, 14336, v4
    v_add_u32 v7, 14336, v5
    s_mul_i32 s33, s32, 28672
    s_waitcnt lgkmcnt(0)
    s_mov_b32 s8, s4
    s_mov_b32 s9, s5
    s_mov_b32 s10, 1835008
    s_mov_b32 s11, 0x00020000
    s_add_u32 s40, s33, 0
    s_add_u32 m0, s39, 0
    s_nop 0
    buffer_load_dwordx4 v4, s[8:11], s40 offen lds
    s_add_u32 m0, s39, 1024
    s_nop 0
    buffer_load_dwordx4 v5, s[8:11], s40 offen lds
    s_add_u32 m0, s39, 2048
    s_nop 0
    buffer_load_dwordx4 v6, s[8:11], s40 offen lds
    s_add_u32 m0, s39, 3072
    s_nop 0
    buffer_load_dwordx4 v7, s[8:11], s40 offen lds
    s_mul_i32 s35, s29, 168
    s_mul_i32 s34, s30, 43008
    s_add_u32 s35, s35, s34
    v_mov_b32 v24, 0x7f000000
    s_sub_u32 s35, s35, s3
    v_add_u32 v20, 0, v0
    v_mul_u32_u24 v21, 43691, v20
    v_lshrrev_b32 v21, 19, v21
    v_mul_u32_u24 v22, 12, v21
    v_sub_u32 v22, v20, v22
    v_cmp_eq_u32 vcc, 11, v22
    v_mul_u32_u24 v21, 2688, v21
    v_lshl_add_u32 v21, v22, 4, v21
    v_add_u32 v21, s35, v21
    v_cndmask_b32 v8, v21, v24, vcc
    v_add_u32 v20, 64, v0
    v_mul_u32_u24 v21, 43691, v20
    v_lshrrev_b32 v21, 19, v21
    v_mul_u32_u24 v22, 12, v21
    v_sub_u32 v22, v20, v22
    v_cmp_eq_u32 vcc, 11, v22
    v_mul_u32_u24 v21, 2688, v21
    v_lshl_add_u32 v21, v22, 4, v21
    v_add_u32 v21, s35, v21
    v_cndmask_b32 v9, v21, v24, vcc
    v_add_u32 v20, 128, v0
    v_mul_u32_u24 v21, 43691, v20
    v_lshrrev_b32 v21, 19, v21
    v_mul_u32_u24 v22, 12, v21
    v_sub_u32 v22, v20, v22
    v_cmp_eq_u32 vcc, 11, v22
    v_mul_u32_u24 v21, 2688, v21
    v_lshl_add_u32 v21, v22, 4, v21
    v_add_u32 v21, s35, v21
    v_cndmask_b32 v10, v21, v24, vcc
    s_mul_i32 s38, s30, 3072
    s_add_u32 s38, s38, 2560
    s_mov_b32 s12, s6
    s_mov_b32 s13, s7
    s_mov_b32 s14, 1204224
    s_mov_b32 s15, 0x00020000
    s_mov_b32 s41, 0
    s_add_u32 m0, s38, 0
    s_nop 0
    buffer_load_dwordx4 v8, s[12:15], s41 offen lds
    s_add_u32 m0, s38, 1024
    s_nop 0
    buffer_load_dwordx4 v9, s[12:15], s41 offen lds
    s_add_u32 m0, s38, 2048
    s_nop 0
    buffer_load_dwordx4 v10, s[12:15], s41 offen lds
    s_add_u32 s40, s33, 128
    s_add_u32 m0, s39, 16384
    s_nop 0
    buffer_load_dwordx4 v4, s[8:11], s40 offen lds
    s_add_u32 m0, s39, 17408
    s_nop 0
    buffer_load_dwordx4 v5, s[8:11], s40 offen lds
    s_add_u32 m0, s39, 18432
    s_nop 0
    buffer_load_dwordx4 v6, s[8:11], s40 offen lds
    s_add_u32 m0, s39, 19456
    s_nop 0
    buffer_load_dwordx4 v7, s[8:11], s40 offen lds
    s_mov_b32 s41, 172032
    s_add_u32 m0, s38, 12288
    s_nop 0
    buffer_load_dwordx4 v8, s[12:15], s41 offen lds
    s_add_u32 m0, s38, 13312
    s_nop 0
    buffer_load_dwordx4 v9, s[12:15], s41 offen lds
    s_add_u32 m0, s38, 14336
    s_nop 0
    buffer_load_dwordx4 v10, s[12:15], s41 offen lds
    s_waitcnt vmcnt(7)
    s_barrier
    s_add_u32 s40, s33, 256
    s_add_u32 m0, s39, 32768
    s_nop 0
    buffer_load_dwordx4 v4, s[8:11], s40 offen lds
    s_add_u32 m0, s39, 33792
    s_nop 0
    buffer_load_dwordx4 v5, s[8:11], s40 offen lds
    s_add_u32 m0, s39, 34816
    s_nop 0
    buffer_load_dwordx4 v6, s[8:11], s40 offen lds
    s_add_u32 m0, s39, 35840
    s_nop 0
    buffer_load_dwordx4 v7, s[8:11], s40 offen lds
    s_mov_b32 s41, 344064
    s_add_u32 m0, s38, 24576
    s_nop 0
    buffer_load_dwordx4 v8, s[12:15], s41 offen lds
    s_add_u32 m0, s38, 25600
    s_nop 0
    buffer_load_dwordx4 v9, s[12:15], s41 offen lds
    s_add_u32 m0, s38, 26624
    s_nop 0
    buffer_load_dwordx4 v10, s[12:15], s41 offen lds
    s_add_u32 s40, s33, 384
    s_add_u32 m0, s39, 49152
    s_nop 0
    buffer_load_dwordx4 v4, s[8:11], s40 offen lds
    s_add_u32 m0, s39, 50176
    s_nop 0
    buffer_load_dwordx4 v5, s[8:11], s40 offen lds
    s_add_u32 m0, s39, 51200
    s_nop 0
    buffer_load_dwordx4 v6, s[8:11], s40 offen lds
    s_add_u32 m0, s39, 52224
    s_nop 0
    buffer_load_dwordx4 v7, s[8:11], s40 offen lds
    s_mov_b32 s41, 516096
    s_add_u32 m0, s38, 36864
    s_nop 0
    buffer_load_dwordx4 v8, s[12:15], s41 offen lds
    s_add_u32 m0, s38, 37888
    s_nop 0
    buffer_load_dwordx4 v9, s[12:15], s41 offen lds
    s_add_u32 m0, s38, 38912
    s_nop 0
    buffer_load_dwordx4 v10, s[12:15], s41 offen lds
    s_waitcnt vmcnt(14)
    s_barrier
    s_add_u32 s40, s33, 512
    s_add_u32 m0, s39, 65536
    s_nop 0
    buffer_load_dwordx4 v4, s[8:11], s40 offen lds
    s_add_u32 m0, s39, 66560
    s_nop 0
    buffer_load_dwordx4 v5, s[8:11], s40 offen lds
    s_add_u32 m0, s39, 67584
    s_nop 0
    buffer_load_dwordx4 v6, s[8:11], s40 offen lds
    s_add_u32 m0, s39, 68608
    s_nop 0
    buffer_load_dwordx4 v7, s[8:11], s40 offen lds
    s_mov_b32 s41, 688128
    s_add_u32 m0, s38, 49152
    s_nop 0
    buffer_load_dwordx4 v8, s[12:15], s41 offen lds
    s_add_u32 m0, s38, 50176
    s_nop 0
    buffer_load_dwordx4 v9, s[12:15], s41 offen lds
    s_add_u32 m0, s38, 51200
    s_nop 0
    buffer_load_dwordx4 v10, s[12:15], s41 offen lds
    s_mov_b32 s16, s24
    s_mov_b32 s17, s25
    s_mov_b32 s18, 26214400
    s_mov_b32 s19, 0x00020000
    s_mul_i32 s42, s29, 11
    s_lshr_b32 s42, s42, 5
    s_mul_i32 s43, s42, 3
    s_cmp_eq_u32 s43, s29
    s_cselect_b32 s44, 1, 0
    s_cmp_eq_u32 s29, 0
    s_cselect_b32 s44, 0, s44
    s_cmp_eq_u32 s29, 15
    s_cselect_b32 s44, 0, s44
    s_min_u32 s43, s42, 4
    s_sub_u32 s43, s29, s43
    s_lshl_b32 s43, s43, 4
    s_add_u32 s43, s43, s28
    s_lshl_b32 s43, s43, 2
    s_add_u32 s43, s43, s30
    s_lshl_b32 s42, s42, 4
    s_add_u32 s42, s42, s28
    s_lshl_b32 s42, s42, 1
    s_add_u32 s42, s42, s30
    s_add_u32 s42, s42, 736
    s_cmp_eq_u32 s44, 0
    s_cselect_b32 s42, s43, s42
    s_lshr_b32 s45, s30, 1
    s_and_b32 s45, s45, s44
    s_cmp_lt_u32 s42, 112
    s_cbranch_scc1 L_k1_h_wo
    s_cmp_lt_u32 s42, 504
    s_cbranch_scc1 L_k1_h_w1
    s_sub_u32 s42, s42, 504
    s_mul_i32 s43, s42, 9363
    s_lshr_b32 s43, s43, 16
    s_mul_i32 s44, s43, 7
    s_sub_u32 s42, s42, s44
    s_mul_i32 s53, s42, 112
    s_add_u32 s53, s53, s43
    s_add_u32 s53, s53, 1008
    s_mov_b32 s59, 114688
    s_mov_b32 s52, 896
    s_mul_i32 s57, s43, 28672
    s_mov_b32 s54, 0
    s_mov_b32 s22, 1605632
    s_mov_b32 s20, s50
    s_mov_b32 s21, s51
    s_branch L_k1_h_done
L_k1_h_w1:
    s_sub_u32 s42, s42, 112
    s_lshr_b32 s43, s42, 2
    s_mul_i32 s43, s43, 9363
    s_lshr_b32 s43, s43, 16
    s_mul_i32 s44, s43, 28
    s_sub_u32 s42, s42, s44
    s_mul_i32 s53, s42, 28
    s_add_u32 s53, s53, s43
    s_add_u32 s53, s53, 224
    s_mov_b32 s59, 28672
    s_mov_b32 s52, 3584
    s_mul_i32 s57, s43, 114688
    s_mov_b32 s54, 0
    s_mov_b32 s22, 1605632
    s_mov_b32 s20, s48
    s_mov_b32 s21, s49
    s_branch L_k1_h_done
L_k1_h_wo:
    s_mul_i32 s43, s42, 9363
    s_lshr_b32 s43, s43, 16
    s_mul_i32 s44, s43, 7
    s_sub_u32 s42, s42, s44
    s_lshl_b32 s53, s42, 5
    s_add_u32 s53, s53, s43
    s_mov_b32 s59, 32768
    s_mov_b32 s52, 896
    s_mul_i32 s57, s43, 25088
    s_mov_b32 s54, -1
    s_mov_b32 s22, 401408
    s_mov_b32 s20, s46
    s_mov_b32 s21, s47
L_k1_h_done:
    s_mov_b32 s23, 0x00020000
    s_lshl_b32 s42, s42, 7
    s_add_u32 s57, s57, s42
    s_lshl_b32 s53, s53, 11
    s_add_u32 s53, s53, 20971520
    s_cmp_lg_u32 s45, 0
    s_cselect_b32 s53, 0x7f000000, s53
    s_cselect_b32 s57, 0x7f000000, s57
    s_add_u32 s58, s53, s59
    s_lshl_b32 s56, s52, 4
    s_add_u32 s56, s56, s57
    s_add_u32 s36, s57, 64
    s_add_u32 s37, s56, 64
    v_lshrrev_b32 v25, 2, v0
    v_mul_u32_u24 v25, s52, v25
    v_and_b32 v26, 3, v0
    v_lshl_add_u32 v25, v26, 4, v25
    s_add_u32 s55, s39, 16384
    s_waitcnt vmcnt(14)
    s_barrier
    s_add_u32 s40, s33, 640
    s_add_u32 m0, s39, 81920
    s_nop 0
    buffer_load_dwordx4 v4, s[8:11], s40 offen lds
    s_add_u32 m0, s39, 82944
    s_nop 0
    buffer_load_dwordx4 v5, s[8:11], s40 offen lds
    s_add_u32 m0, s39, 83968
    s_nop 0
    buffer_load_dwordx4 v6, s[8:11], s40 offen lds
    s_add_u32 m0, s39, 84992
    s_nop 0
    buffer_load_dwordx4 v7, s[8:11], s40 offen lds
    s_add_u32 s40, s33, 768
    s_add_u32 m0, s39, 0
    s_nop 0
    buffer_load_dwordx4 v4, s[8:11], s40 offen lds
    s_add_u32 m0, s39, 1024
    s_nop 0
    buffer_load_dwordx4 v5, s[8:11], s40 offen lds
    s_add_u32 m0, s39, 2048
    s_nop 0
    buffer_load_dwordx4 v6, s[8:11], s40 offen lds
    s_add_u32 m0, s39, 3072
    s_nop 0
    buffer_load_dwordx4 v7, s[8:11], s40 offen lds
    s_mov_b32 s41, 860160
    s_add_u32 m0, s38, 0
    s_nop 0
    buffer_load_dwordx4 v8, s[12:15], s41 offen lds
    s_add_u32 m0, s38, 1024
    s_nop 0
    buffer_load_dwordx4 v9, s[12:15], s41 offen lds
    s_add_u32 m0, s38, 2048
    s_nop 0
    buffer_load_dwordx4 v10, s[12:15], s41 offen lds
    s_waitcnt vmcnt(18)
    s_barrier
    s_mov_b32 s41, 1032192
    s_add_u32 m0, s38, 12288
    s_nop 0
    buffer_load_dwordx4 v8, s[12:15], s41 offen lds
    s_add_u32 m0, s38, 13312
    s_nop 0
    buffer_load_dwordx4 v9, s[12:15], s41 offen lds
    s_add_u32 m0, s38, 14336
    s_nop 0
    buffer_load_dwordx4 v10, s[12:15], s41 offen lds
    s_add_u32 m0, s55, 0
    s_nop 0
    buffer_load_dwordx4 v25, s[20:23], s57 offen lds
    s_add_u32 m0, s55, 1024
    s_nop 0
    buffer_load_dwordx4 v25, s[20:23], s56 offen lds
    s_add_u32 m0, s55, 2048
    s_nop 0
    buffer_load_dwordx4 v25, s[20:23], s36 offen lds
    s_add_u32 m0, s55, 3072
    s_nop 0
    buffer_load_dwordx4 v25, s[20:23], s37 offen lds
    v_mov_b32 v60, 0
    v_mov_b32 v61, 0
    v_mov_b32 v62, 0
    v_mov_b32 v63, 0
    s_lshl_b32 s26, s2, 2
    s_add_u32 s26, s26, s30
    s_lshl_b32 s27, s26, 7
    s_add_u32 s27, s27, 25296896
    s_lshl_b32 s26, s26, 5
    s_add_u32 s26, s26, 25231328
    v_lshlrev_b32 v26, 4, v0
    v_add_u32 v27, s26, v26
    v_add_u32 v26, s27, v26
    v_cmp_gt_u32 vcc, 2, v0
    s_nop 1
    v_cndmask_b32 v15, v27, v26, vcc
    s_mov_b64 exec, 0xf
    buffer_store_dwordx4 v[60:63], v15, s[16:19], 0 offen sc1
    s_mov_b64 exec, -1
    s_waitcnt vmcnt(19)
    s_barrier
    s_waitcnt vmcnt(8)
    s_barrier
    s_waitcnt vmcnt(5)
    s_barrier
    s_barrier
    v_and_b32 v26, 15, v0
    v_lshrrev_b32 v27, 2, v26
    v_and_b32 v26, 3, v26
    v_lshlrev_b32 v26, 3, v26
    v_lshl_add_u32 v26, v27, 6, v26
    v_lshrrev_b32 v27, 4, v0
    v_and_b32 v27, 1, v27
    v_lshl_add_u32 v26, v27, 5, v26
    v_lshl_add_u32 v26, v3, 8, v26
    v_add_u32 v26, s55, v26
    v_lshlrev_b32 v27, 4, v0
    s_waitcnt vmcnt(1)
    ds_read_b64_tr_b16 v[96:97], v26 offset:0
    ds_read_b64_tr_b16 v[98:99], v26 offset:512
    ds_read_b64_tr_b16 v[100:101], v26 offset:1024
    ds_read_b64_tr_b16 v[102:103], v26 offset:1536
    ds_read_b64_tr_b16 v[104:105], v26 offset:2048
    ds_read_b64_tr_b16 v[106:107], v26 offset:2560
    ds_read_b64_tr_b16 v[108:109], v26 offset:3072
    ds_read_b64_tr_b16 v[110:111], v26 offset:3584
    s_mov_b32 exec_lo, 0
    s_mov_b32 exec_hi, s54
    s_waitcnt lgkmcnt(0)
    v_mov_b32 v102, 0
    v_mov_b32 v103, 0
    v_mov_b32 v110, 0
    v_mov_b32 v111, 0
    s_mov_b64 exec, -1
    buffer_store_dwordx4 v[96:99], v27, s[16:19], s53 offen sc1
    buffer_store_dwordx4 v[100:103], v27, s[16:19], s53 offen offset:1024 sc1
    buffer_store_dwordx4 v[104:107], v27, s[16:19], s58 offen sc1
    buffer_store_dwordx4 v[108:111], v27, s[16:19], s58 offen offset:1024 sc1
    s_endpgm
L_k1_stats:
    s_setprio 2
    s_lshr_b32 s60, s2, 3
    s_lshl_b32 s60, s60, 1
    s_and_b32 s61, s30, 1
    s_add_u32 s60, s60, s61
    v_mov_b32 v131, 0x7f000000
    s_mov_b32 s11, 0x00020000
    s_cmp_ge_u32 s30, 2
    s_cbranch_scc1 L_k1_tw
    s_lshr_b32 s61, s28, 2
    s_mul_i32 s61, s61, 458752
    s_mul_i32 s62, s60, 7168
    s_add_u32 s62, s61, s62
    v_lshrrev_b32 v128, 3, v0
    v_and_b32 v129, 7, v0
    v_mul_u32_u24 v128, 896, v128
    v_cmp_gt_u32 vcc, 5, v129
    v_lshl_add_u32 v128, v129, 7, v128
    v_add_u32 v128, 256, v128
    s_mov_b32 s10, 1835008
    s_waitcnt lgkmcnt(0)
    s_mov_b32 s8, s4
    s_mov_b32 s9, s5
    s_branch L_k1_tj
L_k1_tw:
    s_lshr_b32 s63, s29, 3
    s_mul_i32 s63, s63, 1280
    s_mul_i32 s62, s60, 13440
    s_add_u32 s62, s62, s63
    s_add_u32 s62, s62, 344064
    v_mul_u32_u24 v128, 43691, v0
    v_lshrrev_b32 v128, 19, v128
    v_mul_u32_u24 v129, 12, v128
    v_sub_u32 v129, v0, v129
    v_mul_u32_u24 v128, 2688, v128
    v_lshl_add_u32 v128, v129, 7, v128
    v_cmp_gt_u32 vcc, 60, v0
    v_cndmask_b32 v129, 11, v129, vcc
    v_cmp_gt_u32 vcc, 11, v129
    s_mov_b32 s10, 1204224
    s_waitcnt lgkmcnt(0)
    s_mov_b32 s8, s6
    s_mov_b32 s9, s7
L_k1_tj:
    v_cndmask_b32 v128, v131, v128, vcc
    buffer_load_dword v132, v128, s[8:11], s62 offen
    v_and_b32 v20, 15, v0
    v_lshrrev_b32 v21, 2, v20
    v_and_b32 v22, 3, v20
    v_lshrrev_b32 v23, 4, v0
    v_and_b32 v24, 1, v23
    v_lshl_add_u32 v21, v3, 3, v21
    v_mul_u32_u24 v21, 192, v21
    v_lshl_add_u32 v21, v24, 5, v21
    v_lshl_add_u32 v11, v22, 3, v21
    s_min_u32 s43, s30, 2
    s_mul_i32 s44, s43, 56
    s_add_u32 s44, s44, 2560
    v_add_u32 v11, s44, v11
    v_lshrrev_b32 v13, 1, v20
    v_xor_b32 v13, v13, v23
    v_lshlrev_b32 v14, 7, v20
    v_add_u32 v14, s39, v14
    v_lshl_add_u32 v16, v13, 4, v14
    v_xor_b32 v13, 4, v13
    v_lshl_add_u32 v17, v13, 4, v14
    v_add_u32 v18, 49152, v16
    v_add_u32 v19, 49152, v17
    v_xor_b32 v24, v23, v0
    v_and_b32 v24, 1, v24
    v_mov_b32 v28, 0x3f803f80
    v_cmp_eq_u32 vcc, 0, v24
    v_mov_b32 v29, 0x3f803f80
    v_mov_b32 v30, 0x3f803f80
    v_mov_b32 v31, 0x3f803f80
    v_cndmask_b32 v32, 0, v28, vcc
    v_cndmask_b32 v33, 0, v28, vcc
    v_cndmask_b32 v34, 0, v28, vcc
    v_cndmask_b32 v35, 0, v28, vcc
    s_lshl_b32 s43, s30, 8
    v_lshlrev_b32 v12, 3, v2
    v_add_u32 v12, s43, v12
    v_lshlrev_b32 v13, 3, v20
    v_add_u32 v13, s43, v13
    v_lshrrev_b32 v14, 1, v13
    v_and_b32 v20, 3, v0
    v_cmp_eq_u32 s[34:35], 1, v20
    v_cmp_eq_u32 s[26:27], 2, v20
    v_cmp_eq_u32 s[42:43], 3, v20
    v_cmp_gt_u32 s[44:45], 16, v2
    v_add_u32 v11, s3, v11
    s_barrier
    ds_read_b128 v[64:67], v16 offset:0
    ds_read_b128 v[68:71], v16 offset:2048
    ds_read_b128 v[72:75], v17 offset:0
    ds_read_b128 v[76:79], v17 offset:2048
    ds_read_b64_tr_b16 v[96:97], v11 offset:0
    ds_read_b64_tr_b16 v[98:99], v11 offset:768
    ds_read_b64_tr_b16 v[100:101], v11 offset:3072
    ds_read_b64_tr_b16 v[102:103], v11 offset:3840
    ds_read_b64_tr_b16 v[104:105], v11 offset:6144
    ds_read_b64_tr_b16 v[106:107], v11 offset:6912
    ds_read_b64_tr_b16 v[108:109], v11 offset:9216
    ds_read_b64_tr_b16 v[110:111], v11 offset:9984
    s_waitcnt lgkmcnt(11)
    v_mfma_f32_16x16x32_bf16 v[36:39], v[64:67], v[64:67], 0
    v_mfma_f32_16x16x32_bf16 v[44:47], v[28:31], v[64:67], 0
    s_waitcnt lgkmcnt(10)
    v_mfma_f32_16x16x32_bf16 v[40:43], v[68:71], v[68:71], 0
    v_mfma_f32_16x16x32_bf16 v[48:51], v[28:31], v[68:71], 0
    s_waitcnt lgkmcnt(9)
    v_mfma_f32_16x16x32_bf16 v[36:39], v[72:75], v[72:75], v[36:39]
    v_mfma_f32_16x16x32_bf16 v[44:47], v[28:31], v[72:75], v[44:47]
    s_waitcnt lgkmcnt(8)
    v_mfma_f32_16x16x32_bf16 v[40:43], v[76:79], v[76:79], v[40:43]
    v_mfma_f32_16x16x32_bf16 v[48:51], v[28:31], v[76:79], v[48:51]
    s_waitcnt lgkmcnt(6)
    v_mfma_f32_16x16x32_bf16 v[52:55], v[32:35], v[96:99], 0
    s_waitcnt lgkmcnt(4)
    v_mfma_f32_16x16x32_bf16 v[52:55], v[32:35], v[100:103], v[52:55]
    s_waitcnt lgkmcnt(2)
    v_mfma_f32_16x16x32_bf16 v[52:55], v[32:35], v[104:107], v[52:55]
    s_waitcnt lgkmcnt(0)
    v_mfma_f32_16x16x32_bf16 v[52:55], v[32:35], v[108:111], v[52:55]
    s_barrier
    ds_read_b128 v[80:83], v16 offset:16384
    ds_read_b128 v[84:87], v16 offset:18432
    ds_read_b128 v[88:91], v17 offset:16384
    ds_read_b128 v[92:95], v17 offset:18432
    ds_read_b64_tr_b16 v[96:97], v11 offset:12288
    ds_read_b64_tr_b16 v[98:99], v11 offset:13056
    ds_read_b64_tr_b16 v[100:101], v11 offset:15360
    ds_read_b64_tr_b16 v[102:103], v11 offset:16128
    ds_read_b64_tr_b16 v[104:105], v11 offset:18432
    ds_read_b64_tr_b16 v[106:107], v11 offset:19200
    ds_read_b64_tr_b16 v[108:109], v11 offset:21504
    ds_read_b64_tr_b16 v[110:111], v11 offset:22272
    s_waitcnt lgkmcnt(11)
    v_mfma_f32_16x16x32_bf16 v[36:39], v[80:83], v[80:83], v[36:39]
    v_mfma_f32_16x16x32_bf16 v[44:47], v[28:31], v[80:83], v[44:47]
    s_waitcnt lgkmcnt(10)
    v_mfma_f32_16x16x32_bf16 v[40:43], v[84:87], v[84:87], v[40:43]
    v_mfma_f32_16x16x32_bf16 v[48:51], v[28:31], v[84:87], v[48:51]
    s_waitcnt lgkmcnt(9)
    v_mfma_f32_16x16x32_bf16 v[36:39], v[88:91], v[88:91], v[36:39]
    v_mfma_f32_16x16x32_bf16 v[44:47], v[28:31], v[88:91], v[44:47]
    s_waitcnt lgkmcnt(8)
    v_mfma_f32_16x16x32_bf16 v[40:43], v[92:95], v[92:95], v[40:43]
    v_mfma_f32_16x16x32_bf16 v[48:51], v[28:31], v[92:95], v[48:51]
    s_waitcnt lgkmcnt(6)
    v_mfma_f32_16x16x32_bf16 v[52:55], v[32:35], v[96:99], v[52:55]
    s_waitcnt lgkmcnt(4)
    v_mfma_f32_16x16x32_bf16 v[52:55], v[32:35], v[100:103], v[52:55]
    s_waitcnt lgkmcnt(2)
    v_mfma_f32_16x16x32_bf16 v[52:55], v[32:35], v[104:107], v[52:55]
    s_waitcnt lgkmcnt(0)
    v_mfma_f32_16x16x32_bf16 v[52:55], v[32:35], v[108:111], v[52:55]
    s_barrier
    ds_read_b128 v[64:67], v16 offset:32768
    ds_read_b128 v[68:71], v16 offset:34816
    ds_read_b128 v[72:75], v17 offset:32768
    ds_read_b128 v[76:79], v17 offset:34816
    ds_read_b64_tr_b16 v[96:97], v11 offset:24576
    ds_read_b64_tr_b16 v[98:99], v11 offset:25344
    ds_read_b64_tr_b16 v[100:101], v11 offset:27648
    ds_read_b64_tr_b16 v[102:103], v11 offset:28416
    ds_read_b64_tr_b16 v[104:105], v11 offset:30720
    ds_read_b64_tr_b16 v[106:107], v11 offset:31488
    ds_read_b64_tr_b16 v[108:109], v11 offset:33792
    ds_read_b64_tr_b16 v[110:111], v11 offset:34560
    s_waitcnt lgkmcnt(11)
    v_mfma_f32_16x16x32_bf16 v[36:39], v[64:67], v[64:67], v[36:39]
    v_mfma_f32_16x16x32_bf16 v[44:47], v[28:31], v[64:67], v[44:47]
    s_waitcnt lgkmcnt(10)
    v_mfma_f32_16x16x32_bf16 v[40:43], v[68:71], v[68:71], v[40:43]
    v_mfma_f32_16x16x32_bf16 v[48:51], v[28:31], v[68:71], v[48:51]
    s_waitcnt lgkmcnt(9)
    v_mfma_f32_16x16x32_bf16 v[36:39], v[72:75], v[72:75], v[36:39]
    v_mfma_f32_16x16x32_bf16 v[44:47], v[28:31], v[72:75], v[44:47]
    s_waitcnt lgkmcnt(8)
    v_mfma_f32_16x16x32_bf16 v[40:43], v[76:79], v[76:79], v[40:43]
    v_mfma_f32_16x16x32_bf16 v[48:51], v[28:31], v[76:79], v[48:51]
    s_waitcnt lgkmcnt(6)
    v_mfma_f32_16x16x32_bf16 v[52:55], v[32:35], v[96:99], v[52:55]
    s_waitcnt lgkmcnt(4)
    v_mfma_f32_16x16x32_bf16 v[52:55], v[32:35], v[100:103], v[52:55]
    s_waitcnt lgkmcnt(2)
    v_mfma_f32_16x16x32_bf16 v[52:55], v[32:35], v[104:107], v[52:55]
    s_waitcnt lgkmcnt(0)
    v_mfma_f32_16x16x32_bf16 v[52:55], v[32:35], v[108:111], v[52:55]
    s_barrier
    ds_read_b128 v[80:83], v18 offset:0
    ds_read_b128 v[84:87], v18 offset:2048
    ds_read_b128 v[88:91], v19 offset:0
    ds_read_b128 v[92:95], v19 offset:2048
    ds_read_b64_tr_b16 v[96:97], v11 offset:36864
    ds_read_b64_tr_b16 v[98:99], v11 offset:37632
    ds_read_b64_tr_b16 v[100:101], v11 offset:39936
    ds_read_b64_tr_b16 v[102:103], v11 offset:40704
    ds_read_b64_tr_b16 v[104:105], v11 offset:43008
    ds_read_b64_tr_b16 v[106:107], v11 offset:43776
    ds_read_b64_tr_b16 v[108:109], v11 offset:46080
    ds_read_b64_tr_b16 v[110:111], v11 offset:46848
    s_waitcnt lgkmcnt(11)
    v_mfma_f32_16x16x32_bf16 v[36:39], v[80:83], v[80:83], v[36:39]
    v_mfma_f32_16x16x32_bf16 v[44:47], v[28:31], v[80:83], v[44:47]
    s_waitcnt lgkmcnt(10)
    v_mfma_f32_16x16x32_bf16 v[40:43], v[84:87], v[84:87], v[40:43]
    v_mfma_f32_16x16x32_bf16 v[48:51], v[28:31], v[84:87], v[48:51]
    s_waitcnt lgkmcnt(9)
    v_mfma_f32_16x16x32_bf16 v[36:39], v[88:91], v[88:91], v[36:39]
    v_mfma_f32_16x16x32_bf16 v[44:47], v[28:31], v[88:91], v[44:47]
    s_waitcnt lgkmcnt(8)
    v_mfma_f32_16x16x32_bf16 v[40:43], v[92:95], v[92:95], v[40:43]
    v_mfma_f32_16x16x32_bf16 v[48:51], v[28:31], v[92:95], v[48:51]
    s_waitcnt lgkmcnt(6)
    v_mfma_f32_16x16x32_bf16 v[52:55], v[32:35], v[96:99], v[52:55]
    s_waitcnt lgkmcnt(4)
    v_mfma_f32_16x16x32_bf16 v[52:55], v[32:35], v[100:103], v[52:55]
    s_waitcnt lgkmcnt(2)
    v_mfma_f32_16x16x32_bf16 v[52:55], v[32:35], v[104:107], v[52:55]
    s_waitcnt lgkmcnt(0)
    v_mfma_f32_16x16x32_bf16 v[52:55], v[32:35], v[108:111], v[52:55]
    s_barrier
    ds_read_b128 v[64:67], v18 offset:16384
    ds_read_b128 v[68:71], v18 offset:18432
    ds_read_b128 v[72:75], v19 offset:16384
    ds_read_b128 v[76:79], v19 offset:18432
    ds_read_b64_tr_b16 v[96:97], v11 offset:49152
    ds_read_b64_tr_b16 v[98:99], v11 offset:49920
    ds_read_b64_tr_b16 v[100:101], v11 offset:52224
    ds_read_b64_tr_b16 v[102:103], v11 offset:52992
    ds_read_b64_tr_b16 v[104:105], v11 offset:55296
    ds_read_b64_tr_b16 v[106:107], v11 offset:56064
    ds_read_b64_tr_b16 v[108:109], v11 offset:58368
    ds_read_b64_tr_b16 v[110:111], v11 offset:59136
    s_waitcnt lgkmcnt(11)
    v_mfma_f32_16x16x32_bf16 v[36:39], v[64:67], v[64:67], v[36:39]
    v_mfma_f32_16x16x32_bf16 v[44:47], v[28:31], v[64:67], v[44:47]
    s_waitcnt lgkmcnt(10)
    v_mfma_f32_16x16x32_bf16 v[40:43], v[68:71], v[68:71], v[40:43]
    v_mfma_f32_16x16x32_bf16 v[48:51], v[28:31], v[68:71], v[48:51]
    s_waitcnt lgkmcnt(9)
    v_mfma_f32_16x16x32_bf16 v[36:39], v[72:75], v[72:75], v[36:39]
    v_mfma_f32_16x16x32_bf16 v[44:47], v[28:31], v[72:75], v[44:47]
    s_waitcnt lgkmcnt(8)
    v_mfma_f32_16x16x32_bf16 v[40:43], v[76:79], v[76:79], v[40:43]
    v_mfma_f32_16x16x32_bf16 v[48:51], v[28:31], v[76:79], v[48:51]
    s_waitcnt lgkmcnt(6)
    v_mfma_f32_16x16x32_bf16 v[52:55], v[32:35], v[96:99], v[52:55]
    s_waitcnt lgkmcnt(4)
    v_mfma_f32_16x16x32_bf16 v[52:55], v[32:35], v[100:103], v[52:55]
    s_waitcnt lgkmcnt(2)
    v_mfma_f32_16x16x32_bf16 v[52:55], v[32:35], v[104:107], v[52:55]
    s_waitcnt lgkmcnt(0)
    v_mfma_f32_16x16x32_bf16 v[52:55], v[32:35], v[108:111], v[52:55]
    s_barrier
    ds_read_b128 v[80:83], v18 offset:32768
    ds_read_b128 v[84:87], v18 offset:34816
    ds_read_b128 v[88:91], v19 offset:32768
    ds_read_b128 v[92:95], v19 offset:34816
    ds_read_b64_tr_b16 v[96:97], v11 offset:0
    ds_read_b64_tr_b16 v[98:99], v11 offset:768
    ds_read_b64_tr_b16 v[100:101], v11 offset:3072
    ds_read_b64_tr_b16 v[102:103], v11 offset:3840
    ds_read_b64_tr_b16 v[104:105], v11 offset:6144
    ds_read_b64_tr_b16 v[106:107], v11 offset:6912
    ds_read_b64_tr_b16 v[108:109], v11 offset:9216
    ds_read_b64_tr_b16 v[110:111], v11 offset:9984
    s_waitcnt lgkmcnt(11)
    v_mfma_f32_16x16x32_bf16 v[36:39], v[80:83], v[80:83], v[36:39]
    v_mfma_f32_16x16x32_bf16 v[44:47], v[28:31], v[80:83], v[44:47]
    s_waitcnt lgkmcnt(10)
    v_mfma_f32_16x16x32_bf16 v[40:43], v[84:87], v[84:87], v[40:43]
    v_mfma_f32_16x16x32_bf16 v[48:51], v[28:31], v[84:87], v[48:51]
    s_waitcnt lgkmcnt(9)
    v_mfma_f32_16x16x32_bf16 v[36:39], v[88:91], v[88:91], v[36:39]
    v_mfma_f32_16x16x32_bf16 v[44:47], v[28:31], v[88:91], v[44:47]
    s_waitcnt lgkmcnt(8)
    v_mfma_f32_16x16x32_bf16 v[40:43], v[92:95], v[92:95], v[40:43]
    v_mfma_f32_16x16x32_bf16 v[48:51], v[28:31], v[92:95], v[48:51]
    ds_read_b128 v[64:67], v16 offset:0
    ds_read_b128 v[68:71], v16 offset:2048
    ds_read_b128 v[72:75], v17 offset:0
    ds_read_b128 v[76:79], v17 offset:2048
    s_waitcnt lgkmcnt(10)
    v_mfma_f32_16x16x32_bf16 v[52:55], v[32:35], v[96:99], v[52:55]
    s_waitcnt lgkmcnt(8)
    v_mfma_f32_16x16x32_bf16 v[52:55], v[32:35], v[100:103], v[52:55]
    s_waitcnt lgkmcnt(6)
    v_mfma_f32_16x16x32_bf16 v[52:55], v[32:35], v[104:107], v[52:55]
    s_waitcnt lgkmcnt(4)
    v_mfma_f32_16x16x32_bf16 v[52:55], v[32:35], v[108:111], v[52:55]
    s_waitcnt lgkmcnt(3)
    v_mfma_f32_16x16x32_bf16 v[36:39], v[64:67], v[64:67], v[36:39]
    v_mfma_f32_16x16x32_bf16 v[44:47], v[28:31], v[64:67], v[44:47]
    s_waitcnt lgkmcnt(2)
    v_mfma_f32_16x16x32_bf16 v[40:43], v[68:71], v[68:71], v[40:43]
    v_mfma_f32_16x16x32_bf16 v[48:51], v[28:31], v[68:71], v[48:51]
    s_waitcnt lgkmcnt(1)
    v_mfma_f32_16x16x32_bf16 v[36:39], v[72:75], v[72:75], v[36:39]
    v_mfma_f32_16x16x32_bf16 v[44:47], v[28:31], v[72:75], v[44:47]
    s_waitcnt lgkmcnt(0)
    v_mfma_f32_16x16x32_bf16 v[40:43], v[76:79], v[76:79], v[40:43]
    v_mfma_f32_16x16x32_bf16 v[48:51], v[28:31], v[76:79], v[48:51]
    s_nop 7
    v_cndmask_b32 v36, v36, v37, s[34:35]
    v_cndmask_b32 v36, v36, v38, s[26:27]
    v_cndmask_b32 v36, v36, v39, s[42:43]
    v_cndmask_b32 v40, v40, v41, s[34:35]
    v_cndmask_b32 v40, v40, v42, s[26:27]
    v_cndmask_b32 v40, v40, v43, s[42:43]
    v_mul_f32 v44, 0x3b124925, v44
    v_mul_f32 v36, 0x3b124925, v36
    v_fma_f32 v36, -v44, v44, v36
    v_max_f32 v36, 0, v36
    v_cvt_pk_bf16_f32 v112, v44, v44
    v_lshlrev_b32 v44, 16, v112
    v_cvt_pk_bf16_f32 v112, v36, v36
    v_lshlrev_b32 v36, 16, v112
    v_add_f32 v36, 0x3727c5ac, v36
    v_cvt_pk_bf16_f32 v112, v36, v36
    v_lshlrev_b32 v36, 16, v112
    v_sqrt_f32 v36, v36
    s_nop 0
    v_cvt_pk_bf16_f32 v112, v36, v36
    v_lshlrev_b32 v36, 16, v112
    v_rcp_f32 v116, v36
    v_cvt_pk_bf16_f32 v120, -v44, -v44
    v_cvt_pk_bf16_f32 v121, -v44, 0
    v_mul_f32 v48, 0x3b124925, v48
    v_mul_f32 v40, 0x3b124925, v40
    v_fma_f32 v40, -v48, v48, v40
    v_max_f32 v40, 0, v40
    v_cvt_pk_bf16_f32 v112, v48, v48
    v_lshlrev_b32 v48, 16, v112
    v_cvt_pk_bf16_f32 v112, v40, v40
    v_lshlrev_b32 v40, 16, v112
    v_add_f32 v40, 0x3727c5ac, v40
    v_cvt_pk_bf16_f32 v112, v40, v40
    v_lshlrev_b32 v40, 16, v112
    v_sqrt_f32 v40, v40
    s_nop 0
    v_cvt_pk_bf16_f32 v112, v40, v40
    v_lshlrev_b32 v40, 16, v112
    v_rcp_f32 v117, v40
    v_cvt_pk_bf16_f32 v122, -v48, -v48
    v_cvt_pk_bf16_f32 v123, -v48, 0
    s_mov_b32 exec_lo, 0x00f0000f
    s_mov_b32 exec_hi, 0xf0000f00
    ds_write_b64 v13, v[120:121] offset:0
    ds_write_b32 v14, v116 offset:1024
    ds_write_b64 v13, v[122:123] offset:128
    ds_write_b32 v14, v117 offset:1088
    s_mov_b64 exec, -1
    s_waitcnt lgkmcnt(0)
    s_barrier
    ds_read_b64_tr_b16 v[96:97], v11 offset:12288
    ds_read_b64_tr_b16 v[98:99], v11 offset:13056
    ds_read_b64_tr_b16 v[100:101], v11 offset:15360
    ds_read_b64_tr_b16 v[102:103], v11 offset:16128
    ds_read_b64_tr_b16 v[104:105], v11 offset:18432
    ds_read_b64_tr_b16 v[106:107], v11 offset:19200
    ds_read_b64_tr_b16 v[108:109], v11 offset:21504
    ds_read_b64_tr_b16 v[110:111], v11 offset:22272
    s_waitcnt lgkmcnt(6)
    v_mfma_f32_16x16x32_bf16 v[52:55], v[32:35], v[96:99], v[52:55]
    s_waitcnt lgkmcnt(4)
    v_mfma_f32_16x16x32_bf16 v[52:55], v[32:35], v[100:103], v[52:55]
    s_waitcnt lgkmcnt(2)
    v_mfma_f32_16x16x32_bf16 v[52:55], v[32:35], v[104:107], v[52:55]
    s_waitcnt lgkmcnt(0)
    v_mfma_f32_16x16x32_bf16 v[52:55], v[32:35], v[108:111], v[52:55]
    s_nop 7
    v_cndmask_b32 v52, v53, v52, s[44:45]
    v_cvt_pk_bf16_f32 v112, v52, v52
    v_lshlrev_b32 v112, 16, v112
    v_sub_f32 v113, v52, v112
    v_cvt_pk_bf16_f32 v124, v52, v113
    v_and_b32 v112, 0xffff0000, v124
    v_sub_f32 v113, v113, v112
    v_cvt_pk_bf16_f32 v125, v113, 0
    ds_write_b64 v12, v[124:125] offset:1536
    s_waitcnt lgkmcnt(0)
    s_barrier
    s_endpgm
L_k1_mfma:
    v_and_b32 v20, 15, v0
    v_lshrrev_b32 v21, 2, v20
    v_and_b32 v22, 3, v20
    v_lshrrev_b32 v23, 4, v0
    v_and_b32 v23, 1, v23
    v_lshl_add_u32 v21, v3, 3, v21
    v_mul_u32_u24 v21, 192, v21
    v_lshl_add_u32 v21, v23, 5, v21
    v_lshl_add_u32 v11, v22, 3, v21
    v_add_u32 v11, 2560, v11
    v_lshrrev_b32 v13, 1, v2
    v_and_b32 v13, 7, v13
    v_xor_b32 v13, v13, v3
    v_lshlrev_b32 v14, 7, v2
    v_add_u32 v14, s39, v14
    v_add_u32 v11, s3, v11
    v_xor_b32 v15, 0, v13
    v_lshl_add_u32 v16, v15, 4, v14
    v_add_u32 v20, 49152, v16
    v_xor_b32 v15, 2, v13
    v_lshl_add_u32 v17, v15, 4, v14
    v_add_u32 v21, 49152, v17
    v_xor_b32 v15, 4, v13
    v_lshl_add_u32 v18, v15, 4, v14
    v_add_u32 v22, 49152, v18
    v_xor_b32 v15, 6, v13
    v_lshl_add_u32 v19, v15, 4, v14
    v_add_u32 v23, 49152, v19
    v_lshlrev_b32 v5, 3, v2
    s_lshl_b32 s41, s30, 8
    v_add_u32 v9, s41, v5
    v_lshrrev_b32 v7, 1, v9
    s_lshl_b32 s41, s30, 7
    v_lshlrev_b32 v8, 4, v3
    v_add_u32 v8, s41, v8
    v_lshlrev_b32 v12, 4, v0
    s_mul_i32 s44, s29, 3
    s_lshl_b32 s42, s44, 17
    s_lshl_b32 s43, s32, 11
    s_add_u32 s42, s42, s43
    s_add_u32 s43, s42, 131072
    s_add_u32 s44, s42, 262144
    v_cmp_eq_u32 vcc, 28, v2
    v_mov_b32 v165, 0x3f803f80
    s_cmp_lt_u32 s42, 2097152
    s_cselect_b32 s52, 0x3e8b97f6, 1.0
    s_cselect_b32 s56, 0, 0x3f80
    s_cmp_lt_u32 s43, 2097152
    s_cselect_b32 s53, 0x3e8b97f6, 1.0
    s_cselect_b32 s57, 0, 0x3f80
    s_cmp_lt_u32 s44, 2097152
    s_cselect_b32 s54, 0x3e8b97f6, 1.0
    s_cselect_b32 s58, 0, 0x3f80
    v_mov_b32 v160, 0
    v_mov_b32 v161, 0
    v_mov_b32 v162, 0
    v_mov_b32 v163, 0
    s_waitcnt lgkmcnt(0)
    s_mov_b32 s16, s24
    s_mov_b32 s17, s25
    s_mov_b32 s18, 26214400
    s_mov_b32 s19, 0x00020000
    s_cmp_eq_u32 s29, 10
    s_cbranch_scc1 L_k1_m1
    s_cmp_gt_u32 s29, 10
    s_cbranch_scc1 L_k1_m2
    v_mov_b32 v142, s56
    v_mov_b32 v143, 0
    v_mov_b32 v150, s57
    v_mov_b32 v151, 0
    v_mov_b32 v158, s58
    v_mov_b32 v159, 0
    s_barrier
    ds_read_b128 v[24:27], v16 offset:0
    ds_read_b64_tr_b16 v[56:57], v11 offset:0
    ds_read_b64_tr_b16 v[58:59], v11 offset:768
    ds_read_b64_tr_b16 v[60:61], v11 offset:56
    ds_read_b64_tr_b16 v[62:63], v11 offset:824
    ds_read_b64_tr_b16 v[64:65], v11 offset:112
    ds_read_b64_tr_b16 v[66:67], v11 offset:880
    ds_read_b128 v[28:31], v17 offset:0
    ds_read_b64_tr_b16 v[68:69], v11 offset:3072
    ds_read_b64_tr_b16 v[70:71], v11 offset:3840
    ds_read_b64_tr_b16 v[72:73], v11 offset:3128
    ds_read_b64_tr_b16 v[74:75], v11 offset:3896
    ds_read_b64_tr_b16 v[76:77], v11 offset:3184
    ds_read_b64_tr_b16 v[78:79], v11 offset:3952
    s_waitcnt lgkmcnt(11)
    v_mfma_f32_32x32x16_bf16 v[88:103], v[56:59], v[24:27], 0
    ds_read_b128 v[32:35], v18 offset:0
    ds_read_b64_tr_b16 v[80:81], v11 offset:6144
    ds_read_b64_tr_b16 v[82:83], v11 offset:6912
    s_waitcnt lgkmcnt(12)
    v_mfma_f32_32x32x16_bf16 v[104:119], v[60:63], v[24:27], 0
    ds_read_b64_tr_b16 v[84:85], v11 offset:6200
    ds_read_b64_tr_b16 v[86:87], v11 offset:6968
    s_waitcnt lgkmcnt(12)
    v_mfma_f32_32x32x16_bf16 v[120:135], v[64:67], v[24:27], 0
    ds_read_b64_tr_b16 v[56:57], v11 offset:6256
    ds_read_b64_tr_b16 v[58:59], v11 offset:7024
    s_waitcnt lgkmcnt(11)
    v_mfma_f32_32x32x16_bf16 v[88:103], v[68:71], v[28:31], v[88:103]
    ds_read_b128 v[36:39], v19 offset:0
    ds_read_b64_tr_b16 v[60:61], v11 offset:9216
    ds_read_b64_tr_b16 v[62:63], v11 offset:9984
    s_waitcnt lgkmcnt(12)
    v_mfma_f32_32x32x16_bf16 v[104:119], v[72:75], v[28:31], v[104:119]
    ds_read_b64_tr_b16 v[64:65], v11 offset:9272
    ds_read_b64_tr_b16 v[66:67], v11 offset:10040
    s_waitcnt lgkmcnt(12)
    v_mfma_f32_32x32x16_bf16 v[120:135], v[76:79], v[28:31], v[120:135]
    ds_read_b64_tr_b16 v[68:69], v11 offset:9328
    ds_read_b64_tr_b16 v[70:71], v11 offset:10096
    s_waitcnt lgkmcnt(11)
    v_mfma_f32_32x32x16_bf16 v[88:103], v[80:83], v[32:35], v[88:103]
    s_barrier
    ds_read_b128 v[40:43], v16 offset:16384
    ds_read_b64_tr_b16 v[72:73], v11 offset:12288
    ds_read_b64_tr_b16 v[74:75], v11 offset:13056
    s_waitcnt lgkmcnt(12)
    v_mfma_f32_32x32x16_bf16 v[104:119], v[84:87], v[32:35], v[104:119]
    ds_read_b64_tr_b16 v[76:77], v11 offset:12344
    ds_read_b64_tr_b16 v[78:79], v11 offset:13112
    s_waitcnt lgkmcnt(12)
    v_mfma_f32_32x32x16_bf16 v[120:135], v[56:59], v[32:35], v[120:135]
    ds_read_b64_tr_b16 v[80:81], v11 offset:12400
    ds_read_b64_tr_b16 v[82:83], v11 offset:13168
    s_waitcnt lgkmcnt(11)
    v_mfma_f32_32x32x16_bf16 v[88:103], v[60:63], v[36:39], v[88:103]
    ds_read_b128 v[44:47], v17 offset:16384
    ds_read_b64_tr_b16 v[84:85], v11 offset:15360
    ds_read_b64_tr_b16 v[86:87], v11 offset:16128
    s_waitcnt lgkmcnt(12)
    v_mfma_f32_32x32x16_bf16 v[104:119], v[64:67], v[36:39], v[104:119]
    ds_read_b64_tr_b16 v[56:57], v11 offset:15416
    ds_read_b64_tr_b16 v[58:59], v11 offset:16184
    s_waitcnt lgkmcnt(12)
    v_mfma_f32_32x32x16_bf16 v[120:135], v[68:71], v[36:39], v[120:135]
    ds_read_b64_tr_b16 v[60:61], v11 offset:15472
    ds_read_b64_tr_b16 v[62:63], v11 offset:16240
    s_waitcnt lgkmcnt(11)
    v_mfma_f32_32x32x16_bf16 v[88:103], v[72:75], v[40:43], v[88:103]
    ds_read_b128 v[48:51], v18 offset:16384
    ds_read_b64_tr_b16 v[64:65], v11 offset:18432
    ds_read_b64_tr_b16 v[66:67], v11 offset:19200
    s_waitcnt lgkmcnt(12)
    v_mfma_f32_32x32x16_bf16 v[104:119], v[76:79], v[40:43], v[104:119]
    ds_read_b64_tr_b16 v[68:69], v11 offset:18488
    ds_read_b64_tr_b16 v[70:71], v11 offset:19256
    s_waitcnt lgkmcnt(12)
    v_mfma_f32_32x32x16_bf16 v[120:135], v[80:83], v[40:43], v[120:135]
    ds_read_b64_tr_b16 v[72:73], v11 offset:18544
    ds_read_b64_tr_b16 v[74:75], v11 offset:19312
    s_waitcnt lgkmcnt(11)
    v_mfma_f32_32x32x16_bf16 v[88:103], v[84:87], v[44:47], v[88:103]
    ds_read_b128 v[52:55], v19 offset:16384
    ds_read_b64_tr_b16 v[76:77], v11 offset:21504
    ds_read_b64_tr_b16 v[78:79], v11 offset:22272
    s_waitcnt lgkmcnt(12)
    v_mfma_f32_32x32x16_bf16 v[104:119], v[56:59], v[44:47], v[104:119]
    ds_read_b64_tr_b16 v[80:81], v11 offset:21560
    ds_read_b64_tr_b16 v[82:83], v11 offset:22328
    s_waitcnt lgkmcnt(12)
    v_mfma_f32_32x32x16_bf16 v[120:135], v[60:63], v[44:47], v[120:135]
    ds_read_b64_tr_b16 v[84:85], v11 offset:21616
    ds_read_b64_tr_b16 v[86:87], v11 offset:22384
    s_waitcnt lgkmcnt(11)
    v_mfma_f32_32x32x16_bf16 v[88:103], v[64:67], v[48:51], v[88:103]
    s_barrier
    ds_read_b128 v[24:27], v16 offset:32768
    ds_read_b64_tr_b16 v[56:57], v11 offset:24576
    ds_read_b64_tr_b16 v[58:59], v11 offset:25344
    s_waitcnt lgkmcnt(12)
    v_mfma_f32_32x32x16_bf16 v[104:119], v[68:71], v[48:51], v[104:119]
    ds_read_b64_tr_b16 v[60:61], v11 offset:24632
    ds_read_b64_tr_b16 v[62:63], v11 offset:25400
    s_waitcnt lgkmcnt(12)
    v_mfma_f32_32x32x16_bf16 v[120:135], v[72:75], v[48:51], v[120:135]
    ds_read_b64_tr_b16 v[64:65], v11 offset:24688
    ds_read_b64_tr_b16 v[66:67], v11 offset:25456
    s_waitcnt lgkmcnt(11)
    v_mfma_f32_32x32x16_bf16 v[88:103], v[76:79], v[52:55], v[88:103]
    ds_read_b128 v[28:31], v17 offset:32768
    ds_read_b64_tr_b16 v[68:69], v11 offset:27648
    ds_read_b64_tr_b16 v[70:71], v11 offset:28416
    s_waitcnt lgkmcnt(12)
    v_mfma_f32_32x32x16_bf16 v[104:119], v[80:83], v[52:55], v[104:119]
    ds_read_b64_tr_b16 v[72:73], v11 offset:27704
    ds_read_b64_tr_b16 v[74:75], v11 offset:28472
    s_waitcnt lgkmcnt(12)
    v_mfma_f32_32x32x16_bf16 v[120:135], v[84:87], v[52:55], v[120:135]
    ds_read_b64_tr_b16 v[76:77], v11 offset:27760
    ds_read_b64_tr_b16 v[78:79], v11 offset:28528
    s_waitcnt lgkmcnt(11)
    v_mfma_f32_32x32x16_bf16 v[88:103], v[56:59], v[24:27], v[88:103]
    ds_read_b128 v[32:35], v18 offset:32768
    ds_read_b64_tr_b16 v[80:81], v11 offset:30720
    ds_read_b64_tr_b16 v[82:83], v11 offset:31488
    s_waitcnt lgkmcnt(12)
    v_mfma_f32_32x32x16_bf16 v[104:119], v[60:63], v[24:27], v[104:119]
    ds_read_b64_tr_b16 v[84:85], v11 offset:30776
    ds_read_b64_tr_b16 v[86:87], v11 offset:31544
    s_waitcnt lgkmcnt(12)
    v_mfma_f32_32x32x16_bf16 v[120:135], v[64:67], v[24:27], v[120:135]
    ds_read_b64_tr_b16 v[56:57], v11 offset:30832
    ds_read_b64_tr_b16 v[58:59], v11 offset:31600
    s_waitcnt lgkmcnt(11)
    v_mfma_f32_32x32x16_bf16 v[88:103], v[68:71], v[28:31], v[88:103]
    ds_read_b128 v[36:39], v19 offset:32768
    ds_read_b64_tr_b16 v[60:61], v11 offset:33792
    ds_read_b64_tr_b16 v[62:63], v11 offset:34560
    s_waitcnt lgkmcnt(12)
    v_mfma_f32_32x32x16_bf16 v[104:119], v[72:75], v[28:31], v[104:119]
    ds_read_b64_tr_b16 v[64:65], v11 offset:33848
    ds_read_b64_tr_b16 v[66:67], v11 offset:34616
    s_waitcnt lgkmcnt(12)
    v_mfma_f32_32x32x16_bf16 v[120:135], v[76:79], v[28:31], v[120:135]
    ds_read_b64_tr_b16 v[68:69], v11 offset:33904
    ds_read_b64_tr_b16 v[70:71], v11 offset:34672
    s_waitcnt lgkmcnt(11)
    v_mfma_f32_32x32x16_bf16 v[88:103], v[80:83], v[32:35], v[88:103]
    s_barrier
    ds_read_b128 v[40:43], v20 offset:0
    ds_read_b64_tr_b16 v[72:73], v11 offset:36864
    ds_read_b64_tr_b16 v[74:75], v11 offset:37632
    s_waitcnt lgkmcnt(12)
    v_mfma_f32_32x32x16_bf16 v[104:119], v[84:87], v[32:35], v[104:119]
    ds_read_b64_tr_b16 v[76:77], v11 offset:36920
    ds_read_b64_tr_b16 v[78:79], v11 offset:37688
    s_waitcnt lgkmcnt(12)
    v_mfma_f32_32x32x16_bf16 v[120:135], v[56:59], v[32:35], v[120:135]
    ds_read_b64_tr_b16 v[80:81], v11 offset:36976
    ds_read_b64_tr_b16 v[82:83], v11 offset:37744
    s_waitcnt lgkmcnt(11)
    v_mfma_f32_32x32x16_bf16 v[88:103], v[60:63], v[36:39], v[88:103]
    ds_read_b128 v[44:47], v21 offset:0
    ds_read_b64_tr_b16 v[84:85], v11 offset:39936
    ds_read_b64_tr_b16 v[86:87], v11 offset:40704
    s_waitcnt lgkmcnt(12)
    v_mfma_f32_32x32x16_bf16 v[104:119], v[64:67], v[36:39], v[104:119]
    ds_read_b64_tr_b16 v[56:57], v11 offset:39992
    ds_read_b64_tr_b16 v[58:59], v11 offset:40760
    s_waitcnt lgkmcnt(12)
    v_mfma_f32_32x32x16_bf16 v[120:135], v[68:71], v[36:39], v[120:135]
    ds_read_b64_tr_b16 v[60:61], v11 offset:40048
    ds_read_b64_tr_b16 v[62:63], v11 offset:40816
    s_waitcnt lgkmcnt(11)
    v_mfma_f32_32x32x16_bf16 v[88:103], v[72:75], v[40:43], v[88:103]
    ds_read_b128 v[48:51], v22 offset:0
    ds_read_b64_tr_b16 v[64:65], v11 offset:43008
    ds_read_b64_tr_b16 v[66:67], v11 offset:43776
    s_waitcnt lgkmcnt(12)
    v_mfma_f32_32x32x16_bf16 v[104:119], v[76:79], v[40:43], v[104:119]
    ds_read_b64_tr_b16 v[68:69], v11 offset:43064
    ds_read_b64_tr_b16 v[70:71], v11 offset:43832
    s_waitcnt lgkmcnt(12)
    v_mfma_f32_32x32x16_bf16 v[120:135], v[80:83], v[40:43], v[120:135]
    ds_read_b64_tr_b16 v[72:73], v11 offset:43120
    ds_read_b64_tr_b16 v[74:75], v11 offset:43888
    s_waitcnt lgkmcnt(11)
    v_mfma_f32_32x32x16_bf16 v[88:103], v[84:87], v[44:47], v[88:103]
    ds_read_b128 v[52:55], v23 offset:0
    ds_read_b64_tr_b16 v[76:77], v11 offset:46080
    ds_read_b64_tr_b16 v[78:79], v11 offset:46848
    s_waitcnt lgkmcnt(12)
    v_mfma_f32_32x32x16_bf16 v[104:119], v[56:59], v[44:47], v[104:119]
    ds_read_b64_tr_b16 v[80:81], v11 offset:46136
    ds_read_b64_tr_b16 v[82:83], v11 offset:46904
    s_waitcnt lgkmcnt(12)
    v_mfma_f32_32x32x16_bf16 v[120:135], v[60:63], v[44:47], v[120:135]
    ds_read_b64_tr_b16 v[84:85], v11 offset:46192
    ds_read_b64_tr_b16 v[86:87], v11 offset:46960
    s_waitcnt lgkmcnt(11)
    v_mfma_f32_32x32x16_bf16 v[88:103], v[64:67], v[48:51], v[88:103]
    s_barrier
    ds_read_b128 v[24:27], v20 offset:16384
    ds_read_b64_tr_b16 v[56:57], v11 offset:49152
    ds_read_b64_tr_b16 v[58:59], v11 offset:49920
    s_waitcnt lgkmcnt(12)
    v_mfma_f32_32x32x16_bf16 v[104:119], v[68:71], v[48:51], v[104:119]
    ds_read_b64_tr_b16 v[60:61], v11 offset:49208
    ds_read_b64_tr_b16 v[62:63], v11 offset:49976
    s_waitcnt lgkmcnt(12)
    v_mfma_f32_32x32x16_bf16 v[120:135], v[72:75], v[48:51], v[120:135]
    ds_read_b64_tr_b16 v[64:65], v11 offset:49264
    ds_read_b64_tr_b16 v[66:67], v11 offset:50032
    s_waitcnt lgkmcnt(11)
    v_mfma_f32_32x32x16_bf16 v[88:103], v[76:79], v[52:55], v[88:103]
    ds_read_b128 v[28:31], v21 offset:16384
    ds_read_b64_tr_b16 v[68:69], v11 offset:52224
    ds_read_b64_tr_b16 v[70:71], v11 offset:52992
    s_waitcnt lgkmcnt(12)
    v_mfma_f32_32x32x16_bf16 v[104:119], v[80:83], v[52:55], v[104:119]
    ds_read_b64_tr_b16 v[72:73], v11 offset:52280
    ds_read_b64_tr_b16 v[74:75], v11 offset:53048
    s_waitcnt lgkmcnt(12)
    v_mfma_f32_32x32x16_bf16 v[120:135], v[84:87], v[52:55], v[120:135]
    ds_read_b64_tr_b16 v[76:77], v11 offset:52336
    ds_read_b64_tr_b16 v[78:79], v11 offset:53104
    s_waitcnt lgkmcnt(11)
    v_mfma_f32_32x32x16_bf16 v[88:103], v[56:59], v[24:27], v[88:103]
    ds_read_b128 v[32:35], v22 offset:16384
    ds_read_b64_tr_b16 v[80:81], v11 offset:55296
    ds_read_b64_tr_b16 v[82:83], v11 offset:56064
    s_waitcnt lgkmcnt(12)
    v_mfma_f32_32x32x16_bf16 v[104:119], v[60:63], v[24:27], v[104:119]
    ds_read_b64_tr_b16 v[84:85], v11 offset:55352
    ds_read_b64_tr_b16 v[86:87], v11 offset:56120
    s_waitcnt lgkmcnt(12)
    v_mfma_f32_32x32x16_bf16 v[120:135], v[64:67], v[24:27], v[120:135]
    ds_read_b64_tr_b16 v[56:57], v11 offset:55408
    ds_read_b64_tr_b16 v[58:59], v11 offset:56176
    s_waitcnt lgkmcnt(11)
    v_mfma_f32_32x32x16_bf16 v[88:103], v[68:71], v[28:31], v[88:103]
    ds_read_b128 v[36:39], v23 offset:16384
    ds_read_b64_tr_b16 v[60:61], v11 offset:58368
    ds_read_b64_tr_b16 v[62:63], v11 offset:59136
    s_waitcnt lgkmcnt(12)
    v_mfma_f32_32x32x16_bf16 v[104:119], v[72:75], v[28:31], v[104:119]
    ds_read_b64_tr_b16 v[64:65], v11 offset:58424
    ds_read_b64_tr_b16 v[66:67], v11 offset:59192
    s_waitcnt lgkmcnt(12)
    v_mfma_f32_32x32x16_bf16 v[120:135], v[76:79], v[28:31], v[120:135]
    ds_read_b64_tr_b16 v[68:69], v11 offset:58480
    ds_read_b64_tr_b16 v[70:71], v11 offset:59248
    s_waitcnt lgkmcnt(11)
    v_mfma_f32_32x32x16_bf16 v[88:103], v[80:83], v[32:35], v[88:103]
    s_barrier
    ds_read_b128 v[40:43], v20 offset:32768
    ds_read_b64_tr_b16 v[72:73], v11 offset:0
    ds_read_b64_tr_b16 v[74:75], v11 offset:768
    s_waitcnt lgkmcnt(12)
    v_mfma_f32_32x32x16_bf16 v[104:119], v[84:87], v[32:35], v[104:119]
    ds_read_b64_tr_b16 v[76:77], v11 offset:56
    ds_read_b64_tr_b16 v[78:79], v11 offset:824
    s_waitcnt lgkmcnt(12)
    v_mfma_f32_32x32x16_bf16 v[120:135], v[56:59], v[32:35], v[120:135]
    ds_read_b64_tr_b16 v[80:81], v11 offset:112
    ds_read_b64_tr_b16 v[82:83], v11 offset:880
    s_waitcnt lgkmcnt(11)
    v_mfma_f32_32x32x16_bf16 v[88:103], v[60:63], v[36:39], v[88:103]
    ds_read_b128 v[44:47], v21 offset:32768
    ds_read_b64_tr_b16 v[84:85], v11 offset:3072
    ds_read_b64_tr_b16 v[86:87], v11 offset:3840
    s_waitcnt lgkmcnt(12)
    v_mfma_f32_32x32x16_bf16 v[104:119], v[64:67], v[36:39], v[104:119]
    ds_read_b64_tr_b16 v[56:57], v11 offset:3128
    ds_read_b64_tr_b16 v[58:59], v11 offset:3896
    s_waitcnt lgkmcnt(12)
    v_mfma_f32_32x32x16_bf16 v[120:135], v[68:71], v[36:39], v[120:135]
    ds_read_b64_tr_b16 v[60:61], v11 offset:3184
    ds_read_b64_tr_b16 v[62:63], v11 offset:3952
    s_waitcnt lgkmcnt(11)
    v_mfma_f32_32x32x16_bf16 v[88:103], v[72:75], v[40:43], v[88:103]
    ds_read_b128 v[48:51], v22 offset:32768
    ds_read_b64_tr_b16 v[64:65], v11 offset:6144
    ds_read_b64_tr_b16 v[66:67], v11 offset:6912
    s_waitcnt lgkmcnt(12)
    v_mfma_f32_32x32x16_bf16 v[104:119], v[76:79], v[40:43], v[104:119]
    ds_read_b64_tr_b16 v[68:69], v11 offset:6200
    ds_read_b64_tr_b16 v[70:71], v11 offset:6968
    s_waitcnt lgkmcnt(12)
    v_mfma_f32_32x32x16_bf16 v[120:135], v[80:83], v[40:43], v[120:135]
    ds_read_b64_tr_b16 v[72:73], v11 offset:6256
    ds_read_b64_tr_b16 v[74:75], v11 offset:7024
    s_waitcnt lgkmcnt(11)
    v_mfma_f32_32x32x16_bf16 v[88:103], v[84:87], v[44:47], v[88:103]
    ds_read_b128 v[52:55], v23 offset:32768
    ds_read_b64_tr_b16 v[76:77], v11 offset:9216
    ds_read_b64_tr_b16 v[78:79], v11 offset:9984
    s_waitcnt lgkmcnt(12)
    v_mfma_f32_32x32x16_bf16 v[104:119], v[56:59], v[44:47], v[104:119]
    ds_read_b64_tr_b16 v[80:81], v11 offset:9272
    ds_read_b64_tr_b16 v[82:83], v11 offset:10040
    s_waitcnt lgkmcnt(12)
    v_mfma_f32_32x32x16_bf16 v[120:135], v[60:63], v[44:47], v[120:135]
    ds_read_b64_tr_b16 v[84:85], v11 offset:9328
    ds_read_b64_tr_b16 v[86:87], v11 offset:10096
    s_waitcnt lgkmcnt(11)
    v_mfma_f32_32x32x16_bf16 v[88:103], v[64:67], v[48:51], v[88:103]
    s_barrier
    ds_read_b128 v[24:27], v16 offset:0
    ds_read_b64_tr_b16 v[56:57], v11 offset:12288
    ds_read_b64_tr_b16 v[58:59], v11 offset:13056
    s_waitcnt lgkmcnt(12)
    v_mfma_f32_32x32x16_bf16 v[104:119], v[68:71], v[48:51], v[104:119]
    ds_read_b128 v[28:31], v17 offset:0
    ds_read_b64_tr_b16 v[60:61], v11 offset:15360
    ds_read_b64_tr_b16 v[62:63], v11 offset:16128
    s_waitcnt lgkmcnt(13)
    v_mfma_f32_32x32x16_bf16 v[120:135], v[72:75], v[48:51], v[120:135]
    ds_read_b128 v[32:35], v18 offset:0
    ds_read_b64_tr_b16 v[64:65], v11 offset:18432
    ds_read_b64_tr_b16 v[66:67], v11 offset:19200
    s_waitcnt lgkmcnt(13)
    v_mfma_f32_32x32x16_bf16 v[88:103], v[76:79], v[52:55], v[88:103]
    ds_read_b128 v[36:39], v19 offset:0
    ds_read_b64_tr_b16 v[68:69], v11 offset:21504
    ds_read_b64_tr_b16 v[70:71], v11 offset:22272
    s_waitcnt lgkmcnt(14)
    v_mfma_f32_32x32x16_bf16 v[104:119], v[80:83], v[52:55], v[104:119]
    ds_read_b64_tr_b16 v[72:73], v11 offset:12344
    ds_read_b64_tr_b16 v[74:75], v11 offset:13112
    s_waitcnt lgkmcnt(14)
    v_mfma_f32_32x32x16_bf16 v[120:135], v[84:87], v[52:55], v[120:135]
    ds_read_b64_tr_b16 v[76:77], v11 offset:15416
    ds_read_b64_tr_b16 v[78:79], v11 offset:16184
    s_waitcnt lgkmcnt(13)
    v_mfma_f32_32x32x16_bf16 v[88:103], v[56:59], v[24:27], v[88:103]
    ds_read_b64_tr_b16 v[80:81], v11 offset:18488
    ds_read_b64_tr_b16 v[82:83], v11 offset:19256
    s_waitcnt lgkmcnt(12)
    v_mfma_f32_32x32x16_bf16 v[88:103], v[60:63], v[28:31], v[88:103]
    ds_read_b64_tr_b16 v[84:85], v11 offset:21560
    ds_read_b64_tr_b16 v[86:87], v11 offset:22328
    s_waitcnt lgkmcnt(11)
    v_mfma_f32_32x32x16_bf16 v[88:103], v[64:67], v[32:35], v[88:103]
    ds_read_b64_tr_b16 v[56:57], v11 offset:12400
    ds_read_b64_tr_b16 v[58:59], v11 offset:13168
    s_waitcnt lgkmcnt(10)
    v_mfma_f32_32x32x16_bf16 v[88:103], v[68:71], v[36:39], v[88:103]
    s_waitcnt lgkmcnt(8)
    v_mfma_f32_32x32x16_bf16 v[104:119], v[72:75], v[24:27], v[104:119]
    s_waitcnt lgkmcnt(6)
    v_mfma_f32_32x32x16_bf16 v[104:119], v[76:79], v[28:31], v[104:119]
    s_barrier
    s_mov_b32 exec_hi, 0
    ds_read_b64 v[160:161], v9 offset:0
    s_mov_b32 exec_hi, -1
    ds_read_b64 v[60:61], v5 offset:1536
    ds_read_b64 v[64:65], v5 offset:1792
    ds_read_b64_tr_b16 v[68:69], v11 offset:15472
    ds_read_b64_tr_b16 v[70:71], v11 offset:16240
    ds_read_b32 v164, v7 offset:1024
    s_waitcnt lgkmcnt(10)
    v_mfma_f32_32x32x16_bf16 v[104:119], v[80:83], v[32:35], v[104:119]
    ds_read_b64_tr_b16 v[72:73], v11 offset:18544
    ds_read_b64_tr_b16 v[74:75], v11 offset:19312
    s_waitcnt lgkmcnt(10)
    v_mfma_f32_32x32x16_bf16 v[104:119], v[84:87], v[36:39], v[104:119]
    ds_read_b64_tr_b16 v[76:77], v11 offset:21616
    ds_read_b64_tr_b16 v[78:79], v11 offset:22384
    s_waitcnt lgkmcnt(10)
    v_mfma_f32_32x32x16_bf16 v[120:135], v[56:59], v[24:27], v[120:135]
    ds_read_b64 v[80:81], v5 offset:2048
    s_waitcnt lgkmcnt(9)
    v_mfma_f32_32x32x16_bf16 v[88:103], v[60:63], v[160:163], v[88:103]
    s_waitcnt lgkmcnt(8)
    v_mfma_f32_32x32x16_bf16 v[104:119], v[64:67], v[160:163], v[104:119]
    s_waitcnt lgkmcnt(0)
    v_mul_f32 v165, s52, v164
    v_mul_f32 v166, s53, v164
    v_mul_f32 v167, s54, v164
    s_waitcnt lgkmcnt(6)
    v_mfma_f32_32x32x16_bf16 v[120:135], v[68:71], v[28:31], v[120:135]
    v_mul_f32 v88, v165, v88
    v_mul_f32 v89, v165, v89
    v_mul_f32 v90, v165, v90
    v_mul_f32 v91, v165, v91
    v_mul_f32 v92, v165, v92
    s_waitcnt lgkmcnt(3)
    v_mfma_f32_32x32x16_bf16 v[120:135], v[72:75], v[32:35], v[120:135]
    v_mul_f32 v93, v165, v93
    v_mul_f32 v94, v165, v94
    v_mul_f32 v95, v165, v95
    v_mul_f32 v96, v165, v96
    v_mul_f32 v97, v165, v97
    s_waitcnt lgkmcnt(1)
    v_mfma_f32_32x32x16_bf16 v[120:135], v[76:79], v[36:39], v[120:135]
    v_mul_f32 v98, v165, v98
    v_mul_f32 v99, v165, v99
    v_mul_f32 v100, v165, v100
    v_mul_f32 v101, v165, v101
    v_mul_f32 v102, v165, v102
    s_waitcnt lgkmcnt(0)
    v_mfma_f32_32x32x16_bf16 v[120:135], v[80:83], v[160:163], v[120:135]
    v_mul_f32 v103, v165, v103
    v_cvt_pk_bf16_f32 v136, v88, v89
    v_cvt_pk_bf16_f32 v137, v90, v91
    v_cvt_pk_bf16_f32 v138, v92, v93
    v_cvt_pk_bf16_f32 v139, v94, v95
    buffer_store_dwordx4 v[136:139], v12, s[16:19], s42 offen sc1
    v_cvt_pk_bf16_f32 v140, v96, v97
    v_cvt_pk_bf16_f32 v141, v98, v99
    s_mov_b32 exec_hi, 0
    v_cvt_pk_bf16_f32 v142, v100, v101
    v_cvt_pk_bf16_f32 v143, v102, v103
    s_mov_b32 exec_hi, -1
    buffer_store_dwordx4 v[140:143], v12, s[16:19], s42 offen offset:1024 sc1
    v_mul_f32 v104, v166, v104
    v_mul_f32 v105, v166, v105
    v_mul_f32 v106, v166, v106
    v_mul_f32 v107, v166, v107
    v_mul_f32 v108, v166, v108
    v_mul_f32 v109, v166, v109
    v_mul_f32 v110, v166, v110
    v_mul_f32 v111, v166, v111
    v_mul_f32 v112, v166, v112
    v_mul_f32 v113, v166, v113
    v_mul_f32 v114, v166, v114
    v_mul_f32 v115, v166, v115
    v_mul_f32 v116, v166, v116
    v_mul_f32 v117, v166, v117
    v_mul_f32 v118, v166, v118
    v_mul_f32 v119, v166, v119
    v_cvt_pk_bf16_f32 v144, v104, v105
    v_cvt_pk_bf16_f32 v145, v106, v107
    v_cvt_pk_bf16_f32 v146, v108, v109
    v_cvt_pk_bf16_f32 v147, v110, v111
    buffer_store_dwordx4 v[144:147], v12, s[16:19], s43 offen sc1
    v_cvt_pk_bf16_f32 v148, v112, v113
    v_cvt_pk_bf16_f32 v149, v114, v115
    s_mov_b32 exec_hi, 0
    v_cvt_pk_bf16_f32 v150, v116, v117
    v_cvt_pk_bf16_f32 v151, v118, v119
    s_mov_b32 exec_hi, -1
    buffer_store_dwordx4 v[148:151], v12, s[16:19], s43 offen offset:1024 sc1
    v_mul_f32 v120, v167, v120
    v_mul_f32 v121, v167, v121
    v_mul_f32 v122, v167, v122
    v_mul_f32 v123, v167, v123
    v_mul_f32 v124, v167, v124
    v_mul_f32 v125, v167, v125
    v_mul_f32 v126, v167, v126
    v_mul_f32 v127, v167, v127
    v_mul_f32 v128, v167, v128
    v_mul_f32 v129, v167, v129
    v_mul_f32 v130, v167, v130
    v_mul_f32 v131, v167, v131
    v_mul_f32 v132, v167, v132
    v_mul_f32 v133, v167, v133
    v_mul_f32 v134, v167, v134
    v_mul_f32 v135, v167, v135
    v_cvt_pk_bf16_f32 v152, v120, v121
    v_cvt_pk_bf16_f32 v153, v122, v123
    v_cvt_pk_bf16_f32 v154, v124, v125
    v_cvt_pk_bf16_f32 v155, v126, v127
    buffer_store_dwordx4 v[152:155], v12, s[16:19], s44 offen sc1
    v_cvt_pk_bf16_f32 v156, v128, v129
    v_cvt_pk_bf16_f32 v157, v130, v131
    s_mov_b32 exec_hi, 0
    v_cvt_pk_bf16_f32 v158, v132, v133
    v_cvt_pk_bf16_f32 v159, v134, v135
    s_mov_b32 exec_hi, -1
    buffer_store_dwordx4 v[156:159], v12, s[16:19], s44 offen offset:1024 sc1
    s_endpgm
L_k1_m1:
    v_mov_b32 v142, s56
    v_mov_b32 v143, 0
    v_mov_b32 v150, s57
    v_mov_b32 v151, 0
    v_cndmask_b32 v152, 0, v165, vcc
    v_cndmask_b32 v153, 0, v165, vcc
    v_cndmask_b32 v154, 0, v165, vcc
    v_cndmask_b32 v155, 0, v165, vcc
    v_cndmask_b32 v156, 0, v165, vcc
    v_cndmask_b32 v157, 0, v165, vcc
    v_cndmask_b32 v158, 0, v165, vcc
    v_cndmask_b32 v159, 0, v165, vcc
    s_barrier
    ds_read_b128 v[24:27], v16 offset:0
    ds_read_b64_tr_b16 v[56:57], v11 offset:0
    ds_read_b64_tr_b16 v[58:59], v11 offset:768
    ds_read_b64_tr_b16 v[60:61], v11 offset:56
    ds_read_b64_tr_b16 v[62:63], v11 offset:824
    ds_read_b64_tr_b16 v[64:65], v11 offset:112
    ds_read_b64_tr_b16 v[66:67], v11 offset:880
    ds_read_b128 v[28:31], v17 offset:0
    ds_read_b64_tr_b16 v[68:69], v11 offset:3072
    ds_read_b64_tr_b16 v[70:71], v11 offset:3840
    ds_read_b64_tr_b16 v[72:73], v11 offset:3128
    ds_read_b64_tr_b16 v[74:75], v11 offset:3896
    ds_read_b64_tr_b16 v[76:77], v11 offset:3184
    ds_read_b64_tr_b16 v[78:79], v11 offset:3952
    s_waitcnt lgkmcnt(11)
    v_mfma_f32_32x32x16_bf16 v[88:103], v[56:59], v[24:27], 0
    ds_read_b128 v[32:35], v18 offset:0
    ds_read_b64_tr_b16 v[80:81], v11 offset:6144
    ds_read_b64_tr_b16 v[82:83], v11 offset:6912
    s_waitcnt lgkmcnt(12)
    v_mfma_f32_32x32x16_bf16 v[104:119], v[60:63], v[24:27], 0
    ds_read_b64_tr_b16 v[84:85], v11 offset:6200
    ds_read_b64_tr_b16 v[86:87], v11 offset:6968
    s_waitcnt lgkmcnt(12)
    v_mfma_f32_32x32x16_bf16 v[120:135], v[24:27], v[64:67], 0
    ds_read_b64_tr_b16 v[56:57], v11 offset:6256
    ds_read_b64_tr_b16 v[58:59], v11 offset:7024
    s_waitcnt lgkmcnt(11)
    v_mfma_f32_32x32x16_bf16 v[88:103], v[68:71], v[28:31], v[88:103]
    ds_read_b128 v[36:39], v19 offset:0
    ds_read_b64_tr_b16 v[60:61], v11 offset:9216
    ds_read_b64_tr_b16 v[62:63], v11 offset:9984
    s_waitcnt lgkmcnt(12)
    v_mfma_f32_32x32x16_bf16 v[104:119], v[72:75], v[28:31], v[104:119]
    ds_read_b64_tr_b16 v[64:65], v11 offset:9272
    ds_read_b64_tr_b16 v[66:67], v11 offset:10040
    s_waitcnt lgkmcnt(12)
    v_mfma_f32_32x32x16_bf16 v[120:135], v[28:31], v[76:79], v[120:135]
    ds_read_b64_tr_b16 v[68:69], v11 offset:9328
    ds_read_b64_tr_b16 v[70:71], v11 offset:10096
    s_waitcnt lgkmcnt(11)
    v_mfma_f32_32x32x16_bf16 v[88:103], v[80:83], v[32:35], v[88:103]
    s_barrier
    ds_read_b128 v[40:43], v16 offset:16384
    ds_read_b64_tr_b16 v[72:73], v11 offset:12288
    ds_read_b64_tr_b16 v[74:75], v11 offset:13056
    s_waitcnt lgkmcnt(12)
    v_mfma_f32_32x32x16_bf16 v[104:119], v[84:87], v[32:35], v[104:119]
    ds_read_b64_tr_b16 v[76:77], v11 offset:12344
    ds_read_b64_tr_b16 v[78:79], v11 offset:13112
    s_waitcnt lgkmcnt(12)
    v_mfma_f32_32x32x16_bf16 v[120:135], v[32:35], v[56:59], v[120:135]
    ds_read_b64_tr_b16 v[80:81], v11 offset:12400
    ds_read_b64_tr_b16 v[82:83], v11 offset:13168
    s_waitcnt lgkmcnt(11)
    v_mfma_f32_32x32x16_bf16 v[88:103], v[60:63], v[36:39], v[88:103]
    ds_read_b128 v[44:47], v17 offset:16384
    ds_read_b64_tr_b16 v[84:85], v11 offset:15360
    ds_read_b64_tr_b16 v[86:87], v11 offset:16128
    s_waitcnt lgkmcnt(12)
    v_mfma_f32_32x32x16_bf16 v[104:119], v[64:67], v[36:39], v[104:119]
    ds_read_b64_tr_b16 v[56:57], v11 offset:15416
    ds_read_b64_tr_b16 v[58:59], v11 offset:16184
    s_waitcnt lgkmcnt(12)
    v_mfma_f32_32x32x16_bf16 v[120:135], v[36:39], v[68:71], v[120:135]
    ds_read_b64_tr_b16 v[60:61], v11 offset:15472
    ds_read_b64_tr_b16 v[62:63], v11 offset:16240
    s_waitcnt lgkmcnt(11)
    v_mfma_f32_32x32x16_bf16 v[88:103], v[72:75], v[40:43], v[88:103]
    ds_read_b128 v[48:51], v18 offset:16384
    ds_read_b64_tr_b16 v[64:65], v11 offset:18432
    ds_read_b64_tr_b16 v[66:67], v11 offset:19200
    s_waitcnt lgkmcnt(12)
    v_mfma_f32_32x32x16_bf16 v[104:119], v[76:79], v[40:43], v[104:119]
    ds_read_b64_tr_b16 v[68:69], v11 offset:18488
    ds_read_b64_tr_b16 v[70:71], v11 offset:19256
    s_waitcnt lgkmcnt(12)
    v_mfma_f32_32x32x16_bf16 v[120:135], v[40:43], v[80:83], v[120:135]
    ds_read_b64_tr_b16 v[72:73], v11 offset:18544
    ds_read_b64_tr_b16 v[74:75], v11 offset:19312
    s_waitcnt lgkmcnt(11)
    v_mfma_f32_32x32x16_bf16 v[88:103], v[84:87], v[44:47], v[88:103]
    ds_read_b128 v[52:55], v19 offset:16384
    ds_read_b64_tr_b16 v[76:77], v11 offset:21504
    ds_read_b64_tr_b16 v[78:79], v11 offset:22272
    s_waitcnt lgkmcnt(12)
    v_mfma_f32_32x32x16_bf16 v[104:119], v[56:59], v[44:47], v[104:119]
    ds_read_b64_tr_b16 v[80:81], v11 offset:21560
    ds_read_b64_tr_b16 v[82:83], v11 offset:22328
    s_waitcnt lgkmcnt(12)
    v_mfma_f32_32x32x16_bf16 v[120:135], v[44:47], v[60:63], v[120:135]
    ds_read_b64_tr_b16 v[84:85], v11 offset:21616
    ds_read_b64_tr_b16 v[86:87], v11 offset:22384
    s_waitcnt lgkmcnt(11)
    v_mfma_f32_32x32x16_bf16 v[88:103], v[64:67], v[48:51], v[88:103]
    s_barrier
    ds_read_b128 v[24:27], v16 offset:32768
    ds_read_b64_tr_b16 v[56:57], v11 offset:24576
    ds_read_b64_tr_b16 v[58:59], v11 offset:25344
    s_waitcnt lgkmcnt(12)
    v_mfma_f32_32x32x16_bf16 v[104:119], v[68:71], v[48:51], v[104:119]
    ds_read_b64_tr_b16 v[60:61], v11 offset:24632
    ds_read_b64_tr_b16 v[62:63], v11 offset:25400
    s_waitcnt lgkmcnt(12)
    v_mfma_f32_32x32x16_bf16 v[120:135], v[48:51], v[72:75], v[120:135]
    ds_read_b64_tr_b16 v[64:65], v11 offset:24688
    ds_read_b64_tr_b16 v[66:67], v11 offset:25456
    s_waitcnt lgkmcnt(11)
    v_mfma_f32_32x32x16_bf16 v[88:103], v[76:79], v[52:55], v[88:103]
    ds_read_b128 v[28:31], v17 offset:32768
    ds_read_b64_tr_b16 v[68:69], v11 offset:27648
    ds_read_b64_tr_b16 v[70:71], v11 offset:28416
    s_waitcnt lgkmcnt(12)
    v_mfma_f32_32x32x16_bf16 v[104:119], v[80:83], v[52:55], v[104:119]
    ds_read_b64_tr_b16 v[72:73], v11 offset:27704
    ds_read_b64_tr_b16 v[74:75], v11 offset:28472
    s_waitcnt lgkmcnt(12)
    v_mfma_f32_32x32x16_bf16 v[120:135], v[52:55], v[84:87], v[120:135]
    ds_read_b64_tr_b16 v[76:77], v11 offset:27760
    ds_read_b64_tr_b16 v[78:79], v11 offset:28528
    s_waitcnt lgkmcnt(11)
    v_mfma_f32_32x32x16_bf16 v[88:103], v[56:59], v[24:27], v[88:103]
    ds_read_b128 v[32:35], v18 offset:32768
    ds_read_b64_tr_b16 v[80:81], v11 offset:30720
    ds_read_b64_tr_b16 v[82:83], v11 offset:31488
    s_waitcnt lgkmcnt(12)
    v_mfma_f32_32x32x16_bf16 v[104:119], v[60:63], v[24:27], v[104:119]
    ds_read_b64_tr_b16 v[84:85], v11 offset:30776
    ds_read_b64_tr_b16 v[86:87], v11 offset:31544
    s_waitcnt lgkmcnt(12)
    v_mfma_f32_32x32x16_bf16 v[120:135], v[24:27], v[64:67], v[120:135]
    ds_read_b64_tr_b16 v[56:57], v11 offset:30832
    ds_read_b64_tr_b16 v[58:59], v11 offset:31600
    s_waitcnt lgkmcnt(11)
    v_mfma_f32_32x32x16_bf16 v[88:103], v[68:71], v[28:31], v[88:103]
    ds_read_b128 v[36:39], v19 offset:32768
    ds_read_b64_tr_b16 v[60:61], v11 offset:33792
    ds_read_b64_tr_b16 v[62:63], v11 offset:34560
    s_waitcnt lgkmcnt(12)
    v_mfma_f32_32x32x16_bf16 v[104:119], v[72:75], v[28:31], v[104:119]
    ds_read_b64_tr_b16 v[64:65], v11 offset:33848
    ds_read_b64_tr_b16 v[66:67], v11 offset:34616
    s_waitcnt lgkmcnt(12)
    v_mfma_f32_32x32x16_bf16 v[120:135], v[28:31], v[76:79], v[120:135]
    ds_read_b64_tr_b16 v[68:69], v11 offset:33904
    ds_read_b64_tr_b16 v[70:71], v11 offset:34672
    s_waitcnt lgkmcnt(11)
    v_mfma_f32_32x32x16_bf16 v[88:103], v[80:83], v[32:35], v[88:103]
    s_barrier
    ds_read_b128 v[40:43], v20 offset:0
    ds_read_b64_tr_b16 v[72:73], v11 offset:36864
    ds_read_b64_tr_b16 v[74:75], v11 offset:37632
    s_waitcnt lgkmcnt(12)
    v_mfma_f32_32x32x16_bf16 v[104:119], v[84:87], v[32:35], v[104:119]
    ds_read_b64_tr_b16 v[76:77], v11 offset:36920
    ds_read_b64_tr_b16 v[78:79], v11 offset:37688
    s_waitcnt lgkmcnt(12)
    v_mfma_f32_32x32x16_bf16 v[120:135], v[32:35], v[56:59], v[120:135]
    ds_read_b64_tr_b16 v[80:81], v11 offset:36976
    ds_read_b64_tr_b16 v[82:83], v11 offset:37744
    s_waitcnt lgkmcnt(11)
    v_mfma_f32_32x32x16_bf16 v[88:103], v[60:63], v[36:39], v[88:103]
    ds_read_b128 v[44:47], v21 offset:0
    ds_read_b64_tr_b16 v[84:85], v11 offset:39936
    ds_read_b64_tr_b16 v[86:87], v11 offset:40704
    s_waitcnt lgkmcnt(12)
    v_mfma_f32_32x32x16_bf16 v[104:119], v[64:67], v[36:39], v[104:119]
    ds_read_b64_tr_b16 v[56:57], v11 offset:39992
    ds_read_b64_tr_b16 v[58:59], v11 offset:40760
    s_waitcnt lgkmcnt(12)
    v_mfma_f32_32x32x16_bf16 v[120:135], v[36:39], v[68:71], v[120:135]
    ds_read_b64_tr_b16 v[60:61], v11 offset:40048
    ds_read_b64_tr_b16 v[62:63], v11 offset:40816
    s_waitcnt lgkmcnt(11)
    v_mfma_f32_32x32x16_bf16 v[88:103], v[72:75], v[40:43], v[88:103]
    ds_read_b128 v[48:51], v22 offset:0
    ds_read_b64_tr_b16 v[64:65], v11 offset:43008
    ds_read_b64_tr_b16 v[66:67], v11 offset:43776
    s_waitcnt lgkmcnt(12)
    v_mfma_f32_32x32x16_bf16 v[104:119], v[76:79], v[40:43], v[104:119]
    ds_read_b64_tr_b16 v[68:69], v11 offset:43064
    ds_read_b64_tr_b16 v[70:71], v11 offset:43832
    s_waitcnt lgkmcnt(12)
    v_mfma_f32_32x32x16_bf16 v[120:135], v[40:43], v[80:83], v[120:135]
    ds_read_b64_tr_b16 v[72:73], v11 offset:43120
    ds_read_b64_tr_b16 v[74:75], v11 offset:43888
    s_waitcnt lgkmcnt(11)
    v_mfma_f32_32x32x16_bf16 v[88:103], v[84:87], v[44:47], v[88:103]
    ds_read_b128 v[52:55], v23 offset:0
    ds_read_b64_tr_b16 v[76:77], v11 offset:46080
    ds_read_b64_tr_b16 v[78:79], v11 offset:46848
    s_waitcnt lgkmcnt(12)
    v_mfma_f32_32x32x16_bf16 v[104:119], v[56:59], v[44:47], v[104:119]
    ds_read_b64_tr_b16 v[80:81], v11 offset:46136
    ds_read_b64_tr_b16 v[82:83], v11 offset:46904
    s_waitcnt lgkmcnt(12)
    v_mfma_f32_32x32x16_bf16 v[120:135], v[44:47], v[60:63], v[120:135]
    ds_read_b64_tr_b16 v[84:85], v11 offset:46192
    ds_read_b64_tr_b16 v[86:87], v11 offset:46960
    s_waitcnt lgkmcnt(11)
    v_mfma_f32_32x32x16_bf16 v[88:103], v[64:67], v[48:51], v[88:103]
    s_barrier
    ds_read_b128 v[24:27], v20 offset:16384
    ds_read_b64_tr_b16 v[56:57], v11 offset:49152
    ds_read_b64_tr_b16 v[58:59], v11 offset:49920
    s_waitcnt lgkmcnt(12)
    v_mfma_f32_32x32x16_bf16 v[104:119], v[68:71], v[48:51], v[104:119]
    ds_read_b64_tr_b16 v[60:61], v11 offset:49208
    ds_read_b64_tr_b16 v[62:63], v11 offset:49976
    s_waitcnt lgkmcnt(12)
    v_mfma_f32_32x32x16_bf16 v[120:135], v[48:51], v[72:75], v[120:135]
    ds_read_b64_tr_b16 v[64:65], v11 offset:49264
    ds_read_b64_tr_b16 v[66:67], v11 offset:50032
    s_waitcnt lgkmcnt(11)
    v_mfma_f32_32x32x16_bf16 v[88:103], v[76:79], v[52:55], v[88:103]
    ds_read_b128 v[28:31], v21 offset:16384
    ds_read_b64_tr_b16 v[68:69], v11 offset:52224
    ds_read_b64_tr_b16 v[70:71], v11 offset:52992
    s_waitcnt lgkmcnt(12)
    v_mfma_f32_32x32x16_bf16 v[104:119], v[80:83], v[52:55], v[104:119]
    ds_read_b64_tr_b16 v[72:73], v11 offset:52280
    ds_read_b64_tr_b16 v[74:75], v11 offset:53048
    s_waitcnt lgkmcnt(12)
    v_mfma_f32_32x32x16_bf16 v[120:135], v[52:55], v[84:87], v[120:135]
    ds_read_b64_tr_b16 v[76:77], v11 offset:52336
    ds_read_b64_tr_b16 v[78:79], v11 offset:53104
    s_waitcnt lgkmcnt(11)
    v_mfma_f32_32x32x16_bf16 v[88:103], v[56:59], v[24:27], v[88:103]
    ds_read_b128 v[32:35], v22 offset:16384
    ds_read_b64_tr_b16 v[80:81], v11 offset:55296
    ds_read_b64_tr_b16 v[82:83], v11 offset:56064
    s_waitcnt lgkmcnt(12)
    v_mfma_f32_32x32x16_bf16 v[104:119], v[60:63], v[24:27], v[104:119]
    ds_read_b64_tr_b16 v[84:85], v11 offset:55352
    ds_read_b64_tr_b16 v[86:87], v11 offset:56120
    s_waitcnt lgkmcnt(12)
    v_mfma_f32_32x32x16_bf16 v[120:135], v[24:27], v[64:67], v[120:135]
    ds_read_b64_tr_b16 v[56:57], v11 offset:55408
    ds_read_b64_tr_b16 v[58:59], v11 offset:56176
    s_waitcnt lgkmcnt(11)
    v_mfma_f32_32x32x16_bf16 v[88:103], v[68:71], v[28:31], v[88:103]
    ds_read_b128 v[36:39], v23 offset:16384
    ds_read_b64_tr_b16 v[60:61], v11 offset:58368
    ds_read_b64_tr_b16 v[62:63], v11 offset:59136
    s_waitcnt lgkmcnt(12)
    v_mfma_f32_32x32x16_bf16 v[104:119], v[72:75], v[28:31], v[104:119]
    ds_read_b64_tr_b16 v[64:65], v11 offset:58424
    ds_read_b64_tr_b16 v[66:67], v11 offset:59192
    s_waitcnt lgkmcnt(12)
    v_mfma_f32_32x32x16_bf16 v[120:135], v[28:31], v[76:79], v[120:135]
    ds_read_b64_tr_b16 v[68:69], v11 offset:58480
    ds_read_b64_tr_b16 v[70:71], v11 offset:59248
    s_waitcnt lgkmcnt(11)
    v_mfma_f32_32x32x16_bf16 v[88:103], v[80:83], v[32:35], v[88:103]
    s_barrier
    ds_read_b128 v[40:43], v20 offset:32768
    ds_read_b64_tr_b16 v[72:73], v11 offset:0
    ds_read_b64_tr_b16 v[74:75], v11 offset:768
    s_waitcnt lgkmcnt(12)
    v_mfma_f32_32x32x16_bf16 v[104:119], v[84:87], v[32:35], v[104:119]
    ds_read_b64_tr_b16 v[76:77], v11 offset:56
    ds_read_b64_tr_b16 v[78:79], v11 offset:824
    s_waitcnt lgkmcnt(12)
    v_mfma_f32_32x32x16_bf16 v[120:135], v[32:35], v[56:59], v[120:135]
    ds_read_b64_tr_b16 v[80:81], v11 offset:112
    ds_read_b64_tr_b16 v[82:83], v11 offset:880
    s_waitcnt lgkmcnt(11)
    v_mfma_f32_32x32x16_bf16 v[88:103], v[60:63], v[36:39], v[88:103]
    ds_read_b128 v[44:47], v21 offset:32768
    ds_read_b64_tr_b16 v[84:85], v11 offset:3072
    ds_read_b64_tr_b16 v[86:87], v11 offset:3840
    s_waitcnt lgkmcnt(12)
    v_mfma_f32_32x32x16_bf16 v[104:119], v[64:67], v[36:39], v[104:119]
    ds_read_b64_tr_b16 v[56:57], v11 offset:3128
    ds_read_b64_tr_b16 v[58:59], v11 offset:3896
    s_waitcnt lgkmcnt(12)
    v_mfma_f32_32x32x16_bf16 v[120:135], v[36:39], v[68:71], v[120:135]
    ds_read_b64_tr_b16 v[60:61], v11 offset:3184
    ds_read_b64_tr_b16 v[62:63], v11 offset:3952
    s_waitcnt lgkmcnt(11)
    v_mfma_f32_32x32x16_bf16 v[88:103], v[72:75], v[40:43], v[88:103]
    ds_read_b128 v[48:51], v22 offset:32768
    ds_read_b64_tr_b16 v[64:65], v11 offset:6144
    ds_read_b64_tr_b16 v[66:67], v11 offset:6912
    s_waitcnt lgkmcnt(12)
    v_mfma_f32_32x32x16_bf16 v[104:119], v[76:79], v[40:43], v[104:119]
    ds_read_b64_tr_b16 v[68:69], v11 offset:6200
    ds_read_b64_tr_b16 v[70:71], v11 offset:6968
    s_waitcnt lgkmcnt(12)
    v_mfma_f32_32x32x16_bf16 v[120:135], v[40:43], v[80:83], v[120:135]
    ds_read_b64_tr_b16 v[72:73], v11 offset:6256
    ds_read_b64_tr_b16 v[74:75], v11 offset:7024
    s_waitcnt lgkmcnt(11)
    v_mfma_f32_32x32x16_bf16 v[88:103], v[84:87], v[44:47], v[88:103]
    ds_read_b128 v[52:55], v23 offset:32768
    ds_read_b64_tr_b16 v[76:77], v11 offset:9216
    ds_read_b64_tr_b16 v[78:79], v11 offset:9984
    s_waitcnt lgkmcnt(12)
    v_mfma_f32_32x32x16_bf16 v[104:119], v[56:59], v[44:47], v[104:119]
    ds_read_b64_tr_b16 v[80:81], v11 offset:9272
    ds_read_b64_tr_b16 v[82:83], v11 offset:10040
    s_waitcnt lgkmcnt(12)
    v_mfma_f32_32x32x16_bf16 v[120:135], v[44:47], v[60:63], v[120:135]
    ds_read_b64_tr_b16 v[84:85], v11 offset:9328
    ds_read_b64_tr_b16 v[86:87], v11 offset:10096
    s_waitcnt lgkmcnt(11)
    v_mfma_f32_32x32x16_bf16 v[88:103], v[64:67], v[48:51], v[88:103]
    s_barrier
    ds_read_b128 v[24:27], v16 offset:0
    ds_read_b64_tr_b16 v[56:57], v11 offset:12288
    ds_read_b64_tr_b16 v[58:59], v11 offset:13056
    s_waitcnt lgkmcnt(12)
    v_mfma_f32_32x32x16_bf16 v[104:119], v[68:71], v[48:51], v[104:119]
    ds_read_b128 v[28:31], v17 offset:0
    ds_read_b64_tr_b16 v[60:61], v11 offset:15360
    ds_read_b64_tr_b16 v[62:63], v11 offset:16128
    s_waitcnt lgkmcnt(13)
    v_mfma_f32_32x32x16_bf16 v[120:135], v[48:51], v[72:75], v[120:135]
    ds_read_b128 v[32:35], v18 offset:0
    ds_read_b64_tr_b16 v[64:65], v11 offset:18432
    ds_read_b64_tr_b16 v[66:67], v11 offset:19200
    s_waitcnt lgkmcnt(13)
    v_mfma_f32_32x32x16_bf16 v[88:103], v[76:79], v[52:55], v[88:103]
    ds_read_b128 v[36:39], v19 offset:0
    ds_read_b64_tr_b16 v[68:69], v11 offset:21504
    ds_read_b64_tr_b16 v[70:71], v11 offset:22272
    s_waitcnt lgkmcnt(14)
    v_mfma_f32_32x32x16_bf16 v[104:119], v[80:83], v[52:55], v[104:119]
    ds_read_b64_tr_b16 v[72:73], v11 offset:12344
    ds_read_b64_tr_b16 v[74:75], v11 offset:13112
    s_waitcnt lgkmcnt(14)
    v_mfma_f32_32x32x16_bf16 v[120:135], v[52:55], v[84:87], v[120:135]
    ds_read_b64_tr_b16 v[76:77], v11 offset:15416
    ds_read_b64_tr_b16 v[78:79], v11 offset:16184
    s_waitcnt lgkmcnt(13)
    v_mfma_f32_32x32x16_bf16 v[88:103], v[56:59], v[24:27], v[88:103]
    ds_read_b64_tr_b16 v[80:81], v11 offset:18488
    ds_read_b64_tr_b16 v[82:83], v11 offset:19256
    s_waitcnt lgkmcnt(12)
    v_mfma_f32_32x32x16_bf16 v[88:103], v[60:63], v[28:31], v[88:103]
    ds_read_b64_tr_b16 v[84:85], v11 offset:21560
    ds_read_b64_tr_b16 v[86:87], v11 offset:22328
    s_waitcnt lgkmcnt(11)
    v_mfma_f32_32x32x16_bf16 v[88:103], v[64:67], v[32:35], v[88:103]
    ds_read_b64_tr_b16 v[56:57], v11 offset:12400
    ds_read_b64_tr_b16 v[58:59], v11 offset:13168
    s_waitcnt lgkmcnt(10)
    v_mfma_f32_32x32x16_bf16 v[88:103], v[68:71], v[36:39], v[88:103]
    s_waitcnt lgkmcnt(8)
    v_mfma_f32_32x32x16_bf16 v[104:119], v[72:75], v[24:27], v[104:119]
    s_waitcnt lgkmcnt(6)
    v_mfma_f32_32x32x16_bf16 v[104:119], v[76:79], v[28:31], v[104:119]
    s_barrier
    s_mov_b32 exec_hi, 0
    ds_read_b64 v[160:161], v9 offset:0
    s_mov_b32 exec_hi, -1
    ds_read_b64 v[60:61], v5 offset:1536
    ds_read_b64 v[64:65], v5 offset:1792
    ds_read_b64_tr_b16 v[68:69], v11 offset:15472
    ds_read_b64_tr_b16 v[70:71], v11 offset:16240
    ds_read_b32 v164, v7 offset:1024
    s_waitcnt lgkmcnt(10)
    v_mfma_f32_32x32x16_bf16 v[104:119], v[80:83], v[32:35], v[104:119]
    ds_read_b64_tr_b16 v[72:73], v11 offset:18544
    ds_read_b64_tr_b16 v[74:75], v11 offset:19312
    ds_read_b128 v[40:43], v8 offset:1024
    ds_read_b128 v[44:47], v8 offset:1056
    ds_read_b128 v[48:51], v8 offset:1088
    ds_read_b128 v[52:55], v8 offset:1120
    s_waitcnt lgkmcnt(14)
    v_mfma_f32_32x32x16_bf16 v[104:119], v[84:87], v[36:39], v[104:119]
    ds_read_b64_tr_b16 v[76:77], v11 offset:21616
    ds_read_b64_tr_b16 v[78:79], v11 offset:22384
    s_waitcnt lgkmcnt(14)
    v_mfma_f32_32x32x16_bf16 v[120:135], v[24:27], v[56:59], v[120:135]
    ds_read_b64 v[80:81], v5 offset:2048
    s_waitcnt lgkmcnt(13)
    v_mfma_f32_32x32x16_bf16 v[88:103], v[60:63], v[160:163], v[88:103]
    s_waitcnt lgkmcnt(12)
    v_mfma_f32_32x32x16_bf16 v[104:119], v[64:67], v[160:163], v[104:119]
    s_waitcnt lgkmcnt(0)
    v_mul_f32 v165, s52, v164
    v_mul_f32 v166, s53, v164
    s_waitcnt lgkmcnt(10)
    v_mfma_f32_32x32x16_bf16 v[120:135], v[28:31], v[68:71], v[120:135]
    v_mul_f32 v88, v165, v88
    v_mul_f32 v89, v165, v89
    v_mul_f32 v90, v165, v90
    v_mul_f32 v91, v165, v91
    v_mul_f32 v92, v165, v92
    s_waitcnt lgkmcnt(7)
    v_mfma_f32_32x32x16_bf16 v[120:135], v[32:35], v[72:75], v[120:135]
    v_mul_f32 v93, v165, v93
    v_mul_f32 v94, v165, v94
    v_mul_f32 v95, v165, v95
    v_mul_f32 v96, v165, v96
    v_mul_f32 v97, v165, v97
    s_waitcnt lgkmcnt(1)
    v_mfma_f32_32x32x16_bf16 v[120:135], v[36:39], v[76:79], v[120:135]
    v_mul_f32 v98, v165, v98
    v_mul_f32 v99, v165, v99
    v_mul_f32 v100, v165, v100
    v_mul_f32 v101, v165, v101
    v_mul_f32 v102, v165, v102
    s_waitcnt lgkmcnt(0)
    v_mfma_f32_32x32x16_bf16 v[120:135], v[160:163], v[80:83], v[120:135]
    v_mul_f32 v103, v165, v103
    v_cvt_pk_bf16_f32 v136, v88, v89
    v_cvt_pk_bf16_f32 v137, v90, v91
    v_cvt_pk_bf16_f32 v138, v92, v93
    v_cvt_pk_bf16_f32 v139, v94, v95
    buffer_store_dwordx4 v[136:139], v12, s[16:19], s42 offen sc1
    v_cvt_pk_bf16_f32 v140, v96, v97
    v_cvt_pk_bf16_f32 v141, v98, v99
    s_mov_b32 exec_hi, 0
    v_cvt_pk_bf16_f32 v142, v100, v101
    v_cvt_pk_bf16_f32 v143, v102, v103
    s_mov_b32 exec_hi, -1
    buffer_store_dwordx4 v[140:143], v12, s[16:19], s42 offen offset:1024 sc1
    v_mul_f32 v104, v166, v104
    v_mul_f32 v105, v166, v105
    v_mul_f32 v106, v166, v106
    v_mul_f32 v107, v166, v107
    v_mul_f32 v108, v166, v108
    v_mul_f32 v109, v166, v109
    v_mul_f32 v110, v166, v110
    v_mul_f32 v111, v166, v111
    v_mul_f32 v112, v166, v112
    v_mul_f32 v113, v166, v113
    v_mul_f32 v114, v166, v114
    v_mul_f32 v115, v166, v115
    v_mul_f32 v116, v166, v116
    v_mul_f32 v117, v166, v117
    v_mul_f32 v118, v166, v118
    v_mul_f32 v119, v166, v119
    v_cvt_pk_bf16_f32 v144, v104, v105
    v_cvt_pk_bf16_f32 v145, v106, v107
    v_cvt_pk_bf16_f32 v146, v108, v109
    v_cvt_pk_bf16_f32 v147, v110, v111
    buffer_store_dwordx4 v[144:147], v12, s[16:19], s43 offen sc1
    v_cvt_pk_bf16_f32 v148, v112, v113
    v_cvt_pk_bf16_f32 v149, v114, v115
    s_mov_b32 exec_hi, 0
    v_cvt_pk_bf16_f32 v150, v116, v117
    v_cvt_pk_bf16_f32 v151, v118, v119
    s_mov_b32 exec_hi, -1
    buffer_store_dwordx4 v[148:151], v12, s[16:19], s43 offen offset:1024 sc1
    v_mul_f32 v120, v40, v120
    v_mul_f32 v121, v41, v121
    v_mul_f32 v122, v42, v122
    v_mul_f32 v123, v43, v123
    v_mul_f32 v124, v44, v124
    v_mul_f32 v125, v45, v125
    v_mul_f32 v126, v46, v126
    v_mul_f32 v127, v47, v127
    v_mul_f32 v128, v48, v128
    v_mul_f32 v129, v49, v129
    v_mul_f32 v130, v50, v130
    v_mul_f32 v131, v51, v131
    v_mul_f32 v132, v52, v132
    v_mul_f32 v133, v53, v133
    v_mul_f32 v134, v54, v134
    v_mul_f32 v135, v55, v135
    s_mov_b32 exec_lo, 0x0fffffff
    s_mov_b32 exec_hi, 0x0fffffff
    v_cvt_pk_bf16_f32 v152, v120, v121
    v_cvt_pk_bf16_f32 v153, v122, v123
    v_cvt_pk_bf16_f32 v154, v124, v125
    v_cvt_pk_bf16_f32 v155, v126, v127
    s_mov_b64 exec, -1
    buffer_store_dwordx4 v[152:155], v12, s[16:19], s44 offen sc1
    s_mov_b32 exec_lo, 0x0fffffff
    s_mov_b32 exec_hi, 0x0fffffff
    v_cvt_pk_bf16_f32 v156, v128, v129
    v_cvt_pk_bf16_f32 v157, v130, v131
    v_cvt_pk_bf16_f32 v158, v132, v133
    v_cvt_pk_bf16_f32 v159, v134, v135
    s_mov_b64 exec, -1
    buffer_store_dwordx4 v[156:159], v12, s[16:19], s44 offen offset:1024 sc1
    s_endpgm
L_k1_m2:
    v_cndmask_b32 v136, 0, v165, vcc
    v_cndmask_b32 v137, 0, v165, vcc
    v_cndmask_b32 v138, 0, v165, vcc
    v_cndmask_b32 v139, 0, v165, vcc
    v_cndmask_b32 v140, 0, v165, vcc
    v_cndmask_b32 v141, 0, v165, vcc
    v_cndmask_b32 v142, 0, v165, vcc
    v_cndmask_b32 v143, 0, v165, vcc
    v_cndmask_b32 v144, 0, v165, vcc
    v_cndmask_b32 v145, 0, v165, vcc
    v_cndmask_b32 v146, 0, v165, vcc
    v_cndmask_b32 v147, 0, v165, vcc
    v_cndmask_b32 v148, 0, v165, vcc
    v_cndmask_b32 v149, 0, v165, vcc
    v_cndmask_b32 v150, 0, v165, vcc
    v_cndmask_b32 v151, 0, v165, vcc
    v_cndmask_b32 v152, 0, v165, vcc
    v_cndmask_b32 v153, 0, v165, vcc
    v_cndmask_b32 v154, 0, v165, vcc
    v_cndmask_b32 v155, 0, v165, vcc
    v_cndmask_b32 v156, 0, v165, vcc
    v_cndmask_b32 v157, 0, v165, vcc
    v_cndmask_b32 v158, 0, v165, vcc
    v_cndmask_b32 v159, 0, v165, vcc
    s_barrier
    ds_read_b128 v[24:27], v16 offset:0
    ds_read_b64_tr_b16 v[56:57], v11 offset:0
    ds_read_b64_tr_b16 v[58:59], v11 offset:768
    ds_read_b64_tr_b16 v[60:61], v11 offset:56
    ds_read_b64_tr_b16 v[62:63], v11 offset:824
    ds_read_b64_tr_b16 v[64:65], v11 offset:112
    ds_read_b64_tr_b16 v[66:67], v11 offset:880
    ds_read_b128 v[28:31], v17 offset:0
    ds_read_b64_tr_b16 v[68:69], v11 offset:3072
    ds_read_b64_tr_b16 v[70:71], v11 offset:3840
    ds_read_b64_tr_b16 v[72:73], v11 offset:3128
    ds_read_b64_tr_b16 v[74:75], v11 offset:3896
    ds_read_b64_tr_b16 v[76:77], v11 offset:3184
    ds_read_b64_tr_b16 v[78:79], v11 offset:3952
    s_waitcnt lgkmcnt(11)
    v_mfma_f32_32x32x16_bf16 v[88:103], v[24:27], v[56:59], 0
    ds_read_b128 v[32:35], v18 offset:0
    ds_read_b64_tr_b16 v[80:81], v11 offset:6144
    ds_read_b64_tr_b16 v[82:83], v11 offset:6912
    s_waitcnt lgkmcnt(12)
    v_mfma_f32_32x32x16_bf16 v[104:119], v[24:27], v[60:63], 0
    ds_read_b64_tr_b16 v[84:85], v11 offset:6200
    ds_read_b64_tr_b16 v[86:87], v11 offset:6968
    s_waitcnt lgkmcnt(12)
    v_mfma_f32_32x32x16_bf16 v[120:135], v[24:27], v[64:67], 0
    ds_read_b64_tr_b16 v[56:57], v11 offset:6256
    ds_read_b64_tr_b16 v[58:59], v11 offset:7024
    s_waitcnt lgkmcnt(11)
    v_mfma_f32_32x32x16_bf16 v[88:103], v[28:31], v[68:71], v[88:103]
    ds_read_b128 v[36:39], v19 offset:0
    ds_read_b64_tr_b16 v[60:61], v11 offset:9216
    ds_read_b64_tr_b16 v[62:63], v11 offset:9984
    s_waitcnt lgkmcnt(12)
    v_mfma_f32_32x32x16_bf16 v[104:119], v[28:31], v[72:75], v[104:119]
    ds_read_b64_tr_b16 v[64:65], v11 offset:9272
    ds_read_b64_tr_b16 v[66:67], v11 offset:10040
    s_waitcnt lgkmcnt(12)
    v_mfma_f32_32x32x16_bf16 v[120:135], v[28:31], v[76:79], v[120:135]
    ds_read_b64_tr_b16 v[68:69], v11 offset:9328
    ds_read_b64_tr_b16 v[70:71], v11 offset:10096
    s_waitcnt lgkmcnt(11)
    v_mfma_f32_32x32x16_bf16 v[88:103], v[32:35], v[80:83], v[88:103]
    s_barrier
    ds_read_b128 v[40:43], v16 offset:16384
    ds_read_b64_tr_b16 v[72:73], v11 offset:12288
    ds_read_b64_tr_b16 v[74:75], v11 offset:13056
    s_waitcnt lgkmcnt(12)
    v_mfma_f32_32x32x16_bf16 v[104:119], v[32:35], v[84:87], v[104:119]
    ds_read_b64_tr_b16 v[76:77], v11 offset:12344
    ds_read_b64_tr_b16 v[78:79], v11 offset:13112
    s_waitcnt lgkmcnt(12)
    v_mfma_f32_32x32x16_bf16 v[120:135], v[32:35], v[56:59], v[120:135]
    ds_read_b64_tr_b16 v[80:81], v11 offset:12400
    ds_read_b64_tr_b16 v[82:83], v11 offset:13168
    s_waitcnt lgkmcnt(11)
    v_mfma_f32_32x32x16_bf16 v[88:103], v[36:39], v[60:63], v[88:103]
    ds_read_b128 v[44:47], v17 offset:16384
    ds_read_b64_tr_b16 v[84:85], v11 offset:15360
    ds_read_b64_tr_b16 v[86:87], v11 offset:16128
    s_waitcnt lgkmcnt(12)
    v_mfma_f32_32x32x16_bf16 v[104:119], v[36:39], v[64:67], v[104:119]
    ds_read_b64_tr_b16 v[56:57], v11 offset:15416
    ds_read_b64_tr_b16 v[58:59], v11 offset:16184
    s_waitcnt lgkmcnt(12)
    v_mfma_f32_32x32x16_bf16 v[120:135], v[36:39], v[68:71], v[120:135]
    ds_read_b64_tr_b16 v[60:61], v11 offset:15472
    ds_read_b64_tr_b16 v[62:63], v11 offset:16240
    s_waitcnt lgkmcnt(11)
    v_mfma_f32_32x32x16_bf16 v[88:103], v[40:43], v[72:75], v[88:103]
    ds_read_b128 v[48:51], v18 offset:16384
    ds_read_b64_tr_b16 v[64:65], v11 offset:18432
    ds_read_b64_tr_b16 v[66:67], v11 offset:19200
    s_waitcnt lgkmcnt(12)
    v_mfma_f32_32x32x16_bf16 v[104:119], v[40:43], v[76:79], v[104:119]
    ds_read_b64_tr_b16 v[68:69], v11 offset:18488
    ds_read_b64_tr_b16 v[70:71], v11 offset:19256
    s_waitcnt lgkmcnt(12)
    v_mfma_f32_32x32x16_bf16 v[120:135], v[40:43], v[80:83], v[120:135]
    ds_read_b64_tr_b16 v[72:73], v11 offset:18544
    ds_read_b64_tr_b16 v[74:75], v11 offset:19312
    s_waitcnt lgkmcnt(11)
    v_mfma_f32_32x32x16_bf16 v[88:103], v[44:47], v[84:87], v[88:103]
    ds_read_b128 v[52:55], v19 offset:16384
    ds_read_b64_tr_b16 v[76:77], v11 offset:21504
    ds_read_b64_tr_b16 v[78:79], v11 offset:22272
    s_waitcnt lgkmcnt(12)
    v_mfma_f32_32x32x16_bf16 v[104:119], v[44:47], v[56:59], v[104:119]
    ds_read_b64_tr_b16 v[80:81], v11 offset:21560
    ds_read_b64_tr_b16 v[82:83], v11 offset:22328
    s_waitcnt lgkmcnt(12)
    v_mfma_f32_32x32x16_bf16 v[120:135], v[44:47], v[60:63], v[120:135]
    ds_read_b64_tr_b16 v[84:85], v11 offset:21616
    ds_read_b64_tr_b16 v[86:87], v11 offset:22384
    s_waitcnt lgkmcnt(11)
    v_mfma_f32_32x32x16_bf16 v[88:103], v[48:51], v[64:67], v[88:103]
    s_barrier
    ds_read_b128 v[24:27], v16 offset:32768
    ds_read_b64_tr_b16 v[56:57], v11 offset:24576
    ds_read_b64_tr_b16 v[58:59], v11 offset:25344
    s_waitcnt lgkmcnt(12)
    v_mfma_f32_32x32x16_bf16 v[104:119], v[48:51], v[68:71], v[104:119]
    ds_read_b64_tr_b16 v[60:61], v11 offset:24632
    ds_read_b64_tr_b16 v[62:63], v11 offset:25400
    s_waitcnt lgkmcnt(12)
    v_mfma_f32_32x32x16_bf16 v[120:135], v[48:51], v[72:75], v[120:135]
    ds_read_b64_tr_b16 v[64:65], v11 offset:24688
    ds_read_b64_tr_b16 v[66:67], v11 offset:25456
    s_waitcnt lgkmcnt(11)
    v_mfma_f32_32x32x16_bf16 v[88:103], v[52:55], v[76:79], v[88:103]
    ds_read_b128 v[28:31], v17 offset:32768
    ds_read_b64_tr_b16 v[68:69], v11 offset:27648
    ds_read_b64_tr_b16 v[70:71], v11 offset:28416
    s_waitcnt lgkmcnt(12)
    v_mfma_f32_32x32x16_bf16 v[104:119], v[52:55], v[80:83], v[104:119]
    ds_read_b64_tr_b16 v[72:73], v11 offset:27704
    ds_read_b64_tr_b16 v[74:75], v11 offset:28472
    s_waitcnt lgkmcnt(12)
    v_mfma_f32_32x32x16_bf16 v[120:135], v[52:55], v[84:87], v[120:135]
    ds_read_b64_tr_b16 v[76:77], v11 offset:27760
    ds_read_b64_tr_b16 v[78:79], v11 offset:28528
    s_waitcnt lgkmcnt(11)
    v_mfma_f32_32x32x16_bf16 v[88:103], v[24:27], v[56:59], v[88:103]
    ds_read_b128 v[32:35], v18 offset:32768
    ds_read_b64_tr_b16 v[80:81], v11 offset:30720
    ds_read_b64_tr_b16 v[82:83], v11 offset:31488
    s_waitcnt lgkmcnt(12)
    v_mfma_f32_32x32x16_bf16 v[104:119], v[24:27], v[60:63], v[104:119]
    ds_read_b64_tr_b16 v[84:85], v11 offset:30776
    ds_read_b64_tr_b16 v[86:87], v11 offset:31544
    s_waitcnt lgkmcnt(12)
    v_mfma_f32_32x32x16_bf16 v[120:135], v[24:27], v[64:67], v[120:135]
    ds_read_b64_tr_b16 v[56:57], v11 offset:30832
    ds_read_b64_tr_b16 v[58:59], v11 offset:31600
    s_waitcnt lgkmcnt(11)
    v_mfma_f32_32x32x16_bf16 v[88:103], v[28:31], v[68:71], v[88:103]
    ds_read_b128 v[36:39], v19 offset:32768
    ds_read_b64_tr_b16 v[60:61], v11 offset:33792
    ds_read_b64_tr_b16 v[62:63], v11 offset:34560
    s_waitcnt lgkmcnt(12)
    v_mfma_f32_32x32x16_bf16 v[104:119], v[28:31], v[72:75], v[104:119]
    ds_read_b64_tr_b16 v[64:65], v11 offset:33848
    ds_read_b64_tr_b16 v[66:67], v11 offset:34616
    s_waitcnt lgkmcnt(12)
    v_mfma_f32_32x32x16_bf16 v[120:135], v[28:31], v[76:79], v[120:135]
    ds_read_b64_tr_b16 v[68:69], v11 offset:33904
    ds_read_b64_tr_b16 v[70:71], v11 offset:34672
    s_waitcnt lgkmcnt(11)
    v_mfma_f32_32x32x16_bf16 v[88:103], v[32:35], v[80:83], v[88:103]
    s_barrier
    ds_read_b128 v[40:43], v20 offset:0
    ds_read_b64_tr_b16 v[72:73], v11 offset:36864
    ds_read_b64_tr_b16 v[74:75], v11 offset:37632
    s_waitcnt lgkmcnt(12)
    v_mfma_f32_32x32x16_bf16 v[104:119], v[32:35], v[84:87], v[104:119]
    ds_read_b64_tr_b16 v[76:77], v11 offset:36920
    ds_read_b64_tr_b16 v[78:79], v11 offset:37688
    s_waitcnt lgkmcnt(12)
    v_mfma_f32_32x32x16_bf16 v[120:135], v[32:35], v[56:59], v[120:135]
    ds_read_b64_tr_b16 v[80:81], v11 offset:36976
    ds_read_b64_tr_b16 v[82:83], v11 offset:37744
    s_waitcnt lgkmcnt(11)
    v_mfma_f32_32x32x16_bf16 v[88:103], v[36:39], v[60:63], v[88:103]
    ds_read_b128 v[44:47], v21 offset:0
    ds_read_b64_tr_b16 v[84:85], v11 offset:39936
    ds_read_b64_tr_b16 v[86:87], v11 offset:40704
    s_waitcnt lgkmcnt(12)
    v_mfma_f32_32x32x16_bf16 v[104:119], v[36:39], v[64:67], v[104:119]
    ds_read_b64_tr_b16 v[56:57], v11 offset:39992
    ds_read_b64_tr_b16 v[58:59], v11 offset:40760
    s_waitcnt lgkmcnt(12)
    v_mfma_f32_32x32x16_bf16 v[120:135], v[36:39], v[68:71], v[120:135]
    ds_read_b64_tr_b16 v[60:61], v11 offset:40048
    ds_read_b64_tr_b16 v[62:63], v11 offset:40816
    s_waitcnt lgkmcnt(11)
    v_mfma_f32_32x32x16_bf16 v[88:103], v[40:43], v[72:75], v[88:103]
    ds_read_b128 v[48:51], v22 offset:0
    ds_read_b64_tr_b16 v[64:65], v11 offset:43008
    ds_read_b64_tr_b16 v[66:67], v11 offset:43776
    s_waitcnt lgkmcnt(12)
    v_mfma_f32_32x32x16_bf16 v[104:119], v[40:43], v[76:79], v[104:119]
    ds_read_b64_tr_b16 v[68:69], v11 offset:43064
    ds_read_b64_tr_b16 v[70:71], v11 offset:43832
    s_waitcnt lgkmcnt(12)
    v_mfma_f32_32x32x16_bf16 v[120:135], v[40:43], v[80:83], v[120:135]
    ds_read_b64_tr_b16 v[72:73], v11 offset:43120
    ds_read_b64_tr_b16 v[74:75], v11 offset:43888
    s_waitcnt lgkmcnt(11)
    v_mfma_f32_32x32x16_bf16 v[88:103], v[44:47], v[84:87], v[88:103]
    ds_read_b128 v[52:55], v23 offset:0
    ds_read_b64_tr_b16 v[76:77], v11 offset:46080
    ds_read_b64_tr_b16 v[78:79], v11 offset:46848
    s_waitcnt lgkmcnt(12)
    v_mfma_f32_32x32x16_bf16 v[104:119], v[44:47], v[56:59], v[104:119]
    ds_read_b64_tr_b16 v[80:81], v11 offset:46136
    ds_read_b64_tr_b16 v[82:83], v11 offset:46904
    s_waitcnt lgkmcnt(12)
    v_mfma_f32_32x32x16_bf16 v[120:135], v[44:47], v[60:63], v[120:135]
    ds_read_b64_tr_b16 v[84:85], v11 offset:46192
    ds_read_b64_tr_b16 v[86:87], v11 offset:46960
    s_waitcnt lgkmcnt(11)
    v_mfma_f32_32x32x16_bf16 v[88:103], v[48:51], v[64:67], v[88:103]
    s_barrier
    ds_read_b128 v[24:27], v20 offset:16384
    ds_read_b64_tr_b16 v[56:57], v11 offset:49152
    ds_read_b64_tr_b16 v[58:59], v11 offset:49920
    s_waitcnt lgkmcnt(12)
    v_mfma_f32_32x32x16_bf16 v[104:119], v[48:51], v[68:71], v[104:119]
    ds_read_b64_tr_b16 v[60:61], v11 offset:49208
    ds_read_b64_tr_b16 v[62:63], v11 offset:49976
    s_waitcnt lgkmcnt(12)
    v_mfma_f32_32x32x16_bf16 v[120:135], v[48:51], v[72:75], v[120:135]
    ds_read_b64_tr_b16 v[64:65], v11 offset:49264
    ds_read_b64_tr_b16 v[66:67], v11 offset:50032
    s_waitcnt lgkmcnt(11)
    v_mfma_f32_32x32x16_bf16 v[88:103], v[52:55], v[76:79], v[88:103]
    ds_read_b128 v[28:31], v21 offset:16384
    ds_read_b64_tr_b16 v[68:69], v11 offset:52224
    ds_read_b64_tr_b16 v[70:71], v11 offset:52992
    s_waitcnt lgkmcnt(12)
    v_mfma_f32_32x32x16_bf16 v[104:119], v[52:55], v[80:83], v[104:119]
    ds_read_b64_tr_b16 v[72:73], v11 offset:52280
    ds_read_b64_tr_b16 v[74:75], v11 offset:53048
    s_waitcnt lgkmcnt(12)
    v_mfma_f32_32x32x16_bf16 v[120:135], v[52:55], v[84:87], v[120:135]
    ds_read_b64_tr_b16 v[76:77], v11 offset:52336
    ds_read_b64_tr_b16 v[78:79], v11 offset:53104
    s_waitcnt lgkmcnt(11)
    v_mfma_f32_32x32x16_bf16 v[88:103], v[24:27], v[56:59], v[88:103]
    ds_read_b128 v[32:35], v22 offset:16384
    ds_read_b64_tr_b16 v[80:81], v11 offset:55296
    ds_read_b64_tr_b16 v[82:83], v11 offset:56064
    s_waitcnt lgkmcnt(12)
    v_mfma_f32_32x32x16_bf16 v[104:119], v[24:27], v[60:63], v[104:119]
    ds_read_b64_tr_b16 v[84:85], v11 offset:55352
    ds_read_b64_tr_b16 v[86:87], v11 offset:56120
    s_waitcnt lgkmcnt(12)
    v_mfma_f32_32x32x16_bf16 v[120:135], v[24:27], v[64:67], v[120:135]
    ds_read_b64_tr_b16 v[56:57], v11 offset:55408
    ds_read_b64_tr_b16 v[58:59], v11 offset:56176
    s_waitcnt lgkmcnt(11)
    v_mfma_f32_32x32x16_bf16 v[88:103], v[28:31], v[68:71], v[88:103]
    ds_read_b128 v[36:39], v23 offset:16384
    ds_read_b64_tr_b16 v[60:61], v11 offset:58368
    ds_read_b64_tr_b16 v[62:63], v11 offset:59136
    s_waitcnt lgkmcnt(12)
    v_mfma_f32_32x32x16_bf16 v[104:119], v[28:31], v[72:75], v[104:119]
    ds_read_b64_tr_b16 v[64:65], v11 offset:58424
    ds_read_b64_tr_b16 v[66:67], v11 offset:59192
    s_waitcnt lgkmcnt(12)
    v_mfma_f32_32x32x16_bf16 v[120:135], v[28:31], v[76:79], v[120:135]
    ds_read_b64_tr_b16 v[68:69], v11 offset:58480
    ds_read_b64_tr_b16 v[70:71], v11 offset:59248
    s_waitcnt lgkmcnt(11)
    v_mfma_f32_32x32x16_bf16 v[88:103], v[32:35], v[80:83], v[88:103]
    s_barrier
    ds_read_b128 v[40:43], v20 offset:32768
    ds_read_b64_tr_b16 v[72:73], v11 offset:0
    ds_read_b64_tr_b16 v[74:75], v11 offset:768
    s_waitcnt lgkmcnt(12)
    v_mfma_f32_32x32x16_bf16 v[104:119], v[32:35], v[84:87], v[104:119]
    ds_read_b64_tr_b16 v[76:77], v11 offset:56
    ds_read_b64_tr_b16 v[78:79], v11 offset:824
    s_waitcnt lgkmcnt(12)
    v_mfma_f32_32x32x16_bf16 v[120:135], v[32:35], v[56:59], v[120:135]
    ds_read_b64_tr_b16 v[80:81], v11 offset:112
    ds_read_b64_tr_b16 v[82:83], v11 offset:880
    s_waitcnt lgkmcnt(11)
    v_mfma_f32_32x32x16_bf16 v[88:103], v[36:39], v[60:63], v[88:103]
    ds_read_b128 v[44:47], v21 offset:32768
    ds_read_b64_tr_b16 v[84:85], v11 offset:3072
    ds_read_b64_tr_b16 v[86:87], v11 offset:3840
    s_waitcnt lgkmcnt(12)
    v_mfma_f32_32x32x16_bf16 v[104:119], v[36:39], v[64:67], v[104:119]
    ds_read_b64_tr_b16 v[56:57], v11 offset:3128
    ds_read_b64_tr_b16 v[58:59], v11 offset:3896
    s_waitcnt lgkmcnt(12)
    v_mfma_f32_32x32x16_bf16 v[120:135], v[36:39], v[68:71], v[120:135]
    ds_read_b64_tr_b16 v[60:61], v11 offset:3184
    ds_read_b64_tr_b16 v[62:63], v11 offset:3952
    s_waitcnt lgkmcnt(11)
    v_mfma_f32_32x32x16_bf16 v[88:103], v[40:43], v[72:75], v[88:103]
    ds_read_b128 v[48:51], v22 offset:32768
    ds_read_b64_tr_b16 v[64:65], v11 offset:6144
    ds_read_b64_tr_b16 v[66:67], v11 offset:6912
    s_waitcnt lgkmcnt(12)
    v_mfma_f32_32x32x16_bf16 v[104:119], v[40:43], v[76:79], v[104:119]
    ds_read_b64_tr_b16 v[68:69], v11 offset:6200
    ds_read_b64_tr_b16 v[70:71], v11 offset:6968
    s_waitcnt lgkmcnt(12)
    v_mfma_f32_32x32x16_bf16 v[120:135], v[40:43], v[80:83], v[120:135]
    ds_read_b64_tr_b16 v[72:73], v11 offset:6256
    ds_read_b64_tr_b16 v[74:75], v11 offset:7024
    s_waitcnt lgkmcnt(11)
    v_mfma_f32_32x32x16_bf16 v[88:103], v[44:47], v[84:87], v[88:103]
    ds_read_b128 v[52:55], v23 offset:32768
    ds_read_b64_tr_b16 v[76:77], v11 offset:9216
    ds_read_b64_tr_b16 v[78:79], v11 offset:9984
    s_waitcnt lgkmcnt(12)
    v_mfma_f32_32x32x16_bf16 v[104:119], v[44:47], v[56:59], v[104:119]
    ds_read_b64_tr_b16 v[80:81], v11 offset:9272
    ds_read_b64_tr_b16 v[82:83], v11 offset:10040
    s_waitcnt lgkmcnt(12)
    v_mfma_f32_32x32x16_bf16 v[120:135], v[44:47], v[60:63], v[120:135]
    ds_read_b64_tr_b16 v[84:85], v11 offset:9328
    ds_read_b64_tr_b16 v[86:87], v11 offset:10096
    s_waitcnt lgkmcnt(11)
    v_mfma_f32_32x32x16_bf16 v[88:103], v[48:51], v[64:67], v[88:103]
    s_barrier
    ds_read_b128 v[24:27], v16 offset:0
    ds_read_b64_tr_b16 v[56:57], v11 offset:12288
    ds_read_b64_tr_b16 v[58:59], v11 offset:13056
    s_waitcnt lgkmcnt(12)
    v_mfma_f32_32x32x16_bf16 v[104:119], v[48:51], v[68:71], v[104:119]
    ds_read_b128 v[28:31], v17 offset:0
    ds_read_b64_tr_b16 v[60:61], v11 offset:15360
    ds_read_b64_tr_b16 v[62:63], v11 offset:16128
    s_waitcnt lgkmcnt(13)
    v_mfma_f32_32x32x16_bf16 v[120:135], v[48:51], v[72:75], v[120:135]
    ds_read_b128 v[32:35], v18 offset:0
    ds_read_b64_tr_b16 v[64:65], v11 offset:18432
    ds_read_b64_tr_b16 v[66:67], v11 offset:19200
    s_waitcnt lgkmcnt(13)
    v_mfma_f32_32x32x16_bf16 v[88:103], v[52:55], v[76:79], v[88:103]
    ds_read_b128 v[36:39], v19 offset:0
    ds_read_b64_tr_b16 v[68:69], v11 offset:21504
    ds_read_b64_tr_b16 v[70:71], v11 offset:22272
    s_waitcnt lgkmcnt(14)
    v_mfma_f32_32x32x16_bf16 v[104:119], v[52:55], v[80:83], v[104:119]
    ds_read_b64_tr_b16 v[72:73], v11 offset:12344
    ds_read_b64_tr_b16 v[74:75], v11 offset:13112
    s_waitcnt lgkmcnt(14)
    v_mfma_f32_32x32x16_bf16 v[120:135], v[52:55], v[84:87], v[120:135]
    ds_read_b64_tr_b16 v[76:77], v11 offset:15416
    ds_read_b64_tr_b16 v[78:79], v11 offset:16184
    s_waitcnt lgkmcnt(13)
    v_mfma_f32_32x32x16_bf16 v[88:103], v[24:27], v[56:59], v[88:103]
    ds_read_b64_tr_b16 v[80:81], v11 offset:18488
    ds_read_b64_tr_b16 v[82:83], v11 offset:19256
    s_waitcnt lgkmcnt(12)
    v_mfma_f32_32x32x16_bf16 v[88:103], v[28:31], v[60:63], v[88:103]
    ds_read_b64_tr_b16 v[84:85], v11 offset:21560
    ds_read_b64_tr_b16 v[86:87], v11 offset:22328
    s_waitcnt lgkmcnt(11)
    v_mfma_f32_32x32x16_bf16 v[88:103], v[32:35], v[64:67], v[88:103]
    ds_read_b64_tr_b16 v[56:57], v11 offset:12400
    ds_read_b64_tr_b16 v[58:59], v11 offset:13168
    s_waitcnt lgkmcnt(10)
    v_mfma_f32_32x32x16_bf16 v[88:103], v[36:39], v[68:71], v[88:103]
    s_waitcnt lgkmcnt(8)
    v_mfma_f32_32x32x16_bf16 v[104:119], v[24:27], v[72:75], v[104:119]
    s_waitcnt lgkmcnt(6)
    v_mfma_f32_32x32x16_bf16 v[104:119], v[28:31], v[76:79], v[104:119]
    s_barrier
    s_mov_b32 exec_hi, 0
    ds_read_b64 v[160:161], v9 offset:0
    s_mov_b32 exec_hi, -1
    ds_read_b64 v[60:61], v5 offset:1536
    ds_read_b64 v[64:65], v5 offset:1792
    ds_read_b64_tr_b16 v[68:69], v11 offset:15472
    ds_read_b64_tr_b16 v[70:71], v11 offset:16240
    s_waitcnt lgkmcnt(9)
    v_mfma_f32_32x32x16_bf16 v[104:119], v[32:35], v[80:83], v[104:119]
    ds_read_b64_tr_b16 v[72:73], v11 offset:18544
    ds_read_b64_tr_b16 v[74:75], v11 offset:19312
    ds_read_b128 v[40:43], v8 offset:1024
    ds_read_b128 v[44:47], v8 offset:1056
    ds_read_b128 v[48:51], v8 offset:1088
    ds_read_b128 v[52:55], v8 offset:1120
    s_waitcnt lgkmcnt(13)
    v_mfma_f32_32x32x16_bf16 v[104:119], v[36:39], v[84:87], v[104:119]
    ds_read_b64_tr_b16 v[76:77], v11 offset:21616
    ds_read_b64_tr_b16 v[78:79], v11 offset:22384
    s_waitcnt lgkmcnt(13)
    v_mfma_f32_32x32x16_bf16 v[120:135], v[24:27], v[56:59], v[120:135]
    ds_read_b64 v[80:81], v5 offset:2048
    s_waitcnt lgkmcnt(12)
    v_mfma_f32_32x32x16_bf16 v[88:103], v[160:163], v[60:63], v[88:103]
    s_waitcnt lgkmcnt(11)
    v_mfma_f32_32x32x16_bf16 v[104:119], v[160:163], v[64:67], v[104:119]
    s_waitcnt lgkmcnt(0)
    s_waitcnt lgkmcnt(9)
    v_mfma_f32_32x32x16_bf16 v[120:135], v[28:31], v[68:71], v[120:135]
    v_mul_f32 v88, v40, v88
    v_mul_f32 v89, v41, v89
    v_mul_f32 v90, v42, v90
    v_mul_f32 v91, v43, v91
    v_mul_f32 v92, v44, v92
    s_waitcnt lgkmcnt(7)
    v_mfma_f32_32x32x16_bf16 v[120:135], v[32:35], v[72:75], v[120:135]
    v_mul_f32 v93, v45, v93
    v_mul_f32 v94, v46, v94
    v_mul_f32 v95, v47, v95
    v_mul_f32 v96, v48, v96
    v_mul_f32 v97, v49, v97
    s_waitcnt lgkmcnt(1)
    v_mfma_f32_32x32x16_bf16 v[120:135], v[36:39], v[76:79], v[120:135]
    v_mul_f32 v98, v50, v98
    v_mul_f32 v99, v51, v99
    v_mul_f32 v100, v52, v100
    v_mul_f32 v101, v53, v101
    v_mul_f32 v102, v54, v102
    s_waitcnt lgkmcnt(0)
    v_mfma_f32_32x32x16_bf16 v[120:135], v[160:163], v[80:83], v[120:135]
    v_mul_f32 v103, v55, v103
    s_mov_b32 exec_lo, 0x0fffffff
    s_mov_b32 exec_hi, 0x0fffffff
    v_cvt_pk_bf16_f32 v136, v88, v89
    v_cvt_pk_bf16_f32 v137, v90, v91
    v_cvt_pk_bf16_f32 v138, v92, v93
    v_cvt_pk_bf16_f32 v139, v94, v95
    s_mov_b64 exec, -1
    buffer_store_dwordx4 v[136:139], v12, s[16:19], s42 offen sc1
    s_mov_b32 exec_lo, 0x0fffffff
    s_mov_b32 exec_hi, 0x0fffffff
    v_cvt_pk_bf16_f32 v140, v96, v97
    v_cvt_pk_bf16_f32 v141, v98, v99
    v_cvt_pk_bf16_f32 v142, v100, v101
    v_cvt_pk_bf16_f32 v143, v102, v103
    s_mov_b64 exec, -1
    buffer_store_dwordx4 v[140:143], v12, s[16:19], s42 offen offset:1024 sc1
    v_mul_f32 v104, v40, v104
    v_mul_f32 v105, v41, v105
    v_mul_f32 v106, v42, v106
    v_mul_f32 v107, v43, v107
    v_mul_f32 v108, v44, v108
    v_mul_f32 v109, v45, v109
    v_mul_f32 v110, v46, v110
    v_mul_f32 v111, v47, v111
    v_mul_f32 v112, v48, v112
    v_mul_f32 v113, v49, v113
    v_mul_f32 v114, v50, v114
    v_mul_f32 v115, v51, v115
    v_mul_f32 v116, v52, v116
    v_mul_f32 v117, v53, v117
    v_mul_f32 v118, v54, v118
    v_mul_f32 v119, v55, v119
    s_mov_b32 exec_lo, 0x0fffffff
    s_mov_b32 exec_hi, 0x0fffffff
    v_cvt_pk_bf16_f32 v144, v104, v105
    v_cvt_pk_bf16_f32 v145, v106, v107
    v_cvt_pk_bf16_f32 v146, v108, v109
    v_cvt_pk_bf16_f32 v147, v110, v111
    s_mov_b64 exec, -1
    buffer_store_dwordx4 v[144:147], v12, s[16:19], s43 offen sc1
    s_mov_b32 exec_lo, 0x0fffffff
    s_mov_b32 exec_hi, 0x0fffffff
    v_cvt_pk_bf16_f32 v148, v112, v113
    v_cvt_pk_bf16_f32 v149, v114, v115
    v_cvt_pk_bf16_f32 v150, v116, v117
    v_cvt_pk_bf16_f32 v151, v118, v119
    s_mov_b64 exec, -1
    buffer_store_dwordx4 v[148:151], v12, s[16:19], s43 offen offset:1024 sc1
    v_mul_f32 v120, v40, v120
    v_mul_f32 v121, v41, v121
    v_mul_f32 v122, v42, v122
    v_mul_f32 v123, v43, v123
    v_mul_f32 v124, v44, v124
    v_mul_f32 v125, v45, v125
    v_mul_f32 v126, v46, v126
    v_mul_f32 v127, v47, v127
    v_mul_f32 v128, v48, v128
    v_mul_f32 v129, v49, v129
    v_mul_f32 v130, v50, v130
    v_mul_f32 v131, v51, v131
    v_mul_f32 v132, v52, v132
    v_mul_f32 v133, v53, v133
    v_mul_f32 v134, v54, v134
    v_mul_f32 v135, v55, v135
    s_mov_b32 exec_lo, 0x0fffffff
    s_mov_b32 exec_hi, 0x0fffffff
    v_cvt_pk_bf16_f32 v152, v120, v121
    v_cvt_pk_bf16_f32 v153, v122, v123
    v_cvt_pk_bf16_f32 v154, v124, v125
    v_cvt_pk_bf16_f32 v155, v126, v127
    s_mov_b64 exec, -1
    buffer_store_dwordx4 v[152:155], v12, s[16:19], s44 offen sc1
    s_mov_b32 exec_lo, 0x0fffffff
    s_mov_b32 exec_hi, 0x0fffffff
    v_cvt_pk_bf16_f32 v156, v128, v129
    v_cvt_pk_bf16_f32 v157, v130, v131
    v_cvt_pk_bf16_f32 v158, v132, v133
    v_cvt_pk_bf16_f32 v159, v134, v135
    s_mov_b64 exec, -1
    buffer_store_dwordx4 v[156:159], v12, s[16:19], s44 offen offset:1024 sc1
L_qkv_kernel_done:
    s_endpgm
.globl fused_kernel
.p2align 8
.type fused_kernel,@function
fused_kernel:
    s_cmp_ge_u32 s2, 256
    s_cbranch_scc1 L_fused_kernel_done
    s_load_dwordx2 s[4:5], s[0:1], 64
    s_load_dwordx2 s[6:7], s[0:1], 0
    s_load_dwordx2 s[20:21], s[0:1], 48
    v_lshrrev_b32 v1, 6, v0
    v_and_b32 v0, 63, v0
    v_readfirstlane_b32 s30, v1
    v_lshlrev_b32 v1, 4, v0
    s_and_b32 s26, s2, 7
    s_lshr_b32 s27, s2, 3
    s_lshl_b32 s22, s26, 1
    s_lshr_b32 s23, s27, 4
    s_add_u32 s22, s22, s23
    s_and_b32 s23, s27, 15
    s_lshl_b32 s23, s23, 2
    s_lshl_b32 s26, s22, 6
    s_add_u32 s24, s26, s23
    s_add_u32 s24, s24, s30
    s_lshl_b32 s24, s24, 11
    s_lshl_b32 s25, s26, 11
    s_add_u32 s25, s25, 2097152
    s_lshl_b32 s26, s30, 15
    s_add_u32 s25, s25, s26
    s_mov_b32 s3, 0
    v_add_u32 v15, 2097152, v1
    s_waitcnt lgkmcnt(0)
    s_mov_b32 s8, s4
    s_mov_b32 s9, s5
    s_mov_b32 s10, 26214400
    s_mov_b32 s11, 0x00020000
    s_lshl_b32 s26, s22, 6
    s_add_u32 s26, s26, s23
    s_lshl_b32 s26, s26, 11
    s_add_u32 s26, s26, 2097152
    buffer_load_dwordx4 v[144:147], v1, s[8:11], s26 offen offset:0
    buffer_load_dwordx4 v[148:151], v1, s[8:11], s26 offen offset:1024
    buffer_load_dwordx4 v[16:19], v1, s[8:11], s24 offen
    buffer_load_dwordx4 v[20:23], v1, s[8:11], s24 offen offset:1024
    s_xor_b32 s37, s24, 2048
    buffer_load_dwordx4 v[24:27], v1, s[8:11], s37 offen
    buffer_load_dwordx4 v[28:31], v1, s[8:11], s37 offen offset:1024
    s_xor_b32 s37, s24, 4096
    buffer_load_dwordx4 v[32:35], v1, s[8:11], s37 offen
    buffer_load_dwordx4 v[36:39], v1, s[8:11], s37 offen offset:1024
    s_xor_b32 s37, s24, 6144
    buffer_load_dwordx4 v[40:43], v1, s[8:11], s37 offen
    buffer_load_dwordx4 v[44:47], v1, s[8:11], s37 offen offset:1024
    buffer_load_dwordx4 v[96:99], v1, s[8:11], s25 offen offset:0
    buffer_load_dwordx4 v[100:103], v1, s[8:11], s25 offen offset:1024
    buffer_load_dwordx4 v[104:107], v15, s[8:11], s25 offen offset:0
    buffer_load_dwordx4 v[108:111], v15, s[8:11], s25 offen offset:1024
    s_add_u32 s37, s25, 2048
    buffer_load_dwordx4 v[112:115], v1, s[8:11], s37 offen offset:0
    buffer_load_dwordx4 v[116:119], v1, s[8:11], s37 offen offset:1024
    buffer_load_dwordx4 v[120:123], v15, s[8:11], s37 offen offset:0
    buffer_load_dwordx4 v[124:127], v15, s[8:11], s37 offen offset:1024
    s_add_u32 s37, s25, 4096
    buffer_load_dwordx4 v[128:131], v1, s[8:11], s37 offen offset:0
    buffer_load_dwordx4 v[132:135], v1, s[8:11], s37 offen offset:1024
    buffer_load_dwordx4 v[136:139], v15, s[8:11], s37 offen offset:0
    buffer_load_dwordx4 v[140:143], v15, s[8:11], s37 offen offset:1024
    s_and_b32 s26, s2, 7
    s_lshr_b32 s27, s2, 3
    s_lshl_b32 s28, s26, 1
    s_and_b32 s29, s27, 1
    s_add_u32 s28, s28, s29
    s_lshr_b32 s29, s27, 1
    s_lshl_b32 s32, s28, 2
    s_and_b32 s63, s29, 1
    s_add_u32 s33, s63, s32
    s_and_b32 s53, s30, 1
    s_lshl_b32 s31, s53, 1
    s_add_u32 s36, s33, s31
    s_and_b32 s34, s29, 14
    s_lshr_b32 s54, s30, 1
    s_add_u32 s35, s34, s54
    s_xor_b32 s38, s35, 1
    s_lshl_b32 s40, s54, 1
    s_add_u32 s40, s40, s33
    s_lshl_b32 s40, s40, 15
    s_lshl_b32 s41, s53, 14
    s_add_u32 s40, s40, s41
    s_add_u32 s40, s40, 6291456
    s_lshl_b32 s42, s30, 14
    s_lshl_b32 s41, s34, 15
    s_add_u32 s41, s41, s42
    s_add_u32 s41, s41, 20971520
    s_add_u32 s42, s42, 2048
    v_and_b32 v2, 31, v0
    v_lshrrev_b32 v3, 5, v0
    s_lshl_b32 s44, s36, 5
    v_add_u32 v4, s44, v2
    v_mul_u32_u24 v4, 896, v4
    v_lshl_add_u32 v4, v3, 3, v4
    s_lshl_b32 s45, s35, 6
    s_mov_b32 s12, s6
    s_mov_b32 s13, s7
    s_mov_b32 s14, 1835008
    s_mov_b32 s15, 0x00020000
    buffer_load_dwordx2 v[248:249], v4, s[12:15], s45 offen offset:0
    buffer_load_dwordx2 v[250:251], v4, s[12:15], s45 offen offset:16
    buffer_load_dwordx2 v[252:253], v4, s[12:15], s45 offen offset:32
    buffer_load_dwordx2 v[254:255], v4, s[12:15], s45 offen offset:48
    s_mov_b32 s16, s20
    s_mov_b32 s17, s21
    s_mov_b32 s18, 1835008
    s_mov_b32 s19, 0x00020000
    s_lshl_b32 s31, s29, 2
    s_add_u32 s31, s31, s30
    s_mul_i32 s46, s31, 28672
    s_add_u32 s46, s46, 21430272
    s_lshl_b32 s39, s30, 11
    s_mul_i32 s43, s63, 57344
    s_add_u32 s39, s39, s43
    s_mul_i32 s47, s35, 114688
    s_add_u32 s47, s47, s39
    s_add_u32 s47, s47, 23035904
    s_mul_i32 s48, s38, 114688
    s_add_u32 s48, s48, s39
    s_add_u32 s48, s48, 23035904
    s_lshl_b32 s43, s43, 1
    s_sub_u32 s43, 57344, s43
    s_add_u32 s57, s47, s43
    s_add_u32 s58, s48, s43
    s_lshl_b32 s50, s28, 11
    s_lshl_b32 s62, s28, 13
    s_add_u32 s62, s62, 25296896
    s_add_u32 s50, s50, 25231360
    s_lshl_b32 s51, s31, 2
    s_add_u32 s51, s51, s50
    s_mul_i32 s55, s36, 14
    s_add_u32 s55, s55, s35
    s_lshl_b32 s55, s55, 11
    s_add_u32 s55, s55, 8388608
    s_lshl_b32 s56, s35, 11
    s_lshl_b32 s49, s36, 5
    s_add_u32 s56, s56, s49
    s_lshl_b32 s56, s56, 3
    s_add_u32 s56, s56, 10485760
    s_mul_i32 s49, s32, 56
    s_add_u32 s49, s49, s31
    s_lshl_b32 s49, s49, 11
    s_add_u32 s49, s49, 12582912
    v_mov_b32 v244, -1
    v_mov_b32 v245, -1
    v_mov_b32 v246, -1
    v_mov_b32 v247, -1
    s_cmp_lt_u32 s29, 14
    s_cselect_b32 s49, s49, 0x7f000000
    s_cselect_b32 s41, s41, 0x7f000000
    s_cselect_b32 s46, s46, 0x7f000000
    s_cselect_b32 s47, s47, 0x7f000000
    s_cselect_b32 s48, s48, 0x7f000000
    s_cselect_b32 s57, s57, 0x7f000000
    s_cselect_b32 s58, s58, 0x7f000000
    v_mov_b32 v8, 0
    v_mov_b32 v10, 1
    s_add_u32 s59, s25, 4096
    s_add_u32 s6, s4, s59
    s_addc_u32 s7, s5, 0
    s_add_u32 s12, s6, 2097152
    s_addc_u32 s13, s7, 0
    s_cmp_lt_u32 s29, 14
    s_cselect_b32 s59, s46, 20971520
    s_add_u32 s59, s59, 4096
    s_add_u32 s14, s4, s59
    s_addc_u32 s15, s5, 0
    s_cmp_lt_u32 s29, 14
    s_cselect_b32 s59, s47, 20971520
    s_add_u32 s20, s4, s59
    s_addc_u32 s21, s5, 0
    s_cmp_lt_u32 s29, 14
    s_cselect_b32 s59, s48, 20971520
    s_add_u32 s72, s4, s59
    s_addc_u32 s73, s5, 0
    s_cmp_lt_u32 s29, 14
    s_cselect_b32 s59, s57, 20971520
    s_add_u32 s60, s4, s59
    s_addc_u32 s61, s5, 0
    s_cmp_lt_u32 s29, 14
    s_cselect_b32 s59, s58, 20971520
    s_add_u32 s64, s4, s59
    s_addc_u32 s65, s5, 0
    s_cmp_lt_u32 s29, 14
    s_cselect_b32 s59, s41, 20971520
    s_add_u32 s66, s4, s59
    s_addc_u32 s67, s5, 0
    s_add_u32 s68, s66, 4096
    s_addc_u32 s69, s67, 0
    s_and_b32 s70, s2, 31
    s_lshl_b32 s70, s70, 2
    s_add_u32 s70, s70, s30
    s_mul_i32 s70, s70, 458752
    s_add_u32 s70, s70, 29360128
    s_cmp_lt_u32 s29, 14
    s_cselect_b32 s59, s49, s70
    s_add_u32 s70, s4, s59
    s_addc_u32 s71, s5, 0
    s_add_u32 s59, s23, s30
    s_lshl_b32 s59, s59, 4
    s_add_u32 s59, s59, s22
    s_lshl_b32 s59, s59, 11
    s_add_u32 s59, s59, 6291456
    s_add_u32 s98, s4, s59
    s_addc_u32 s99, s5, 0
    v_add_u32 v4, 8192, v1
    v_add_u32 v5, 16384, v1
    v_add_u32 v6, 24576, v1
    v_add_u32 v7, 32768, v1
    v_add_u32 v9, 40960, v1
    v_add_u32 v11, 49152, v1
    v_add_u32 v12, 114688, v1
    v_add_u32 v13, 229376, v1
    v_add_u32 v14, 344064, v1
    v_mov_b32 v240, 0x3f803f80
    v_mov_b32 v241, 0x3f803f80
    v_mov_b32 v242, 0x3f803f80
    v_mov_b32 v243, 0x3f803f80
    s_waitcnt vmcnt(22)
    v_mfma_f32_32x32x16_bf16 v[160:175], v[144:147], v[16:19], 0
    v_mfma_f32_32x32x16_bf16 v[160:175], v[148:151], v[20:23], v[160:175]
    s_waitcnt vmcnt(20)
    v_mfma_f32_32x32x16_bf16 v[176:191], v[144:147], v[24:27], 0
    v_mfma_f32_32x32x16_bf16 v[176:191], v[148:151], v[28:31], v[176:191]
    v_max3_f32 v224, v160, v161, v162
    v_max3_f32 v225, v163, v164, v165
    v_max3_f32 v224, v224, v166, v167
    v_max3_f32 v225, v225, v168, v169
    v_max3_f32 v224, v224, v170, v171
    v_max3_f32 v225, v225, v172, v173
    v_max3_f32 v224, v224, v174, v175
    v_max_f32 v224, v224, v225
    v_mov_b32 v225, v224
    s_nop 1
    v_permlane32_swap_b32 v224, v225
    s_nop 0
    v_max_f32 v224, v224, v225
    s_mov_b32 exec_lo, 0
    v_cvt_pk_bf16_f32 v22, -v224, 0
    s_mov_b32 exec_lo, -1
    s_waitcnt vmcnt(18)
    v_mfma_f32_32x32x16_bf16 v[192:207], v[144:147], v[32:35], 0
    v_mfma_f32_32x32x16_bf16 v[192:207], v[148:151], v[36:39], v[192:207]
    v_max3_f32 v226, v176, v177, v178
    v_max3_f32 v227, v179, v180, v181
    v_max3_f32 v226, v226, v182, v183
    v_max3_f32 v227, v227, v184, v185
    v_max3_f32 v226, v226, v186, v187
    v_max3_f32 v227, v227, v188, v189
    v_max3_f32 v226, v226, v190, v191
    v_max_f32 v226, v226, v227
    v_mov_b32 v227, v226
    s_nop 1
    v_permlane32_swap_b32 v226, v227
    s_nop 0
    v_max_f32 v226, v226, v227
    s_mov_b32 exec_lo, 0
    v_cvt_pk_bf16_f32 v30, -v226, 0
    s_mov_b32 exec_lo, -1
    s_waitcnt vmcnt(16)
    v_mfma_f32_32x32x16_bf16 v[208:223], v[144:147], v[40:43], 0
    v_mfma_f32_32x32x16_bf16 v[208:223], v[148:151], v[44:47], v[208:223]
    v_max3_f32 v228, v192, v193, v194
    v_max3_f32 v229, v195, v196, v197
    v_max3_f32 v228, v228, v198, v199
    v_max3_f32 v229, v229, v200, v201
    v_max3_f32 v228, v228, v202, v203
    v_max3_f32 v229, v229, v204, v205
    v_max3_f32 v228, v228, v206, v207
    v_max_f32 v228, v228, v229
    v_mov_b32 v229, v228
    s_nop 1
    v_permlane32_swap_b32 v228, v229
    s_nop 0
    v_max_f32 v228, v228, v229
    s_mov_b32 exec_lo, 0
    v_cvt_pk_bf16_f32 v38, -v228, 0
    s_mov_b32 exec_lo, -1
    s_waitcnt vmcnt(14)
    v_mfma_f32_32x32x16_bf16 v[48:63], v[96:99], v[16:19], 0
    v_mfma_f32_32x32x16_bf16 v[48:63], v[100:103], v[20:23], v[48:63]
    v_max3_f32 v230, v208, v209, v210
    v_max3_f32 v231, v211, v212, v213
    v_max3_f32 v230, v230, v214, v215
    v_max3_f32 v231, v231, v216, v217
    v_max3_f32 v230, v230, v218, v219
    v_max3_f32 v231, v231, v220, v221
    v_max3_f32 v230, v230, v222, v223
    v_max_f32 v230, v230, v231
    v_mov_b32 v231, v230
    s_nop 1
    v_permlane32_swap_b32 v230, v231
    s_nop 0
    v_max_f32 v230, v230, v231
    s_mov_b32 exec_lo, 0
    v_cvt_pk_bf16_f32 v46, -v230, 0
    s_mov_b32 exec_lo, -1
L_att_loop:
    v_mfma_f32_32x32x16_bf16 v[64:79], v[96:99], v[24:27], 0
    global_load_dwordx4 v[144:147], v1, s[6:7] offset:2048
    v_exp_f32 v48, v48
    v_exp_f32 v49, v49
    v_exp_f32 v50, v50
    v_exp_f32 v51, v51
    v_cvt_pk_bf16_f32 v80, v48, v49
    v_exp_f32 v52, v52
    v_mfma_f32_32x32x16_bf16 v[64:79], v[100:103], v[28:31], v[64:79]
    global_load_dwordx4 v[148:151], v1, s[6:7] offset:3072
    v_exp_f32 v53, v53
    v_cvt_pk_bf16_f32 v81, v50, v51
    v_exp_f32 v54, v54
    v_exp_f32 v55, v55
    v_cvt_pk_bf16_f32 v82, v52, v53
    v_exp_f32 v56, v56
    v_exp_f32 v57, v57
    v_cvt_pk_bf16_f32 v83, v54, v55
    v_exp_f32 v58, v58
    v_exp_f32 v59, v59
    v_cvt_pk_bf16_f32 v84, v56, v57
    v_exp_f32 v60, v60
    global_load_dwordx4 v[152:155], v1, s[12:13] offset:2048
    v_exp_f32 v61, v61
    v_cvt_pk_bf16_f32 v85, v58, v59
    v_exp_f32 v62, v62
    v_exp_f32 v63, v63
    v_cvt_pk_bf16_f32 v86, v60, v61
    v_cvt_pk_bf16_f32 v87, v62, v63
    v_mfma_f32_32x32x16_bf16 v[48:63], v[96:99], v[32:35], 0
    v_exp_f32 v64, v64
    v_exp_f32 v65, v65
    v_exp_f32 v66, v66
    v_exp_f32 v67, v67
    v_cvt_pk_bf16_f32 v88, v64, v65
    v_exp_f32 v68, v68
    v_mfma_f32_32x32x16_bf16 v[48:63], v[100:103], v[36:39], v[48:63]
    global_load_dwordx4 v[156:159], v1, s[12:13] offset:3072
    v_exp_f32 v69, v69
    v_cvt_pk_bf16_f32 v89, v66, v67
    v_exp_f32 v70, v70
    v_exp_f32 v71, v71
    v_cvt_pk_bf16_f32 v90, v68, v69
    v_exp_f32 v72, v72
    s_waitcnt vmcnt(16)
    v_mfma_f32_32x32x16_bf16 v[160:175], v[104:107], v[80:83], 0
    v_exp_f32 v73, v73
    v_cvt_pk_bf16_f32 v91, v70, v71
    v_exp_f32 v74, v74
    v_exp_f32 v75, v75
    v_cvt_pk_bf16_f32 v92, v72, v73
    v_exp_f32 v76, v76
    v_mfma_f32_32x32x16_bf16 v[160:175], v[108:111], v[84:87], v[160:175]
    v_exp_f32 v77, v77
    v_cvt_pk_bf16_f32 v93, v74, v75
    v_exp_f32 v78, v78
    v_exp_f32 v79, v79
    v_cvt_pk_bf16_f32 v94, v76, v77
    v_cvt_pk_bf16_f32 v95, v78, v79
    v_mfma_f32_32x32x16_bf16 v[64:79], v[96:99], v[40:43], 0
    v_exp_f32 v48, v48
    v_exp_f32 v49, v49
    v_exp_f32 v50, v50
    v_exp_f32 v51, v51
    v_cvt_pk_bf16_f32 v80, v48, v49
    v_exp_f32 v52, v52
    v_mfma_f32_32x32x16_bf16 v[64:79], v[100:103], v[44:47], v[64:79]
    v_exp_f32 v53, v53
    v_cvt_pk_bf16_f32 v81, v50, v51
    v_exp_f32 v54, v54
    v_exp_f32 v55, v55
    v_cvt_pk_bf16_f32 v82, v52, v53
    v_exp_f32 v56, v56
    v_mfma_f32_32x32x16_bf16 v[176:191], v[104:107], v[88:91], 0
    s_waitcnt vmcnt(14)
    v_exp_f32 v57, v57
    v_cvt_pk_bf16_f32 v83, v54, v55
    v_exp_f32 v58, v58
    v_exp_f32 v59, v59
    v_cvt_pk_bf16_f32 v84, v56, v57
    v_exp_f32 v60, v60
    v_mfma_f32_32x32x16_bf16 v[176:191], v[108:111], v[92:95], v[176:191]
    v_exp_f32 v61, v61
    v_cvt_pk_bf16_f32 v85, v58, v59
    v_exp_f32 v62, v62
    v_exp_f32 v63, v63
    v_cvt_pk_bf16_f32 v86, v60, v61
    v_cvt_pk_bf16_f32 v87, v62, v63
    v_mfma_f32_32x32x16_bf16 v[48:63], v[112:115], v[16:19], 0
    v_exp_f32 v64, v64
    v_exp_f32 v65, v65
    v_exp_f32 v66, v66
    v_exp_f32 v67, v67
    v_cvt_pk_bf16_f32 v88, v64, v65
    v_exp_f32 v68, v68
    v_mfma_f32_32x32x16_bf16 v[48:63], v[116:119], v[20:23], v[48:63]
    global_load_dwordx4 v[96:99], v4, s[6:7] offset:-4096
    v_exp_f32 v69, v69
    v_cvt_pk_bf16_f32 v89, v66, v67
    v_exp_f32 v70, v70
    v_exp_f32 v71, v71
    v_cvt_pk_bf16_f32 v90, v68, v69
    v_exp_f32 v72, v72
    v_mfma_f32_32x32x16_bf16 v[192:207], v[104:107], v[80:83], 0
    v_exp_f32 v73, v73
    v_cvt_pk_bf16_f32 v91, v70, v71
    v_exp_f32 v74, v74
    v_exp_f32 v75, v75
    v_cvt_pk_bf16_f32 v92, v72, v73
    v_exp_f32 v76, v76
    v_mfma_f32_32x32x16_bf16 v[192:207], v[108:111], v[84:87], v[192:207]
    global_load_dwordx4 v[100:103], v4, s[6:7] offset:-3072
    v_exp_f32 v77, v77
    v_cvt_pk_bf16_f32 v93, v74, v75
    v_exp_f32 v78, v78
    v_exp_f32 v79, v79
    v_cvt_pk_bf16_f32 v94, v76, v77
    v_cvt_pk_bf16_f32 v95, v78, v79
    v_mfma_f32_32x32x16_bf16 v[64:79], v[112:115], v[24:27], 0
    global_load_dwordx4 a[112:115], v1, s[20:21] offset:0
    v_exp_f32 v48, v48
    v_exp_f32 v49, v49
    v_exp_f32 v50, v50
    v_exp_f32 v51, v51
    v_cvt_pk_bf16_f32 v80, v48, v49
    v_exp_f32 v52, v52
    v_mfma_f32_32x32x16_bf16 v[64:79], v[116:119], v[28:31], v[64:79]
    v_exp_f32 v53, v53
    v_cvt_pk_bf16_f32 v81, v50, v51
    v_exp_f32 v54, v54
    v_exp_f32 v55, v55
    v_cvt_pk_bf16_f32 v82, v52, v53
    v_exp_f32 v56, v56
    v_mfma_f32_32x32x16_bf16 v[208:223], v[104:107], v[88:91], 0
    global_load_dwordx4 a[116:119], v1, s[72:73] offset:0
    v_exp_f32 v57, v57
    v_cvt_pk_bf16_f32 v83, v54, v55
    v_exp_f32 v58, v58
    v_exp_f32 v59, v59
    v_cvt_pk_bf16_f32 v84, v56, v57
    v_exp_f32 v60, v60
    v_mfma_f32_32x32x16_bf16 v[208:223], v[108:111], v[92:95], v[208:223]
    global_load_dwordx4 v[104:107], v4, s[12:13] offset:-4096
    v_exp_f32 v61, v61
    v_cvt_pk_bf16_f32 v85, v58, v59
    v_exp_f32 v62, v62
    v_exp_f32 v63, v63
    v_cvt_pk_bf16_f32 v86, v60, v61
    v_cvt_pk_bf16_f32 v87, v62, v63
    v_mfma_f32_32x32x16_bf16 v[48:63], v[112:115], v[32:35], 0
    s_waitcnt vmcnt(17)
    v_exp_f32 v64, v64
    v_exp_f32 v65, v65
    v_exp_f32 v66, v66
    v_exp_f32 v67, v67
    v_cvt_pk_bf16_f32 v88, v64, v65
    v_exp_f32 v68, v68
    v_mfma_f32_32x32x16_bf16 v[48:63], v[116:119], v[36:39], v[48:63]
    global_load_dwordx4 v[108:111], v4, s[12:13] offset:-3072
    v_exp_f32 v69, v69
    v_cvt_pk_bf16_f32 v89, v66, v67
    v_exp_f32 v70, v70
    v_exp_f32 v71, v71
    v_cvt_pk_bf16_f32 v90, v68, v69
    v_exp_f32 v72, v72
    v_mfma_f32_32x32x16_bf16 v[160:175], v[120:123], v[80:83], v[160:175]
    global_store_dwordx4 v1, v[244:247], s[98:99] offset:0 nt sc1
    v_exp_f32 v73, v73
    v_cvt_pk_bf16_f32 v91, v70, v71
    v_exp_f32 v74, v74
    v_exp_f32 v75, v75
    v_cvt_pk_bf16_f32 v92, v72, v73
    v_exp_f32 v76, v76
    v_mfma_f32_32x32x16_bf16 v[160:175], v[124:127], v[84:87], v[160:175]
    global_load_dwordx4 a[120:123], v1, s[20:21] offset:1024
    v_exp_f32 v77, v77
    v_cvt_pk_bf16_f32 v93, v74, v75
    v_exp_f32 v78, v78
    v_exp_f32 v79, v79
    v_cvt_pk_bf16_f32 v94, v76, v77
    v_cvt_pk_bf16_f32 v95, v78, v79
    v_mfma_f32_32x32x16_bf16 v[64:79], v[112:115], v[40:43], 0
    v_exp_f32 v48, v48
    v_exp_f32 v49, v49
    v_exp_f32 v50, v50
    v_exp_f32 v51, v51
    v_cvt_pk_bf16_f32 v80, v48, v49
    v_exp_f32 v52, v52
    v_mfma_f32_32x32x16_bf16 v[64:79], v[116:119], v[44:47], v[64:79]
    v_exp_f32 v53, v53
    v_cvt_pk_bf16_f32 v81, v50, v51
    v_exp_f32 v54, v54
    v_exp_f32 v55, v55
    v_cvt_pk_bf16_f32 v82, v52, v53
    v_exp_f32 v56, v56
    v_mfma_f32_32x32x16_bf16 v[176:191], v[120:123], v[88:91], v[176:191]
    s_waitcnt vmcnt(18)
    v_exp_f32 v57, v57
    v_cvt_pk_bf16_f32 v83, v54, v55
    v_exp_f32 v58, v58
    v_exp_f32 v59, v59
    v_cvt_pk_bf16_f32 v84, v56, v57
    v_exp_f32 v60, v60
    v_mfma_f32_32x32x16_bf16 v[176:191], v[124:127], v[92:95], v[176:191]
    global_load_dwordx4 a[124:127], v1, s[72:73] offset:1024
    v_exp_f32 v61, v61
    v_cvt_pk_bf16_f32 v85, v58, v59
    v_exp_f32 v62, v62
    v_exp_f32 v63, v63
    v_cvt_pk_bf16_f32 v86, v60, v61
    v_cvt_pk_bf16_f32 v87, v62, v63
    v_mfma_f32_32x32x16_bf16 v[48:63], v[128:131], v[16:19], 0
    global_load_dwordx4 a[128:131], v4, s[20:21] offset:0
    v_exp_f32 v64, v64
    v_exp_f32 v65, v65
    v_exp_f32 v66, v66
    v_exp_f32 v67, v67
    v_cvt_pk_bf16_f32 v88, v64, v65
    v_exp_f32 v68, v68
    v_mfma_f32_32x32x16_bf16 v[48:63], v[132:135], v[20:23], v[48:63]
    global_load_dwordx4 v[112:115], v4, s[6:7] offset:-2048
    v_exp_f32 v69, v69
    v_cvt_pk_bf16_f32 v89, v66, v67
    v_exp_f32 v70, v70
    v_exp_f32 v71, v71
    v_cvt_pk_bf16_f32 v90, v68, v69
    v_exp_f32 v72, v72
    v_mfma_f32_32x32x16_bf16 v[192:207], v[120:123], v[80:83], v[192:207]
    v_exp_f32 v73, v73
    v_cvt_pk_bf16_f32 v91, v70, v71
    v_exp_f32 v74, v74
    v_exp_f32 v75, v75
    v_cvt_pk_bf16_f32 v92, v72, v73
    v_exp_f32 v76, v76
    v_mfma_f32_32x32x16_bf16 v[192:207], v[124:127], v[84:87], v[192:207]
    global_load_dwordx4 v[116:119], v4, s[6:7] offset:-1024
    v_exp_f32 v77, v77
    v_cvt_pk_bf16_f32 v93, v74, v75
    v_exp_f32 v78, v78
    v_exp_f32 v79, v79
    v_cvt_pk_bf16_f32 v94, v76, v77
    v_cvt_pk_bf16_f32 v95, v78, v79
    v_mfma_f32_32x32x16_bf16 v[64:79], v[128:131], v[24:27], 0
    global_store_dwordx4 v1, v[244:247], s[98:99] offset:1024 nt sc1
    v_exp_f32 v48, v48
    v_exp_f32 v49, v49
    v_exp_f32 v50, v50
    v_exp_f32 v51, v51
    v_cvt_pk_bf16_f32 v80, v48, v49
    v_exp_f32 v52, v52
    v_mfma_f32_32x32x16_bf16 v[64:79], v[132:135], v[28:31], v[64:79]
    global_load_dwordx4 a[132:135], v4, s[72:73] offset:0
    v_exp_f32 v53, v53
    v_cvt_pk_bf16_f32 v81, v50, v51
    v_exp_f32 v54, v54
    v_exp_f32 v55, v55
    v_cvt_pk_bf16_f32 v82, v52, v53
    v_exp_f32 v56, v56
    v_mfma_f32_32x32x16_bf16 v[208:223], v[120:123], v[88:91], v[208:223]
    v_exp_f32 v57, v57
    v_cvt_pk_bf16_f32 v83, v54, v55
    v_exp_f32 v58, v58
    v_exp_f32 v59, v59
    v_cvt_pk_bf16_f32 v84, v56, v57
    v_exp_f32 v60, v60
    v_mfma_f32_32x32x16_bf16 v[208:223], v[124:127], v[92:95], v[208:223]
    global_load_dwordx4 v[120:123], v4, s[12:13] offset:-2048
    v_exp_f32 v61, v61
    v_cvt_pk_bf16_f32 v85, v58, v59
    v_exp_f32 v62, v62
    v_exp_f32 v63, v63
    v_cvt_pk_bf16_f32 v86, v60, v61
    v_cvt_pk_bf16_f32 v87, v62, v63
    v_mfma_f32_32x32x16_bf16 v[48:63], v[128:131], v[32:35], 0
    s_waitcnt vmcnt(23)
    v_exp_f32 v64, v64
    v_exp_f32 v65, v65
    v_exp_f32 v66, v66
    v_exp_f32 v67, v67
    v_cvt_pk_bf16_f32 v88, v64, v65
    v_exp_f32 v68, v68
    v_mfma_f32_32x32x16_bf16 v[48:63], v[132:135], v[36:39], v[48:63]
    global_load_dwordx4 v[124:127], v4, s[12:13] offset:-1024
    v_exp_f32 v69, v69
    v_cvt_pk_bf16_f32 v89, v66, v67
    v_exp_f32 v70, v70
    v_exp_f32 v71, v71
    v_cvt_pk_bf16_f32 v90, v68, v69
    v_exp_f32 v72, v72
    v_mfma_f32_32x32x16_bf16 v[160:175], v[136:139], v[80:83], v[160:175]
    global_load_dwordx4 a[136:139], v4, s[20:21] offset:1024
    v_exp_f32 v73, v73
    v_cvt_pk_bf16_f32 v91, v70, v71
    v_exp_f32 v74, v74
    v_exp_f32 v75, v75
    v_cvt_pk_bf16_f32 v92, v72, v73
    v_exp_f32 v76, v76
    v_mfma_f32_32x32x16_bf16 v[160:175], v[140:143], v[84:87], v[160:175]
    global_load_dwordx4 a[140:143], v4, s[72:73] offset:1024
    v_exp_f32 v77, v77
    v_cvt_pk_bf16_f32 v93, v74, v75
    v_exp_f32 v78, v78
    v_exp_f32 v79, v79
    v_cvt_pk_bf16_f32 v94, v76, v77
    v_cvt_pk_bf16_f32 v95, v78, v79
    v_mfma_f32_32x32x16_bf16 v[64:79], v[128:131], v[40:43], 0
    v_exp_f32 v48, v48
    v_exp_f32 v49, v49
    v_exp_f32 v50, v50
    v_exp_f32 v51, v51
    v_cvt_pk_bf16_f32 v80, v48, v49
    v_exp_f32 v52, v52
    v_mfma_f32_32x32x16_bf16 v[64:79], v[132:135], v[44:47], v[64:79]
    global_load_dwordx4 a[144:147], v5, s[20:21] offset:0
    v_exp_f32 v53, v53
    v_cvt_pk_bf16_f32 v81, v50, v51
    v_exp_f32 v54, v54
    v_exp_f32 v55, v55
    v_cvt_pk_bf16_f32 v82, v52, v53
    v_exp_f32 v56, v56
    v_mfma_f32_32x32x16_bf16 v[176:191], v[136:139], v[88:91], v[176:191]
    s_waitcnt vmcnt(21)
    v_exp_f32 v57, v57
    v_cvt_pk_bf16_f32 v83, v54, v55
    v_exp_f32 v58, v58
    v_exp_f32 v59, v59
    v_cvt_pk_bf16_f32 v84, v56, v57
    v_exp_f32 v60, v60
    v_mfma_f32_32x32x16_bf16 v[176:191], v[140:143], v[92:95], v[176:191]
    global_load_dwordx4 a[148:151], v5, s[72:73] offset:0
    v_exp_f32 v61, v61
    v_cvt_pk_bf16_f32 v85, v58, v59
    v_exp_f32 v62, v62
    v_exp_f32 v63, v63
    v_cvt_pk_bf16_f32 v86, v60, v61
    v_cvt_pk_bf16_f32 v87, v62, v63
    v_mfma_f32_32x32x16_bf16 v[48:63], v[144:147], v[16:19], 0
    v_exp_f32 v64, v64
    v_exp_f32 v65, v65
    v_exp_f32 v66, v66
    v_exp_f32 v67, v67
    v_cvt_pk_bf16_f32 v88, v64, v65
    v_exp_f32 v68, v68
    v_mfma_f32_32x32x16_bf16 v[48:63], v[148:151], v[20:23], v[48:63]
    global_load_dwordx4 v[128:131], v4, s[6:7] offset:0
    v_exp_f32 v69, v69
    v_cvt_pk_bf16_f32 v89, v66, v67
    v_exp_f32 v70, v70
    v_exp_f32 v71, v71
    v_cvt_pk_bf16_f32 v90, v68, v69
    v_exp_f32 v72, v72
    v_mfma_f32_32x32x16_bf16 v[192:207], v[136:139], v[80:83], v[192:207]
    global_load_dwordx4 a[152:155], v5, s[20:21] offset:1024
    v_exp_f32 v73, v73
    v_cvt_pk_bf16_f32 v91, v70, v71
    v_exp_f32 v74, v74
    v_exp_f32 v75, v75
    v_cvt_pk_bf16_f32 v92, v72, v73
    v_exp_f32 v76, v76
    v_mfma_f32_32x32x16_bf16 v[192:207], v[140:143], v[84:87], v[192:207]
    global_load_dwordx4 v[132:135], v4, s[6:7] offset:1024
    v_exp_f32 v77, v77
    v_cvt_pk_bf16_f32 v93, v74, v75
    v_exp_f32 v78, v78
    v_exp_f32 v79, v79
    v_cvt_pk_bf16_f32 v94, v76, v77
    v_cvt_pk_bf16_f32 v95, v78, v79
    v_mfma_f32_32x32x16_bf16 v[64:79], v[144:147], v[24:27], 0
    global_load_dwordx4 a[156:159], v5, s[72:73] offset:1024
    v_exp_f32 v48, v48
    v_exp_f32 v49, v49
    v_exp_f32 v50, v50
    v_exp_f32 v51, v51
    v_cvt_pk_bf16_f32 v80, v48, v49
    v_exp_f32 v52, v52
    v_mfma_f32_32x32x16_bf16 v[64:79], v[148:151], v[28:31], v[64:79]
    v_exp_f32 v53, v53
    v_cvt_pk_bf16_f32 v81, v50, v51
    v_exp_f32 v54, v54
    v_exp_f32 v55, v55
    v_cvt_pk_bf16_f32 v82, v52, v53
    v_exp_f32 v56, v56
    v_mfma_f32_32x32x16_bf16 v[208:223], v[136:139], v[88:91], v[208:223]
    v_exp_f32 v57, v57
    v_cvt_pk_bf16_f32 v83, v54, v55
    v_exp_f32 v58, v58
    v_exp_f32 v59, v59
    v_cvt_pk_bf16_f32 v84, v56, v57
    v_exp_f32 v60, v60
    v_mfma_f32_32x32x16_bf16 v[208:223], v[140:143], v[92:95], v[208:223]
    global_load_dwordx4 v[136:139], v4, s[12:13] offset:0
    v_exp_f32 v61, v61
    v_cvt_pk_bf16_f32 v85, v58, v59
    v_exp_f32 v62, v62
    v_exp_f32 v63, v63
    v_cvt_pk_bf16_f32 v86, v60, v61
    v_cvt_pk_bf16_f32 v87, v62, v63
    v_mfma_f32_32x32x16_bf16 v[48:63], v[144:147], v[32:35], 0
    s_waitcnt vmcnt(25)
    v_exp_f32 v64, v64
    v_exp_f32 v65, v65
    v_exp_f32 v66, v66
    v_exp_f32 v67, v67
    v_cvt_pk_bf16_f32 v88, v64, v65
    v_exp_f32 v68, v68
    v_mfma_f32_32x32x16_bf16 v[48:63], v[148:151], v[36:39], v[48:63]
    global_load_dwordx4 v[140:143], v4, s[12:13] offset:1024
    v_exp_f32 v69, v69
    v_cvt_pk_bf16_f32 v89, v66, v67
    v_exp_f32 v70, v70
    v_exp_f32 v71, v71
    v_cvt_pk_bf16_f32 v90, v68, v69
    v_exp_f32 v72, v72
    v_mfma_f32_32x32x16_bf16 v[160:175], v[152:155], v[80:83], v[160:175]
    global_load_dwordx4 a[160:163], v6, s[20:21] offset:0
    v_exp_f32 v73, v73
    v_cvt_pk_bf16_f32 v91, v70, v71
    v_exp_f32 v74, v74
    v_exp_f32 v75, v75
    v_cvt_pk_bf16_f32 v92, v72, v73
    v_exp_f32 v76, v76
    v_mfma_f32_32x32x16_bf16 v[160:175], v[156:159], v[84:87], v[160:175]
    global_load_dwordx4 a[164:167], v6, s[72:73] offset:0
    v_exp_f32 v77, v77
    v_cvt_pk_bf16_f32 v93, v74, v75
    v_exp_f32 v78, v78
    v_exp_f32 v79, v79
    v_cvt_pk_bf16_f32 v94, v76, v77
    v_cvt_pk_bf16_f32 v95, v78, v79
    v_mfma_f32_32x32x16_bf16 v[64:79], v[144:147], v[40:43], 0
    global_load_dwordx4 a[168:171], v6, s[20:21] offset:1024
    v_exp_f32 v48, v48
    v_exp_f32 v49, v49
    v_exp_f32 v50, v50
    v_exp_f32 v51, v51
    v_cvt_pk_bf16_f32 v80, v48, v49
    v_exp_f32 v52, v52
    v_mfma_f32_32x32x16_bf16 v[64:79], v[148:151], v[44:47], v[64:79]
    v_exp_f32 v53, v53
    v_cvt_pk_bf16_f32 v81, v50, v51
    v_exp_f32 v54, v54
    v_exp_f32 v55, v55
    v_cvt_pk_bf16_f32 v82, v52, v53
    v_exp_f32 v56, v56
    v_mfma_f32_32x32x16_bf16 v[176:191], v[152:155], v[88:91], v[176:191]
    s_waitcnt vmcnt(27)
    v_exp_f32 v57, v57
    v_cvt_pk_bf16_f32 v83, v54, v55
    v_exp_f32 v58, v58
    v_exp_f32 v59, v59
    v_cvt_pk_bf16_f32 v84, v56, v57
    v_exp_f32 v60, v60
    v_mfma_f32_32x32x16_bf16 v[176:191], v[156:159], v[92:95], v[176:191]
    global_load_dwordx4 a[172:175], v6, s[72:73] offset:1024
    v_exp_f32 v61, v61
    v_cvt_pk_bf16_f32 v85, v58, v59
    v_exp_f32 v62, v62
    v_exp_f32 v63, v63
    v_cvt_pk_bf16_f32 v86, v60, v61
    v_cvt_pk_bf16_f32 v87, v62, v63
    v_mfma_f32_32x32x16_bf16 v[48:63], v[96:99], v[16:19], 0
    v_exp_f32 v64, v64
    v_exp_f32 v65, v65
    v_exp_f32 v66, v66
    v_exp_f32 v67, v67
    v_cvt_pk_bf16_f32 v88, v64, v65
    v_exp_f32 v68, v68
    v_mfma_f32_32x32x16_bf16 v[48:63], v[100:103], v[20:23], v[48:63]
    global_load_dwordx4 v[144:147], v4, s[6:7] offset:2048
    v_exp_f32 v69, v69
    v_cvt_pk_bf16_f32 v89, v66, v67
    v_exp_f32 v70, v70
    v_exp_f32 v71, v71
    v_cvt_pk_bf16_f32 v90, v68, v69
    v_exp_f32 v72, v72
    v_mfma_f32_32x32x16_bf16 v[192:207], v[152:155], v[80:83], v[192:207]
    global_load_dwordx4 a[176:179], v7, s[20:21] offset:0
    v_exp_f32 v73, v73
    v_cvt_pk_bf16_f32 v91, v70, v71
    v_exp_f32 v74, v74
    v_exp_f32 v75, v75
    v_cvt_pk_bf16_f32 v92, v72, v73
    v_exp_f32 v76, v76
    v_mfma_f32_32x32x16_bf16 v[192:207], v[156:159], v[84:87], v[192:207]
    global_load_dwordx4 v[148:151], v4, s[6:7] offset:3072
    v_exp_f32 v77, v77
    v_cvt_pk_bf16_f32 v93, v74, v75
    v_exp_f32 v78, v78
    v_exp_f32 v79, v79
    v_cvt_pk_bf16_f32 v94, v76, v77
    v_cvt_pk_bf16_f32 v95, v78, v79
    v_mfma_f32_32x32x16_bf16 v[64:79], v[96:99], v[24:27], 0
    global_load_dwordx4 a[180:183], v7, s[72:73] offset:0
    v_exp_f32 v48, v48
    v_exp_f32 v49, v49
    v_exp_f32 v50, v50
    v_exp_f32 v51, v51
    v_cvt_pk_bf16_f32 v80, v48, v49
    v_exp_f32 v52, v52
    v_mfma_f32_32x32x16_bf16 v[64:79], v[100:103], v[28:31], v[64:79]
    v_exp_f32 v53, v53
    v_cvt_pk_bf16_f32 v81, v50, v51
    v_exp_f32 v54, v54
    v_exp_f32 v55, v55
    v_cvt_pk_bf16_f32 v82, v52, v53
    v_exp_f32 v56, v56
    v_mfma_f32_32x32x16_bf16 v[208:223], v[152:155], v[88:91], v[208:223]
    global_load_dwordx4 a[184:187], v7, s[20:21] offset:1024
    v_exp_f32 v57, v57
    v_cvt_pk_bf16_f32 v83, v54, v55
    v_exp_f32 v58, v58
    v_exp_f32 v59, v59
    v_cvt_pk_bf16_f32 v84, v56, v57
    v_exp_f32 v60, v60
    v_mfma_f32_32x32x16_bf16 v[208:223], v[156:159], v[92:95], v[208:223]
    global_load_dwordx4 v[152:155], v4, s[12:13] offset:2048
    v_exp_f32 v61, v61
    v_cvt_pk_bf16_f32 v85, v58, v59
    v_exp_f32 v62, v62
    v_exp_f32 v63, v63
    v_cvt_pk_bf16_f32 v86, v60, v61
    v_cvt_pk_bf16_f32 v87, v62, v63
    v_mfma_f32_32x32x16_bf16 v[48:63], v[96:99], v[32:35], 0
    s_waitcnt vmcnt(30)
    v_exp_f32 v64, v64
    v_exp_f32 v65, v65
    v_exp_f32 v66, v66
    v_exp_f32 v67, v67
    v_cvt_pk_bf16_f32 v88, v64, v65
    v_exp_f32 v68, v68
    v_mfma_f32_32x32x16_bf16 v[48:63], v[100:103], v[36:39], v[48:63]
    global_load_dwordx4 v[156:159], v4, s[12:13] offset:3072
    v_exp_f32 v69, v69
    v_cvt_pk_bf16_f32 v89, v66, v67
    v_exp_f32 v70, v70
    v_exp_f32 v71, v71
    v_cvt_pk_bf16_f32 v90, v68, v69
    v_exp_f32 v72, v72
    v_mfma_f32_32x32x16_bf16 v[160:175], v[104:107], v[80:83], v[160:175]
    global_load_dwordx4 a[188:191], v7, s[72:73] offset:1024
    v_exp_f32 v73, v73
    v_cvt_pk_bf16_f32 v91, v70, v71
    v_exp_f32 v74, v74
    v_exp_f32 v75, v75
    v_cvt_pk_bf16_f32 v92, v72, v73
    v_exp_f32 v76, v76
    v_mfma_f32_32x32x16_bf16 v[160:175], v[108:111], v[84:87], v[160:175]
    global_load_dwordx4 a[192:195], v9, s[20:21] offset:0
    v_exp_f32 v77, v77
    v_cvt_pk_bf16_f32 v93, v74, v75
    v_exp_f32 v78, v78
    v_exp_f32 v79, v79
    v_cvt_pk_bf16_f32 v94, v76, v77
    v_cvt_pk_bf16_f32 v95, v78, v79
    v_mfma_f32_32x32x16_bf16 v[64:79], v[96:99], v[40:43], 0
    v_exp_f32 v48, v48
    v_exp_f32 v49, v49
    v_exp_f32 v50, v50
    v_exp_f32 v51, v51
    v_cvt_pk_bf16_f32 v80, v48, v49
    v_exp_f32 v52, v52
    v_mfma_f32_32x32x16_bf16 v[64:79], v[100:103], v[44:47], v[64:79]
    v_exp_f32 v53, v53
    v_cvt_pk_bf16_f32 v81, v50, v51
    v_exp_f32 v54, v54
    v_exp_f32 v55, v55
    v_cvt_pk_bf16_f32 v82, v52, v53
    v_exp_f32 v56, v56
    v_mfma_f32_32x32x16_bf16 v[176:191], v[104:107], v[88:91], v[176:191]
    s_waitcnt vmcnt(27)
    v_exp_f32 v57, v57
    v_cvt_pk_bf16_f32 v83, v54, v55
    v_exp_f32 v58, v58
    v_exp_f32 v59, v59
    v_cvt_pk_bf16_f32 v84, v56, v57
    v_exp_f32 v60, v60
    v_mfma_f32_32x32x16_bf16 v[176:191], v[108:111], v[92:95], v[176:191]
    global_load_dwordx4 a[196:199], v9, s[72:73] offset:0
    v_exp_f32 v61, v61
    v_cvt_pk_bf16_f32 v85, v58, v59
    v_exp_f32 v62, v62
    v_exp_f32 v63, v63
    v_cvt_pk_bf16_f32 v86, v60, v61
    v_cvt_pk_bf16_f32 v87, v62, v63
    v_mfma_f32_32x32x16_bf16 v[48:63], v[112:115], v[16:19], 0
    global_load_dwordx4 a[200:203], v9, s[20:21] offset:1024
    v_exp_f32 v64, v64
    v_exp_f32 v65, v65
    v_exp_f32 v66, v66
    v_exp_f32 v67, v67
    v_cvt_pk_bf16_f32 v88, v64, v65
    v_exp_f32 v68, v68
    v_mfma_f32_32x32x16_bf16 v[48:63], v[116:119], v[20:23], v[48:63]
    global_load_dwordx4 v[96:99], v5, s[6:7] offset:-4096
    v_exp_f32 v69, v69
    v_cvt_pk_bf16_f32 v89, v66, v67
    v_exp_f32 v70, v70
    v_exp_f32 v71, v71
    v_cvt_pk_bf16_f32 v90, v68, v69
    v_exp_f32 v72, v72
    v_mfma_f32_32x32x16_bf16 v[192:207], v[104:107], v[80:83], v[192:207]
    v_exp_f32 v73, v73
    v_cvt_pk_bf16_f32 v91, v70, v71
    v_exp_f32 v74, v74
    v_exp_f32 v75, v75
    v_cvt_pk_bf16_f32 v92, v72, v73
    v_exp_f32 v76, v76
    v_mfma_f32_32x32x16_bf16 v[192:207], v[108:111], v[84:87], v[192:207]
    global_load_dwordx4 v[100:103], v5, s[6:7] offset:-3072
    v_exp_f32 v77, v77
    v_cvt_pk_bf16_f32 v93, v74, v75
    v_exp_f32 v78, v78
    v_exp_f32 v79, v79
    v_cvt_pk_bf16_f32 v94, v76, v77
    v_cvt_pk_bf16_f32 v95, v78, v79
    v_mfma_f32_32x32x16_bf16 v[64:79], v[112:115], v[24:27], 0
    global_load_dwordx4 a[204:207], v9, s[72:73] offset:1024
    v_exp_f32 v48, v48
    v_exp_f32 v49, v49
    v_exp_f32 v50, v50
    v_exp_f32 v51, v51
    v_cvt_pk_bf16_f32 v80, v48, v49
    v_exp_f32 v52, v52
    v_mfma_f32_32x32x16_bf16 v[64:79], v[116:119], v[28:31], v[64:79]
    global_load_dwordx4 a[208:211], v11, s[20:21] offset:0
    v_exp_f32 v53, v53
    v_cvt_pk_bf16_f32 v81, v50, v51
    v_exp_f32 v54, v54
    v_exp_f32 v55, v55
    v_cvt_pk_bf16_f32 v82, v52, v53
    v_exp_f32 v56, v56
    v_mfma_f32_32x32x16_bf16 v[208:223], v[104:107], v[88:91], v[208:223]
    v_exp_f32 v57, v57
    v_cvt_pk_bf16_f32 v83, v54, v55
    v_exp_f32 v58, v58
    v_exp_f32 v59, v59
    v_cvt_pk_bf16_f32 v84, v56, v57
    v_exp_f32 v60, v60
    v_mfma_f32_32x32x16_bf16 v[208:223], v[108:111], v[92:95], v[208:223]
    global_load_dwordx4 v[104:107], v5, s[12:13] offset:-4096
    v_exp_f32 v61, v61
    v_cvt_pk_bf16_f32 v85, v58, v59
    v_exp_f32 v62, v62
    v_exp_f32 v63, v63
    v_cvt_pk_bf16_f32 v86, v60, v61
    v_cvt_pk_bf16_f32 v87, v62, v63
    v_mfma_f32_32x32x16_bf16 v[48:63], v[112:115], v[32:35], 0
    s_waitcnt vmcnt(30)
    v_exp_f32 v64, v64
    v_exp_f32 v65, v65
    v_exp_f32 v66, v66
    v_exp_f32 v67, v67
    v_cvt_pk_bf16_f32 v88, v64, v65
    v_exp_f32 v68, v68
    v_mfma_f32_32x32x16_bf16 v[48:63], v[116:119], v[36:39], v[48:63]
    global_load_dwordx4 v[108:111], v5, s[12:13] offset:-3072
    v_exp_f32 v69, v69
    v_cvt_pk_bf16_f32 v89, v66, v67
    v_exp_f32 v70, v70
    v_exp_f32 v71, v71
    v_cvt_pk_bf16_f32 v90, v68, v69
    v_exp_f32 v72, v72
    v_mfma_f32_32x32x16_bf16 v[160:175], v[120:123], v[80:83], v[160:175]
    global_load_dwordx4 a[212:215], v11, s[72:73] offset:0
    v_exp_f32 v73, v73
    v_cvt_pk_bf16_f32 v91, v70, v71
    v_exp_f32 v74, v74
    v_exp_f32 v75, v75
    v_cvt_pk_bf16_f32 v92, v72, v73
    v_exp_f32 v76, v76
    v_mfma_f32_32x32x16_bf16 v[160:175], v[124:127], v[84:87], v[160:175]
    global_load_dwordx4 a[216:219], v11, s[20:21] offset:1024
    v_exp_f32 v77, v77
    v_cvt_pk_bf16_f32 v93, v74, v75
    v_exp_f32 v78, v78
    v_exp_f32 v79, v79
    v_cvt_pk_bf16_f32 v94, v76, v77
    v_cvt_pk_bf16_f32 v95, v78, v79
    v_mfma_f32_32x32x16_bf16 v[64:79], v[112:115], v[40:43], 0
    v_exp_f32 v48, v48
    v_exp_f32 v49, v49
    v_exp_f32 v50, v50
    v_exp_f32 v51, v51
    v_cvt_pk_bf16_f32 v80, v48, v49
    v_exp_f32 v52, v52
    v_mfma_f32_32x32x16_bf16 v[64:79], v[116:119], v[44:47], v[64:79]
    global_load_dwordx4 a[220:223], v11, s[72:73] offset:1024
    v_exp_f32 v53, v53
    v_cvt_pk_bf16_f32 v81, v50, v51
    v_exp_f32 v54, v54
    v_exp_f32 v55, v55
    v_cvt_pk_bf16_f32 v82, v52, v53
    v_exp_f32 v56, v56
    v_mfma_f32_32x32x16_bf16 v[176:191], v[120:123], v[88:91], v[176:191]
    s_waitcnt vmcnt(27)
    v_exp_f32 v57, v57
    v_cvt_pk_bf16_f32 v83, v54, v55
    v_exp_f32 v58, v58
    v_exp_f32 v59, v59
    v_cvt_pk_bf16_f32 v84, v56, v57
    v_exp_f32 v60, v60
    v_mfma_f32_32x32x16_bf16 v[176:191], v[124:127], v[92:95], v[176:191]
    v_exp_f32 v61, v61
    v_cvt_pk_bf16_f32 v85, v58, v59
    v_exp_f32 v62, v62
    v_exp_f32 v63, v63
    v_cvt_pk_bf16_f32 v86, v60, v61
    v_cvt_pk_bf16_f32 v87, v62, v63
    v_mfma_f32_32x32x16_bf16 v[48:63], v[128:131], v[16:19], 0
    global_load_dwordx4 a[224:227], v1, s[60:61] offset:0
    v_exp_f32 v64, v64
    v_exp_f32 v65, v65
    v_exp_f32 v66, v66
    v_exp_f32 v67, v67
    v_cvt_pk_bf16_f32 v88, v64, v65
    v_exp_f32 v68, v68
    v_mfma_f32_32x32x16_bf16 v[48:63], v[132:135], v[20:23], v[48:63]
    global_load_dwordx4 v[112:115], v5, s[6:7] offset:-2048
    v_exp_f32 v69, v69
    v_cvt_pk_bf16_f32 v89, v66, v67
    v_exp_f32 v70, v70
    v_exp_f32 v71, v71
    v_cvt_pk_bf16_f32 v90, v68, v69
    v_exp_f32 v72, v72
    v_mfma_f32_32x32x16_bf16 v[192:207], v[120:123], v[80:83], v[192:207]
    global_load_dwordx4 a[228:231], v1, s[64:65] offset:0
    v_exp_f32 v73, v73
    v_cvt_pk_bf16_f32 v91, v70, v71
    v_exp_f32 v74, v74
    v_exp_f32 v75, v75
    v_cvt_pk_bf16_f32 v92, v72, v73
    v_exp_f32 v76, v76
    v_mfma_f32_32x32x16_bf16 v[192:207], v[124:127], v[84:87], v[192:207]
    global_load_dwordx4 v[116:119], v5, s[6:7] offset:-1024
    v_exp_f32 v77, v77
    v_cvt_pk_bf16_f32 v93, v74, v75
    v_exp_f32 v78, v78
    v_exp_f32 v79, v79
    v_cvt_pk_bf16_f32 v94, v76, v77
    v_cvt_pk_bf16_f32 v95, v78, v79
    v_mfma_f32_32x32x16_bf16 v[64:79], v[128:131], v[24:27], 0
    v_exp_f32 v48, v48
    v_exp_f32 v49, v49
    v_exp_f32 v50, v50
    v_exp_f32 v51, v51
    v_cvt_pk_bf16_f32 v80, v48, v49
    v_exp_f32 v52, v52
    v_mfma_f32_32x32x16_bf16 v[64:79], v[132:135], v[28:31], v[64:79]
    global_load_dwordx4 a[232:235], v1, s[60:61] offset:1024
    v_exp_f32 v53, v53
    v_cvt_pk_bf16_f32 v81, v50, v51
    v_exp_f32 v54, v54
    v_exp_f32 v55, v55
    v_cvt_pk_bf16_f32 v82, v52, v53
    v_exp_f32 v56, v56
    v_mfma_f32_32x32x16_bf16 v[208:223], v[120:123], v[88:91], v[208:223]
    v_exp_f32 v57, v57
    v_cvt_pk_bf16_f32 v83, v54, v55
    v_exp_f32 v58, v58
    v_exp_f32 v59, v59
    v_cvt_pk_bf16_f32 v84, v56, v57
    v_exp_f32 v60, v60
    v_mfma_f32_32x32x16_bf16 v[208:223], v[124:127], v[92:95], v[208:223]
    global_load_dwordx4 v[120:123], v5, s[12:13] offset:-2048
    v_exp_f32 v61, v61
    v_cvt_pk_bf16_f32 v85, v58, v59
    v_exp_f32 v62, v62
    v_exp_f32 v63, v63
    v_cvt_pk_bf16_f32 v86, v60, v61
    v_cvt_pk_bf16_f32 v87, v62, v63
    v_mfma_f32_32x32x16_bf16 v[48:63], v[128:131], v[32:35], 0
    s_waitcnt vmcnt(30)
    v_exp_f32 v64, v64
    v_exp_f32 v65, v65
    v_exp_f32 v66, v66
    v_exp_f32 v67, v67
    v_cvt_pk_bf16_f32 v88, v64, v65
    v_exp_f32 v68, v68
    v_mfma_f32_32x32x16_bf16 v[48:63], v[132:135], v[36:39], v[48:63]
    global_load_dwordx4 v[124:127], v5, s[12:13] offset:-1024
    v_exp_f32 v69, v69
    v_cvt_pk_bf16_f32 v89, v66, v67
    v_exp_f32 v70, v70
    v_exp_f32 v71, v71
    v_cvt_pk_bf16_f32 v90, v68, v69
    v_exp_f32 v72, v72
    v_mfma_f32_32x32x16_bf16 v[160:175], v[136:139], v[80:83], v[160:175]
    global_load_dwordx4 a[236:239], v1, s[64:65] offset:1024
    v_exp_f32 v73, v73
    v_cvt_pk_bf16_f32 v91, v70, v71
    v_exp_f32 v74, v74
    v_exp_f32 v75, v75
    v_cvt_pk_bf16_f32 v92, v72, v73
    v_exp_f32 v76, v76
    v_mfma_f32_32x32x16_bf16 v[160:175], v[140:143], v[84:87], v[160:175]
    global_load_dwordx4 a[240:243], v4, s[60:61] offset:0
    v_exp_f32 v77, v77
    v_cvt_pk_bf16_f32 v93, v74, v75
    v_exp_f32 v78, v78
    v_exp_f32 v79, v79
    v_cvt_pk_bf16_f32 v94, v76, v77
    v_cvt_pk_bf16_f32 v95, v78, v79
    v_mfma_f32_32x32x16_bf16 v[64:79], v[128:131], v[40:43], 0
    global_load_dwordx4 a[244:247], v4, s[64:65] offset:0
    v_exp_f32 v48, v48
    v_exp_f32 v49, v49
    v_exp_f32 v50, v50
    v_exp_f32 v51, v51
    v_cvt_pk_bf16_f32 v80, v48, v49
    v_exp_f32 v52, v52
    v_mfma_f32_32x32x16_bf16 v[64:79], v[132:135], v[44:47], v[64:79]
    v_exp_f32 v53, v53
    v_cvt_pk_bf16_f32 v81, v50, v51
    v_exp_f32 v54, v54
    v_exp_f32 v55, v55
    v_cvt_pk_bf16_f32 v82, v52, v53
    v_exp_f32 v56, v56
    v_mfma_f32_32x32x16_bf16 v[176:191], v[136:139], v[88:91], v[176:191]
    s_waitcnt vmcnt(27)
    v_exp_f32 v57, v57
    v_cvt_pk_bf16_f32 v83, v54, v55
    v_exp_f32 v58, v58
    v_exp_f32 v59, v59
    v_cvt_pk_bf16_f32 v84, v56, v57
    v_exp_f32 v60, v60
    v_mfma_f32_32x32x16_bf16 v[176:191], v[140:143], v[92:95], v[176:191]
    global_load_dwordx4 a[248:251], v4, s[60:61] offset:1024
    v_exp_f32 v61, v61
    v_cvt_pk_bf16_f32 v85, v58, v59
    v_exp_f32 v62, v62
    v_exp_f32 v63, v63
    v_cvt_pk_bf16_f32 v86, v60, v61
    v_cvt_pk_bf16_f32 v87, v62, v63
    v_mfma_f32_32x32x16_bf16 v[48:63], v[144:147], v[16:19], 0
    v_exp_f32 v64, v64
    v_exp_f32 v65, v65
    v_exp_f32 v66, v66
    v_exp_f32 v67, v67
    v_cvt_pk_bf16_f32 v88, v64, v65
    v_exp_f32 v68, v68
    v_mfma_f32_32x32x16_bf16 v[48:63], v[148:151], v[20:23], v[48:63]
    global_load_dwordx4 v[128:131], v5, s[6:7] offset:0
    v_exp_f32 v69, v69
    v_cvt_pk_bf16_f32 v89, v66, v67
    v_exp_f32 v70, v70
    v_exp_f32 v71, v71
    v_cvt_pk_bf16_f32 v90, v68, v69
    v_exp_f32 v72, v72
    v_mfma_f32_32x32x16_bf16 v[192:207], v[136:139], v[80:83], v[192:207]
    global_load_dwordx4 a[252:255], v4, s[64:65] offset:1024
    v_exp_f32 v73, v73
    v_cvt_pk_bf16_f32 v91, v70, v71
    v_exp_f32 v74, v74
    v_exp_f32 v75, v75
    v_cvt_pk_bf16_f32 v92, v72, v73
    v_exp_f32 v76, v76
    v_mfma_f32_32x32x16_bf16 v[192:207], v[140:143], v[84:87], v[192:207]
    global_load_dwordx4 v[132:135], v5, s[6:7] offset:1024
    v_exp_f32 v77, v77
    v_cvt_pk_bf16_f32 v93, v74, v75
    v_exp_f32 v78, v78
    v_exp_f32 v79, v79
    v_cvt_pk_bf16_f32 v94, v76, v77
    v_cvt_pk_bf16_f32 v95, v78, v79
    v_mfma_f32_32x32x16_bf16 v[64:79], v[144:147], v[24:27], 0
    global_load_dwordx4 a[0:3], v1, s[14:15] offset:-4096
    v_exp_f32 v48, v48
    v_exp_f32 v49, v49
    v_exp_f32 v50, v50
    v_exp_f32 v51, v51
    v_cvt_pk_bf16_f32 v80, v48, v49
    v_exp_f32 v52, v52
    v_mfma_f32_32x32x16_bf16 v[64:79], v[148:151], v[28:31], v[64:79]
    v_exp_f32 v53, v53
    v_cvt_pk_bf16_f32 v81, v50, v51
    v_exp_f32 v54, v54
    v_exp_f32 v55, v55
    v_cvt_pk_bf16_f32 v82, v52, v53
    v_exp_f32 v56, v56
    v_mfma_f32_32x32x16_bf16 v[208:223], v[136:139], v[88:91], v[208:223]
    global_load_dwordx4 a[4:7], v1, s[14:15] offset:-3072
    v_exp_f32 v57, v57
    v_cvt_pk_bf16_f32 v83, v54, v55
    v_exp_f32 v58, v58
    v_exp_f32 v59, v59
    v_cvt_pk_bf16_f32 v84, v56, v57
    v_exp_f32 v60, v60
    v_mfma_f32_32x32x16_bf16 v[208:223], v[140:143], v[92:95], v[208:223]
    global_load_dwordx4 v[136:139], v5, s[12:13] offset:0
    v_exp_f32 v61, v61
    v_cvt_pk_bf16_f32 v85, v58, v59
    v_exp_f32 v62, v62
    v_exp_f32 v63, v63
    v_cvt_pk_bf16_f32 v86, v60, v61
    v_cvt_pk_bf16_f32 v87, v62, v63
    v_mfma_f32_32x32x16_bf16 v[48:63], v[144:147], v[32:35], 0
    s_waitcnt vmcnt(30)
    v_exp_f32 v64, v64
    v_exp_f32 v65, v65
    v_exp_f32 v66, v66
    v_exp_f32 v67, v67
    v_cvt_pk_bf16_f32 v88, v64, v65
    v_exp_f32 v68, v68
    v_mfma_f32_32x32x16_bf16 v[48:63], v[148:151], v[36:39], v[48:63]
    global_load_dwordx4 v[140:143], v5, s[12:13] offset:1024
    v_exp_f32 v69, v69
    v_cvt_pk_bf16_f32 v89, v66, v67
    v_exp_f32 v70, v70
    v_exp_f32 v71, v71
    v_cvt_pk_bf16_f32 v90, v68, v69
    v_exp_f32 v72, v72
    v_mfma_f32_32x32x16_bf16 v[160:175], v[152:155], v[80:83], v[160:175]
    global_load_dwordx4 a[8:11], v1, s[14:15] offset:-2048
    v_exp_f32 v73, v73
    v_cvt_pk_bf16_f32 v91, v70, v71
    v_exp_f32 v74, v74
    v_exp_f32 v75, v75
    v_cvt_pk_bf16_f32 v92, v72, v73
    v_exp_f32 v76, v76
    v_mfma_f32_32x32x16_bf16 v[160:175], v[156:159], v[84:87], v[160:175]
    global_load_dwordx4 a[12:15], v1, s[14:15] offset:-1024
    v_exp_f32 v77, v77
    v_cvt_pk_bf16_f32 v93, v74, v75
    v_exp_f32 v78, v78
    v_exp_f32 v79, v79
    v_cvt_pk_bf16_f32 v94, v76, v77
    v_cvt_pk_bf16_f32 v95, v78, v79
    v_mfma_f32_32x32x16_bf16 v[64:79], v[144:147], v[40:43], 0
    v_exp_f32 v48, v48
    v_exp_f32 v49, v49
    v_exp_f32 v50, v50
    v_exp_f32 v51, v51
    v_cvt_pk_bf16_f32 v80, v48, v49
    v_exp_f32 v52, v52
    v_mfma_f32_32x32x16_bf16 v[64:79], v[148:151], v[44:47], v[64:79]
    v_exp_f32 v53, v53
    v_cvt_pk_bf16_f32 v81, v50, v51
    v_exp_f32 v54, v54
    v_exp_f32 v55, v55
    v_cvt_pk_bf16_f32 v82, v52, v53
    v_exp_f32 v56, v56
    v_mfma_f32_32x32x16_bf16 v[176:191], v[152:155], v[88:91], v[176:191]
    s_waitcnt vmcnt(27)
    v_exp_f32 v57, v57
    v_cvt_pk_bf16_f32 v83, v54, v55
    v_exp_f32 v58, v58
    v_exp_f32 v59, v59
    v_cvt_pk_bf16_f32 v84, v56, v57
    v_exp_f32 v60, v60
    v_mfma_f32_32x32x16_bf16 v[176:191], v[156:159], v[92:95], v[176:191]
    global_load_dwordx4 a[16:19], v1, s[14:15] offset:0
    v_exp_f32 v61, v61
    v_cvt_pk_bf16_f32 v85, v58, v59
    v_exp_f32 v62, v62
    v_exp_f32 v63, v63
    v_cvt_pk_bf16_f32 v86, v60, v61
    v_cvt_pk_bf16_f32 v87, v62, v63
    v_mfma_f32_32x32x16_bf16 v[48:63], v[96:99], v[16:19], 0
    global_load_dwordx4 a[20:23], v1, s[14:15] offset:1024
    v_exp_f32 v64, v64
    v_exp_f32 v65, v65
    v_exp_f32 v66, v66
    v_exp_f32 v67, v67
    v_cvt_pk_bf16_f32 v88, v64, v65
    v_exp_f32 v68, v68
    v_mfma_f32_32x32x16_bf16 v[48:63], v[100:103], v[20:23], v[48:63]
    global_load_dwordx4 v[144:147], v5, s[6:7] offset:2048
    v_exp_f32 v69, v69
    v_cvt_pk_bf16_f32 v89, v66, v67
    v_exp_f32 v70, v70
    v_exp_f32 v71, v71
    v_cvt_pk_bf16_f32 v90, v68, v69
    v_exp_f32 v72, v72
    v_mfma_f32_32x32x16_bf16 v[192:207], v[152:155], v[80:83], v[192:207]
    v_exp_f32 v73, v73
    v_cvt_pk_bf16_f32 v91, v70, v71
    v_exp_f32 v74, v74
    v_exp_f32 v75, v75
    v_cvt_pk_bf16_f32 v92, v72, v73
    v_exp_f32 v76, v76
    v_mfma_f32_32x32x16_bf16 v[192:207], v[156:159], v[84:87], v[192:207]
    global_load_dwordx4 v[148:151], v5, s[6:7] offset:3072
    v_exp_f32 v77, v77
    v_cvt_pk_bf16_f32 v93, v74, v75
    v_exp_f32 v78, v78
    v_exp_f32 v79, v79
    v_cvt_pk_bf16_f32 v94, v76, v77
    v_cvt_pk_bf16_f32 v95, v78, v79
    v_mfma_f32_32x32x16_bf16 v[64:79], v[96:99], v[24:27], 0
    global_load_dwordx4 a[24:27], v1, s[14:15] offset:2048
    v_exp_f32 v48, v48
    v_exp_f32 v49, v49
    v_exp_f32 v50, v50
    v_exp_f32 v51, v51
    v_cvt_pk_bf16_f32 v80, v48, v49
    v_exp_f32 v52, v52
    v_mfma_f32_32x32x16_bf16 v[64:79], v[100:103], v[28:31], v[64:79]
    v_exp_f32 v53, v53
    v_cvt_pk_bf16_f32 v81, v50, v51
    v_exp_f32 v54, v54
    v_exp_f32 v55, v55
    v_cvt_pk_bf16_f32 v82, v52, v53
    v_exp_f32 v56, v56
    v_mfma_f32_32x32x16_bf16 v[208:223], v[152:155], v[88:91], v[208:223]
    global_load_dwordx4 a[28:31], v1, s[14:15] offset:3072
    v_exp_f32 v57, v57
    v_cvt_pk_bf16_f32 v83, v54, v55
    v_exp_f32 v58, v58
    v_exp_f32 v59, v59
    v_cvt_pk_bf16_f32 v84, v56, v57
    v_exp_f32 v60, v60
    v_mfma_f32_32x32x16_bf16 v[208:223], v[156:159], v[92:95], v[208:223]
    global_load_dwordx4 v[152:155], v5, s[12:13] offset:2048
    v_exp_f32 v61, v61
    v_cvt_pk_bf16_f32 v85, v58, v59
    v_exp_f32 v62, v62
    v_exp_f32 v63, v63
    v_cvt_pk_bf16_f32 v86, v60, v61
    v_cvt_pk_bf16_f32 v87, v62, v63
    v_mfma_f32_32x32x16_bf16 v[48:63], v[96:99], v[32:35], 0
    s_waitcnt vmcnt(30)
    v_exp_f32 v64, v64
    v_exp_f32 v65, v65
    v_exp_f32 v66, v66
    v_exp_f32 v67, v67
    v_cvt_pk_bf16_f32 v88, v64, v65
    v_exp_f32 v68, v68
    v_mfma_f32_32x32x16_bf16 v[48:63], v[100:103], v[36:39], v[48:63]
    global_load_dwordx4 v[156:159], v5, s[12:13] offset:3072
    v_exp_f32 v69, v69
    v_cvt_pk_bf16_f32 v89, v66, v67
    v_exp_f32 v70, v70
    v_exp_f32 v71, v71
    v_cvt_pk_bf16_f32 v90, v68, v69
    v_exp_f32 v72, v72
    v_mfma_f32_32x32x16_bf16 v[160:175], v[104:107], v[80:83], v[160:175]
    global_load_dwordx4 a[32:35], v4, s[14:15] offset:-4096
    v_exp_f32 v73, v73
    v_cvt_pk_bf16_f32 v91, v70, v71
    v_exp_f32 v74, v74
    v_exp_f32 v75, v75
    v_cvt_pk_bf16_f32 v92, v72, v73
    v_exp_f32 v76, v76
    v_mfma_f32_32x32x16_bf16 v[160:175], v[108:111], v[84:87], v[160:175]
    global_load_dwordx4 a[36:39], v4, s[14:15] offset:-3072
    v_exp_f32 v77, v77
    v_cvt_pk_bf16_f32 v93, v74, v75
    v_exp_f32 v78, v78
    v_exp_f32 v79, v79
    v_cvt_pk_bf16_f32 v94, v76, v77
    v_cvt_pk_bf16_f32 v95, v78, v79
    v_mfma_f32_32x32x16_bf16 v[64:79], v[96:99], v[40:43], 0
    v_exp_f32 v48, v48
    v_exp_f32 v49, v49
    v_exp_f32 v50, v50
    v_exp_f32 v51, v51
    v_cvt_pk_bf16_f32 v80, v48, v49
    v_exp_f32 v52, v52
    v_mfma_f32_32x32x16_bf16 v[64:79], v[100:103], v[44:47], v[64:79]
    global_load_dwordx4 a[40:43], v4, s[14:15] offset:-2048
    v_exp_f32 v53, v53
    v_cvt_pk_bf16_f32 v81, v50, v51
    v_exp_f32 v54, v54
    v_exp_f32 v55, v55
    v_cvt_pk_bf16_f32 v82, v52, v53
    v_exp_f32 v56, v56
    v_mfma_f32_32x32x16_bf16 v[176:191], v[104:107], v[88:91], v[176:191]
    s_waitcnt vmcnt(27)
    v_exp_f32 v57, v57
    v_cvt_pk_bf16_f32 v83, v54, v55
    v_exp_f32 v58, v58
    v_exp_f32 v59, v59
    v_cvt_pk_bf16_f32 v84, v56, v57
    v_exp_f32 v60, v60
    v_mfma_f32_32x32x16_bf16 v[176:191], v[108:111], v[92:95], v[176:191]
    v_exp_f32 v61, v61
    v_cvt_pk_bf16_f32 v85, v58, v59
    v_exp_f32 v62, v62
    v_exp_f32 v63, v63
    v_cvt_pk_bf16_f32 v86, v60, v61
    v_cvt_pk_bf16_f32 v87, v62, v63
    v_mfma_f32_32x32x16_bf16 v[48:63], v[112:115], v[16:19], 0
    global_load_dwordx4 a[44:47], v4, s[14:15] offset:-1024
    v_exp_f32 v64, v64
    v_exp_f32 v65, v65
    v_exp_f32 v66, v66
    v_exp_f32 v67, v67
    v_cvt_pk_bf16_f32 v88, v64, v65
    v_exp_f32 v68, v68
    v_mfma_f32_32x32x16_bf16 v[48:63], v[116:119], v[20:23], v[48:63]
    global_load_dwordx4 v[96:99], v6, s[6:7] offset:-4096
    v_exp_f32 v69, v69
    v_cvt_pk_bf16_f32 v89, v66, v67
    v_exp_f32 v70, v70
    v_exp_f32 v71, v71
    v_cvt_pk_bf16_f32 v90, v68, v69
    v_exp_f32 v72, v72
    v_mfma_f32_32x32x16_bf16 v[192:207], v[104:107], v[80:83], v[192:207]
    global_load_dwordx4 a[48:51], v4, s[14:15] offset:0
    v_exp_f32 v73, v73
    v_cvt_pk_bf16_f32 v91, v70, v71
    v_exp_f32 v74, v74
    v_exp_f32 v75, v75
    v_cvt_pk_bf16_f32 v92, v72, v73
    v_exp_f32 v76, v76
    v_mfma_f32_32x32x16_bf16 v[192:207], v[108:111], v[84:87], v[192:207]
    global_load_dwordx4 v[100:103], v6, s[6:7] offset:-3072
    v_exp_f32 v77, v77
    v_cvt_pk_bf16_f32 v93, v74, v75
    v_exp_f32 v78, v78
    v_exp_f32 v79, v79
    v_cvt_pk_bf16_f32 v94, v76, v77
    v_cvt_pk_bf16_f32 v95, v78, v79
    v_mfma_f32_32x32x16_bf16 v[64:79], v[112:115], v[24:27], 0
    v_exp_f32 v48, v48
    v_exp_f32 v49, v49
    v_exp_f32 v50, v50
    v_exp_f32 v51, v51
    v_cvt_pk_bf16_f32 v80, v48, v49
    v_exp_f32 v52, v52
    v_mfma_f32_32x32x16_bf16 v[64:79], v[116:119], v[28:31], v[64:79]
    global_load_dwordx4 a[52:55], v4, s[14:15] offset:1024
    v_exp_f32 v53, v53
    v_cvt_pk_bf16_f32 v81, v50, v51
    v_exp_f32 v54, v54
    v_exp_f32 v55, v55
    v_cvt_pk_bf16_f32 v82, v52, v53
    v_exp_f32 v56, v56
    v_mfma_f32_32x32x16_bf16 v[208:223], v[104:107], v[88:91], v[208:223]
    v_exp_f32 v57, v57
    v_cvt_pk_bf16_f32 v83, v54, v55
    v_exp_f32 v58, v58
    v_exp_f32 v59, v59
    v_cvt_pk_bf16_f32 v84, v56, v57
    v_exp_f32 v60, v60
    v_mfma_f32_32x32x16_bf16 v[208:223], v[108:111], v[92:95], v[208:223]
    global_load_dwordx4 v[104:107], v6, s[12:13] offset:-4096
    v_exp_f32 v61, v61
    v_cvt_pk_bf16_f32 v85, v58, v59
    v_exp_f32 v62, v62
    v_exp_f32 v63, v63
    v_cvt_pk_bf16_f32 v86, v60, v61
    v_cvt_pk_bf16_f32 v87, v62, v63
    v_mfma_f32_32x32x16_bf16 v[48:63], v[112:115], v[32:35], 0
    s_waitcnt vmcnt(30)
    v_exp_f32 v64, v64
    v_exp_f32 v65, v65
    v_exp_f32 v66, v66
    v_exp_f32 v67, v67
    v_cvt_pk_bf16_f32 v88, v64, v65
    v_exp_f32 v68, v68
    v_mfma_f32_32x32x16_bf16 v[48:63], v[116:119], v[36:39], v[48:63]
    global_load_dwordx4 v[108:111], v6, s[12:13] offset:-3072
    v_exp_f32 v69, v69
    v_cvt_pk_bf16_f32 v89, v66, v67
    v_exp_f32 v70, v70
    v_exp_f32 v71, v71
    v_cvt_pk_bf16_f32 v90, v68, v69
    v_exp_f32 v72, v72
    v_mfma_f32_32x32x16_bf16 v[160:175], v[120:123], v[80:83], v[160:175]
    global_load_dwordx4 a[56:59], v4, s[14:15] offset:2048
    v_exp_f32 v73, v73
    v_cvt_pk_bf16_f32 v91, v70, v71
    v_exp_f32 v74, v74
    v_exp_f32 v75, v75
    v_cvt_pk_bf16_f32 v92, v72, v73
    v_exp_f32 v76, v76
    v_mfma_f32_32x32x16_bf16 v[160:175], v[124:127], v[84:87], v[160:175]
    global_load_dwordx4 a[60:63], v4, s[14:15] offset:3072
    v_exp_f32 v77, v77
    v_cvt_pk_bf16_f32 v93, v74, v75
    v_exp_f32 v78, v78
    v_exp_f32 v79, v79
    v_cvt_pk_bf16_f32 v94, v76, v77
    v_cvt_pk_bf16_f32 v95, v78, v79
    v_mfma_f32_32x32x16_bf16 v[64:79], v[112:115], v[40:43], 0
    global_load_dwordx4 a[64:67], v5, s[14:15] offset:-4096
    v_exp_f32 v48, v48
    v_exp_f32 v49, v49
    v_exp_f32 v50, v50
    v_exp_f32 v51, v51
    v_cvt_pk_bf16_f32 v80, v48, v49
    v_exp_f32 v52, v52
    v_mfma_f32_32x32x16_bf16 v[64:79], v[116:119], v[44:47], v[64:79]
    v_exp_f32 v53, v53
    v_cvt_pk_bf16_f32 v81, v50, v51
    v_exp_f32 v54, v54
    v_exp_f32 v55, v55
    v_cvt_pk_bf16_f32 v82, v52, v53
    v_exp_f32 v56, v56
    v_mfma_f32_32x32x16_bf16 v[176:191], v[120:123], v[88:91], v[176:191]
    s_waitcnt vmcnt(27)
    v_exp_f32 v57, v57
    v_cvt_pk_bf16_f32 v83, v54, v55
    v_exp_f32 v58, v58
    v_exp_f32 v59, v59
    v_cvt_pk_bf16_f32 v84, v56, v57
    v_exp_f32 v60, v60
    v_mfma_f32_32x32x16_bf16 v[176:191], v[124:127], v[92:95], v[176:191]
    global_load_dwordx4 a[68:71], v5, s[14:15] offset:-3072
    v_exp_f32 v61, v61
    v_cvt_pk_bf16_f32 v85, v58, v59
    v_exp_f32 v62, v62
    v_exp_f32 v63, v63
    v_cvt_pk_bf16_f32 v86, v60, v61
    v_cvt_pk_bf16_f32 v87, v62, v63
    v_mfma_f32_32x32x16_bf16 v[48:63], v[128:131], v[16:19], 0
    v_exp_f32 v64, v64
    v_exp_f32 v65, v65
    v_exp_f32 v66, v66
    v_exp_f32 v67, v67
    v_cvt_pk_bf16_f32 v88, v64, v65
    v_exp_f32 v68, v68
    v_mfma_f32_32x32x16_bf16 v[48:63], v[132:135], v[20:23], v[48:63]
    global_load_dwordx4 v[112:115], v6, s[6:7] offset:-2048
    v_exp_f32 v69, v69
    v_cvt_pk_bf16_f32 v89, v66, v67
    v_exp_f32 v70, v70
    v_exp_f32 v71, v71
    v_cvt_pk_bf16_f32 v90, v68, v69
    v_exp_f32 v72, v72
    v_mfma_f32_32x32x16_bf16 v[192:207], v[120:123], v[80:83], v[192:207]
    global_load_dwordx4 a[72:75], v5, s[14:15] offset:-2048
    v_exp_f32 v73, v73
    v_cvt_pk_bf16_f32 v91, v70, v71
    v_exp_f32 v74, v74
    v_exp_f32 v75, v75
    v_cvt_pk_bf16_f32 v92, v72, v73
    v_exp_f32 v76, v76
    v_mfma_f32_32x32x16_bf16 v[192:207], v[124:127], v[84:87], v[192:207]
    global_load_dwordx4 v[116:119], v6, s[6:7] offset:-1024
    v_exp_f32 v77, v77
    v_cvt_pk_bf16_f32 v93, v74, v75
    v_exp_f32 v78, v78
    v_exp_f32 v79, v79
    v_cvt_pk_bf16_f32 v94, v76, v77
    v_cvt_pk_bf16_f32 v95, v78, v79
    v_mfma_f32_32x32x16_bf16 v[64:79], v[128:131], v[24:27], 0
    global_load_dwordx4 a[76:79], v5, s[14:15] offset:-1024
    v_exp_f32 v48, v48
    v_exp_f32 v49, v49
    v_exp_f32 v50, v50
    v_exp_f32 v51, v51
    v_cvt_pk_bf16_f32 v80, v48, v49
    v_exp_f32 v52, v52
    v_mfma_f32_32x32x16_bf16 v[64:79], v[132:135], v[28:31], v[64:79]
    v_exp_f32 v53, v53
    v_cvt_pk_bf16_f32 v81, v50, v51
    v_exp_f32 v54, v54
    v_exp_f32 v55, v55
    v_cvt_pk_bf16_f32 v82, v52, v53
    v_exp_f32 v56, v56
    v_mfma_f32_32x32x16_bf16 v[208:223], v[120:123], v[88:91], v[208:223]
    global_load_dwordx4 a[80:83], v5, s[14:15] offset:0
    v_exp_f32 v57, v57
    v_cvt_pk_bf16_f32 v83, v54, v55
    v_exp_f32 v58, v58
    v_exp_f32 v59, v59
    v_cvt_pk_bf16_f32 v84, v56, v57
    v_exp_f32 v60, v60
    v_mfma_f32_32x32x16_bf16 v[208:223], v[124:127], v[92:95], v[208:223]
    global_load_dwordx4 v[120:123], v6, s[12:13] offset:-2048
    v_exp_f32 v61, v61
    v_cvt_pk_bf16_f32 v85, v58, v59
    v_exp_f32 v62, v62
    v_exp_f32 v63, v63
    v_cvt_pk_bf16_f32 v86, v60, v61
    v_cvt_pk_bf16_f32 v87, v62, v63
    v_mfma_f32_32x32x16_bf16 v[48:63], v[128:131], v[32:35], 0
    s_waitcnt vmcnt(30)
    v_exp_f32 v64, v64
    v_exp_f32 v65, v65
    v_exp_f32 v66, v66
    v_exp_f32 v67, v67
    v_cvt_pk_bf16_f32 v88, v64, v65
    v_exp_f32 v68, v68
    v_mfma_f32_32x32x16_bf16 v[48:63], v[132:135], v[36:39], v[48:63]
    global_load_dwordx4 v[124:127], v6, s[12:13] offset:-1024
    v_exp_f32 v69, v69
    v_cvt_pk_bf16_f32 v89, v66, v67
    v_exp_f32 v70, v70
    v_exp_f32 v71, v71
    v_cvt_pk_bf16_f32 v90, v68, v69
    v_exp_f32 v72, v72
    v_mfma_f32_32x32x16_bf16 v[160:175], v[136:139], v[80:83], v[160:175]
    global_load_dwordx4 a[84:87], v5, s[14:15] offset:1024
    v_exp_f32 v73, v73
    v_cvt_pk_bf16_f32 v91, v70, v71
    v_exp_f32 v74, v74
    v_exp_f32 v75, v75
    v_cvt_pk_bf16_f32 v92, v72, v73
    v_exp_f32 v76, v76
    v_mfma_f32_32x32x16_bf16 v[160:175], v[140:143], v[84:87], v[160:175]
    v_exp_f32 v77, v77
    v_cvt_pk_bf16_f32 v93, v74, v75
    v_exp_f32 v78, v78
    v_exp_f32 v79, v79
    v_cvt_pk_bf16_f32 v94, v76, v77
    v_cvt_pk_bf16_f32 v95, v78, v79
    v_mfma_f32_32x32x16_bf16 v[64:79], v[128:131], v[40:43], 0
    global_load_dwordx4 a[88:91], v5, s[14:15] offset:2048
    v_exp_f32 v48, v48
    v_exp_f32 v49, v49
    v_exp_f32 v50, v50
    v_exp_f32 v51, v51
    v_cvt_pk_bf16_f32 v80, v48, v49
    v_exp_f32 v52, v52
    v_mfma_f32_32x32x16_bf16 v[64:79], v[132:135], v[44:47], v[64:79]
    v_exp_f32 v53, v53
    v_cvt_pk_bf16_f32 v81, v50, v51
    v_exp_f32 v54, v54
    v_exp_f32 v55, v55
    v_cvt_pk_bf16_f32 v82, v52, v53
    v_exp_f32 v56, v56
    v_mfma_f32_32x32x16_bf16 v[176:191], v[136:139], v[88:91], v[176:191]
    s_waitcnt vmcnt(27)
    v_exp_f32 v57, v57
    v_cvt_pk_bf16_f32 v83, v54, v55
    v_exp_f32 v58, v58
    v_exp_f32 v59, v59
    v_cvt_pk_bf16_f32 v84, v56, v57
    v_exp_f32 v60, v60
    v_mfma_f32_32x32x16_bf16 v[176:191], v[140:143], v[92:95], v[176:191]
    global_load_dwordx4 a[92:95], v5, s[14:15] offset:3072
    v_exp_f32 v61, v61
    v_cvt_pk_bf16_f32 v85, v58, v59
    v_exp_f32 v62, v62
    v_exp_f32 v63, v63
    v_cvt_pk_bf16_f32 v86, v60, v61
    v_cvt_pk_bf16_f32 v87, v62, v63
    v_mfma_f32_32x32x16_bf16 v[48:63], v[144:147], v[16:19], 0
    v_exp_f32 v64, v64
    v_exp_f32 v65, v65
    v_exp_f32 v66, v66
    v_exp_f32 v67, v67
    v_cvt_pk_bf16_f32 v88, v64, v65
    v_exp_f32 v68, v68
    v_mfma_f32_32x32x16_bf16 v[48:63], v[148:151], v[20:23], v[48:63]
    global_load_dwordx4 v[128:131], v6, s[6:7] offset:0
    v_exp_f32 v69, v69
    v_cvt_pk_bf16_f32 v89, v66, v67
    v_exp_f32 v70, v70
    v_exp_f32 v71, v71
    v_cvt_pk_bf16_f32 v90, v68, v69
    v_exp_f32 v72, v72
    v_mfma_f32_32x32x16_bf16 v[192:207], v[136:139], v[80:83], v[192:207]
    global_load_dwordx4 a[96:99], v6, s[14:15] offset:-4096
    v_exp_f32 v73, v73
    v_cvt_pk_bf16_f32 v91, v70, v71
    v_exp_f32 v74, v74
    v_exp_f32 v75, v75
    v_cvt_pk_bf16_f32 v92, v72, v73
    v_exp_f32 v76, v76
    v_mfma_f32_32x32x16_bf16 v[192:207], v[140:143], v[84:87], v[192:207]
    global_load_dwordx4 v[132:135], v6, s[6:7] offset:1024
    v_exp_f32 v77, v77
    v_cvt_pk_bf16_f32 v93, v74, v75
    v_exp_f32 v78, v78
    v_exp_f32 v79, v79
    v_cvt_pk_bf16_f32 v94, v76, v77
    v_cvt_pk_bf16_f32 v95, v78, v79
    v_mfma_f32_32x32x16_bf16 v[64:79], v[144:147], v[24:27], 0
    global_load_dwordx4 a[100:103], v6, s[14:15] offset:-3072
    v_exp_f32 v48, v48
    v_exp_f32 v49, v49
    v_exp_f32 v50, v50
    v_exp_f32 v51, v51
    v_cvt_pk_bf16_f32 v80, v48, v49
    v_exp_f32 v52, v52
    v_mfma_f32_32x32x16_bf16 v[64:79], v[148:151], v[28:31], v[64:79]
    v_exp_f32 v53, v53
    v_cvt_pk_bf16_f32 v81, v50, v51
    v_exp_f32 v54, v54
    v_exp_f32 v55, v55
    v_cvt_pk_bf16_f32 v82, v52, v53
    v_exp_f32 v56, v56
    v_mfma_f32_32x32x16_bf16 v[208:223], v[136:139], v[88:91], v[208:223]
    global_load_dwordx4 a[104:107], v6, s[14:15] offset:-2048
    v_exp_f32 v57, v57
    v_cvt_pk_bf16_f32 v83, v54, v55
    v_exp_f32 v58, v58
    v_exp_f32 v59, v59
    v_cvt_pk_bf16_f32 v84, v56, v57
    v_exp_f32 v60, v60
    v_mfma_f32_32x32x16_bf16 v[208:223], v[140:143], v[92:95], v[208:223]
    global_load_dwordx4 v[136:139], v6, s[12:13] offset:0
    v_exp_f32 v61, v61
    v_cvt_pk_bf16_f32 v85, v58, v59
    v_exp_f32 v62, v62
    v_exp_f32 v63, v63
    v_cvt_pk_bf16_f32 v86, v60, v61
    v_cvt_pk_bf16_f32 v87, v62, v63
    v_mfma_f32_32x32x16_bf16 v[48:63], v[144:147], v[32:35], 0
    s_waitcnt vmcnt(30)
    v_exp_f32 v64, v64
    v_exp_f32 v65, v65
    v_exp_f32 v66, v66
    v_exp_f32 v67, v67
    v_cvt_pk_bf16_f32 v88, v64, v65
    v_exp_f32 v68, v68
    v_mfma_f32_32x32x16_bf16 v[48:63], v[148:151], v[36:39], v[48:63]
    global_load_dwordx4 v[140:143], v6, s[12:13] offset:1024
    v_exp_f32 v69, v69
    v_cvt_pk_bf16_f32 v89, v66, v67
    v_exp_f32 v70, v70
    v_exp_f32 v71, v71
    v_cvt_pk_bf16_f32 v90, v68, v69
    v_exp_f32 v72, v72
    v_mfma_f32_32x32x16_bf16 v[160:175], v[152:155], v[80:83], v[160:175]
    global_load_dwordx4 a[108:111], v6, s[14:15] offset:-1024
    v_exp_f32 v73, v73
    v_cvt_pk_bf16_f32 v91, v70, v71
    v_exp_f32 v74, v74
    v_exp_f32 v75, v75
    v_cvt_pk_bf16_f32 v92, v72, v73
    v_exp_f32 v76, v76
    v_mfma_f32_32x32x16_bf16 v[160:175], v[156:159], v[84:87], v[160:175]
    s_add_u32 m0, s42, 65536
    v_exp_f32 v77, v77
    v_cvt_pk_bf16_f32 v93, v74, v75
    v_exp_f32 v78, v78
    v_exp_f32 v79, v79
    v_cvt_pk_bf16_f32 v94, v76, v77
    v_cvt_pk_bf16_f32 v95, v78, v79
    v_mfma_f32_32x32x16_bf16 v[64:79], v[144:147], v[40:43], 0
    global_load_lds_dwordx4 v1, s[66:67] offset:0
    v_exp_f32 v48, v48
    v_exp_f32 v49, v49
    v_exp_f32 v50, v50
    v_exp_f32 v51, v51
    v_cvt_pk_bf16_f32 v80, v48, v49
    v_exp_f32 v52, v52
    v_mfma_f32_32x32x16_bf16 v[64:79], v[148:151], v[44:47], v[64:79]
    global_load_lds_dwordx4 v1, s[66:67] offset:1024
    v_exp_f32 v53, v53
    v_cvt_pk_bf16_f32 v81, v50, v51
    v_exp_f32 v54, v54
    v_exp_f32 v55, v55
    v_cvt_pk_bf16_f32 v82, v52, v53
    v_exp_f32 v56, v56
    v_mfma_f32_32x32x16_bf16 v[176:191], v[152:155], v[88:91], v[176:191]
    s_waitcnt vmcnt(27)
    v_exp_f32 v57, v57
    v_cvt_pk_bf16_f32 v83, v54, v55
    v_exp_f32 v58, v58
    v_exp_f32 v59, v59
    v_cvt_pk_bf16_f32 v84, v56, v57
    v_exp_f32 v60, v60
    v_mfma_f32_32x32x16_bf16 v[176:191], v[156:159], v[92:95], v[176:191]
    v_exp_f32 v61, v61
    v_cvt_pk_bf16_f32 v85, v58, v59
    v_exp_f32 v62, v62
    v_exp_f32 v63, v63
    v_cvt_pk_bf16_f32 v86, v60, v61
    v_cvt_pk_bf16_f32 v87, v62, v63
    v_mfma_f32_32x32x16_bf16 v[48:63], v[96:99], v[16:19], 0
    global_load_lds_dwordx4 v1, s[66:67] offset:2048
    v_exp_f32 v64, v64
    v_exp_f32 v65, v65
    v_exp_f32 v66, v66
    v_exp_f32 v67, v67
    v_cvt_pk_bf16_f32 v88, v64, v65
    v_exp_f32 v68, v68
    v_mfma_f32_32x32x16_bf16 v[48:63], v[100:103], v[20:23], v[48:63]
    global_load_dwordx4 v[144:147], v6, s[6:7] offset:2048
    v_exp_f32 v69, v69
    v_cvt_pk_bf16_f32 v89, v66, v67
    v_exp_f32 v70, v70
    v_exp_f32 v71, v71
    v_cvt_pk_bf16_f32 v90, v68, v69
    v_exp_f32 v72, v72
    v_mfma_f32_32x32x16_bf16 v[192:207], v[152:155], v[80:83], v[192:207]
    global_load_lds_dwordx4 v1, s[66:67] offset:3072
    v_exp_f32 v73, v73
    v_cvt_pk_bf16_f32 v91, v70, v71
    v_exp_f32 v74, v74
    v_exp_f32 v75, v75
    v_cvt_pk_bf16_f32 v92, v72, v73
    v_exp_f32 v76, v76
    v_mfma_f32_32x32x16_bf16 v[192:207], v[156:159], v[84:87], v[192:207]
    global_load_dwordx4 v[148:151], v6, s[6:7] offset:3072
    v_exp_f32 v77, v77
    v_cvt_pk_bf16_f32 v93, v74, v75
    v_exp_f32 v78, v78
    v_exp_f32 v79, v79
    v_cvt_pk_bf16_f32 v94, v76, v77
    v_cvt_pk_bf16_f32 v95, v78, v79
    v_mfma_f32_32x32x16_bf16 v[64:79], v[96:99], v[24:27], 0
    s_add_u32 m0, s42, 69632
    v_exp_f32 v48, v48
    v_exp_f32 v49, v49
    v_exp_f32 v50, v50
    v_exp_f32 v51, v51
    v_cvt_pk_bf16_f32 v80, v48, v49
    v_exp_f32 v52, v52
    v_mfma_f32_32x32x16_bf16 v[64:79], v[100:103], v[28:31], v[64:79]
    global_load_lds_dwordx4 v1, s[68:69] offset:0
    v_exp_f32 v53, v53
    v_cvt_pk_bf16_f32 v81, v50, v51
    v_exp_f32 v54, v54
    v_exp_f32 v55, v55
    v_cvt_pk_bf16_f32 v82, v52, v53
    v_exp_f32 v56, v56
    v_mfma_f32_32x32x16_bf16 v[208:223], v[152:155], v[88:91], v[208:223]
    v_exp_f32 v57, v57
    v_cvt_pk_bf16_f32 v83, v54, v55
    v_exp_f32 v58, v58
    v_exp_f32 v59, v59
    v_cvt_pk_bf16_f32 v84, v56, v57
    v_exp_f32 v60, v60
    v_mfma_f32_32x32x16_bf16 v[208:223], v[156:159], v[92:95], v[208:223]
    global_load_dwordx4 v[152:155], v6, s[12:13] offset:2048
    v_exp_f32 v61, v61
    v_cvt_pk_bf16_f32 v85, v58, v59
    v_exp_f32 v62, v62
    v_exp_f32 v63, v63
    v_cvt_pk_bf16_f32 v86, v60, v61
    v_cvt_pk_bf16_f32 v87, v62, v63
    v_mfma_f32_32x32x16_bf16 v[48:63], v[96:99], v[32:35], 0
    s_waitcnt vmcnt(30)
    v_exp_f32 v64, v64
    v_exp_f32 v65, v65
    v_exp_f32 v66, v66
    v_exp_f32 v67, v67
    v_cvt_pk_bf16_f32 v88, v64, v65
    v_exp_f32 v68, v68
    v_mfma_f32_32x32x16_bf16 v[48:63], v[100:103], v[36:39], v[48:63]
    global_load_dwordx4 v[156:159], v6, s[12:13] offset:3072
    v_exp_f32 v69, v69
    v_cvt_pk_bf16_f32 v89, v66, v67
    v_exp_f32 v70, v70
    v_exp_f32 v71, v71
    v_cvt_pk_bf16_f32 v90, v68, v69
    v_exp_f32 v72, v72
    v_mfma_f32_32x32x16_bf16 v[160:175], v[104:107], v[80:83], v[160:175]
    global_load_lds_dwordx4 v1, s[68:69] offset:1024
    v_exp_f32 v73, v73
    v_cvt_pk_bf16_f32 v91, v70, v71
    v_exp_f32 v74, v74
    v_exp_f32 v75, v75
    v_cvt_pk_bf16_f32 v92, v72, v73
    v_exp_f32 v76, v76
    v_mfma_f32_32x32x16_bf16 v[160:175], v[108:111], v[84:87], v[160:175]
    global_load_lds_dwordx4 v1, s[68:69] offset:2048
    v_exp_f32 v77, v77
    v_cvt_pk_bf16_f32 v93, v74, v75
    v_exp_f32 v78, v78
    v_exp_f32 v79, v79
    v_cvt_pk_bf16_f32 v94, v76, v77
    v_cvt_pk_bf16_f32 v95, v78, v79
    v_mfma_f32_32x32x16_bf16 v[64:79], v[96:99], v[40:43], 0
    global_load_lds_dwordx4 v1, s[68:69] offset:3072
    v_exp_f32 v48, v48
    v_exp_f32 v49, v49
    v_exp_f32 v50, v50
    v_exp_f32 v51, v51
    v_cvt_pk_bf16_f32 v80, v48, v49
    v_exp_f32 v52, v52
    v_mfma_f32_32x32x16_bf16 v[64:79], v[100:103], v[44:47], v[64:79]
    s_add_u32 m0, s42, 73728
    v_exp_f32 v53, v53
    v_cvt_pk_bf16_f32 v81, v50, v51
    v_exp_f32 v54, v54
    v_exp_f32 v55, v55
    v_cvt_pk_bf16_f32 v82, v52, v53
    v_exp_f32 v56, v56
    v_mfma_f32_32x32x16_bf16 v[176:191], v[104:107], v[88:91], v[176:191]
    s_waitcnt vmcnt(27)
    v_exp_f32 v57, v57
    v_cvt_pk_bf16_f32 v83, v54, v55
    v_exp_f32 v58, v58
    v_exp_f32 v59, v59
    v_cvt_pk_bf16_f32 v84, v56, v57
    v_exp_f32 v60, v60
    v_mfma_f32_32x32x16_bf16 v[176:191], v[108:111], v[92:95], v[176:191]
    global_load_lds_dwordx4 v4, s[66:67] offset:0
    v_exp_f32 v61, v61
    v_cvt_pk_bf16_f32 v85, v58, v59
    v_exp_f32 v62, v62
    v_exp_f32 v63, v63
    v_cvt_pk_bf16_f32 v86, v60, v61
    v_cvt_pk_bf16_f32 v87, v62, v63
    v_mfma_f32_32x32x16_bf16 v[48:63], v[112:115], v[16:19], 0
    v_exp_f32 v64, v64
    v_exp_f32 v65, v65
    v_exp_f32 v66, v66
    v_exp_f32 v67, v67
    v_cvt_pk_bf16_f32 v88, v64, v65
    v_exp_f32 v68, v68
    v_mfma_f32_32x32x16_bf16 v[48:63], v[116:119], v[20:23], v[48:63]
    v_exp_f32 v69, v69
    v_cvt_pk_bf16_f32 v89, v66, v67
    v_exp_f32 v70, v70
    v_exp_f32 v71, v71
    v_cvt_pk_bf16_f32 v90, v68, v69
    v_exp_f32 v72, v72
    v_mfma_f32_32x32x16_bf16 v[192:207], v[104:107], v[80:83], v[192:207]
    global_load_lds_dwordx4 v4, s[66:67] offset:1024
    v_exp_f32 v73, v73
    v_cvt_pk_bf16_f32 v91, v70, v71
    v_exp_f32 v74, v74
    v_exp_f32 v75, v75
    v_cvt_pk_bf16_f32 v92, v72, v73
    v_exp_f32 v76, v76
    v_mfma_f32_32x32x16_bf16 v[192:207], v[108:111], v[84:87], v[192:207]
    v_exp_f32 v77, v77
    v_cvt_pk_bf16_f32 v93, v74, v75
    v_exp_f32 v78, v78
    v_exp_f32 v79, v79
    v_cvt_pk_bf16_f32 v94, v76, v77
    v_cvt_pk_bf16_f32 v95, v78, v79
    v_mfma_f32_32x32x16_bf16 v[64:79], v[112:115], v[24:27], 0
    global_load_lds_dwordx4 v4, s[66:67] offset:2048
    v_exp_f32 v48, v48
    v_exp_f32 v49, v49
    v_exp_f32 v50, v50
    v_exp_f32 v51, v51
    v_cvt_pk_bf16_f32 v80, v48, v49
    v_exp_f32 v52, v52
    v_mfma_f32_32x32x16_bf16 v[64:79], v[116:119], v[28:31], v[64:79]
    v_exp_f32 v53, v53
    v_cvt_pk_bf16_f32 v81, v50, v51
    v_exp_f32 v54, v54
    v_exp_f32 v55, v55
    v_cvt_pk_bf16_f32 v82, v52, v53
    v_exp_f32 v56, v56
    v_mfma_f32_32x32x16_bf16 v[208:223], v[104:107], v[88:91], v[208:223]
    v_exp_f32 v57, v57
    v_cvt_pk_bf16_f32 v83, v54, v55
    v_exp_f32 v58, v58
    v_exp_f32 v59, v59
    v_cvt_pk_bf16_f32 v84, v56, v57
    v_exp_f32 v60, v60
    v_mfma_f32_32x32x16_bf16 v[208:223], v[108:111], v[92:95], v[208:223]
    global_load_lds_dwordx4 v4, s[66:67] offset:3072
    v_exp_f32 v61, v61
    v_cvt_pk_bf16_f32 v85, v58, v59
    v_exp_f32 v62, v62
    v_exp_f32 v63, v63
    v_cvt_pk_bf16_f32 v86, v60, v61
    v_cvt_pk_bf16_f32 v87, v62, v63
    v_mfma_f32_32x32x16_bf16 v[48:63], v[112:115], v[32:35], 0
    s_waitcnt vmcnt(27)
    v_exp_f32 v64, v64
    v_exp_f32 v65, v65
    v_exp_f32 v66, v66
    v_exp_f32 v67, v67
    v_cvt_pk_bf16_f32 v88, v64, v65
    v_exp_f32 v68, v68
    v_mfma_f32_32x32x16_bf16 v[48:63], v[116:119], v[36:39], v[48:63]
    s_add_u32 m0, s42, 77824
    v_exp_f32 v69, v69
    v_cvt_pk_bf16_f32 v89, v66, v67
    v_exp_f32 v70, v70
    v_exp_f32 v71, v71
    v_cvt_pk_bf16_f32 v90, v68, v69
    v_exp_f32 v72, v72
    v_mfma_f32_32x32x16_bf16 v[160:175], v[120:123], v[80:83], v[160:175]
    global_load_lds_dwordx4 v4, s[68:69] offset:0
    v_exp_f32 v73, v73
    v_cvt_pk_bf16_f32 v91, v70, v71
    v_exp_f32 v74, v74
    v_exp_f32 v75, v75
    v_cvt_pk_bf16_f32 v92, v72, v73
    v_exp_f32 v76, v76
    v_mfma_f32_32x32x16_bf16 v[160:175], v[124:127], v[84:87], v[160:175]
    v_exp_f32 v77, v77
    v_cvt_pk_bf16_f32 v93, v74, v75
    v_exp_f32 v78, v78
    v_exp_f32 v79, v79
    v_cvt_pk_bf16_f32 v94, v76, v77
    v_cvt_pk_bf16_f32 v95, v78, v79
    v_mfma_f32_32x32x16_bf16 v[64:79], v[112:115], v[40:43], 0
    global_load_lds_dwordx4 v4, s[68:69] offset:1024
    v_exp_f32 v48, v48
    v_exp_f32 v49, v49
    v_exp_f32 v50, v50
    v_exp_f32 v51, v51
    v_cvt_pk_bf16_f32 v80, v48, v49
    v_exp_f32 v52, v52
    v_mfma_f32_32x32x16_bf16 v[64:79], v[116:119], v[44:47], v[64:79]
    v_exp_f32 v53, v53
    v_cvt_pk_bf16_f32 v81, v50, v51
    v_exp_f32 v54, v54
    v_exp_f32 v55, v55
    v_cvt_pk_bf16_f32 v82, v52, v53
    v_exp_f32 v56, v56
    v_mfma_f32_32x32x16_bf16 v[176:191], v[120:123], v[88:91], v[176:191]
    s_waitcnt vmcnt(23)
    v_exp_f32 v57, v57
    v_cvt_pk_bf16_f32 v83, v54, v55
    v_exp_f32 v58, v58
    v_exp_f32 v59, v59
    v_cvt_pk_bf16_f32 v84, v56, v57
    v_exp_f32 v60, v60
    v_mfma_f32_32x32x16_bf16 v[176:191], v[124:127], v[92:95], v[176:191]
    global_load_lds_dwordx4 v4, s[68:69] offset:2048
    v_exp_f32 v61, v61
    v_cvt_pk_bf16_f32 v85, v58, v59
    v_exp_f32 v62, v62
    v_exp_f32 v63, v63
    v_cvt_pk_bf16_f32 v86, v60, v61
    v_cvt_pk_bf16_f32 v87, v62, v63
    v_mfma_f32_32x32x16_bf16 v[48:63], v[128:131], v[16:19], 0
    v_exp_f32 v64, v64
    v_exp_f32 v65, v65
    v_exp_f32 v66, v66
    v_exp_f32 v67, v67
    v_cvt_pk_bf16_f32 v88, v64, v65
    v_exp_f32 v68, v68
    v_mfma_f32_32x32x16_bf16 v[48:63], v[132:135], v[20:23], v[48:63]
    global_load_lds_dwordx4 v4, s[68:69] offset:3072
    v_exp_f32 v69, v69
    v_cvt_pk_bf16_f32 v89, v66, v67
    v_exp_f32 v70, v70
    v_exp_f32 v71, v71
    v_cvt_pk_bf16_f32 v90, v68, v69
    v_exp_f32 v72, v72
    v_mfma_f32_32x32x16_bf16 v[192:207], v[120:123], v[80:83], v[192:207]
    v_exp_f32 v73, v73
    v_cvt_pk_bf16_f32 v91, v70, v71
    v_exp_f32 v74, v74
    v_exp_f32 v75, v75
    v_cvt_pk_bf16_f32 v92, v72, v73
    v_exp_f32 v76, v76
    v_mfma_f32_32x32x16_bf16 v[192:207], v[124:127], v[84:87], v[192:207]
    global_store_dwordx4 v1, v[244:247], s[70:71] offset:0 nt sc1
    v_exp_f32 v77, v77
    v_cvt_pk_bf16_f32 v93, v74, v75
    v_exp_f32 v78, v78
    v_exp_f32 v79, v79
    v_cvt_pk_bf16_f32 v94, v76, v77
    v_cvt_pk_bf16_f32 v95, v78, v79
    v_mfma_f32_32x32x16_bf16 v[64:79], v[128:131], v[24:27], 0
    v_exp_f32 v48, v48
    v_exp_f32 v49, v49
    v_exp_f32 v50, v50
    v_exp_f32 v51, v51
    v_cvt_pk_bf16_f32 v80, v48, v49
    v_exp_f32 v52, v52
    v_mfma_f32_32x32x16_bf16 v[64:79], v[132:135], v[28:31], v[64:79]
    v_exp_f32 v53, v53
    v_cvt_pk_bf16_f32 v81, v50, v51
    v_exp_f32 v54, v54
    v_exp_f32 v55, v55
    v_cvt_pk_bf16_f32 v82, v52, v53
    v_exp_f32 v56, v56
    v_mfma_f32_32x32x16_bf16 v[208:223], v[120:123], v[88:91], v[208:223]
    global_store_dwordx4 v1, v[244:247], s[70:71] offset:1024 nt sc1
    v_exp_f32 v57, v57
    v_cvt_pk_bf16_f32 v83, v54, v55
    v_exp_f32 v58, v58
    v_exp_f32 v59, v59
    v_cvt_pk_bf16_f32 v84, v56, v57
    v_exp_f32 v60, v60
    v_mfma_f32_32x32x16_bf16 v[208:223], v[124:127], v[92:95], v[208:223]
    v_exp_f32 v61, v61
    v_cvt_pk_bf16_f32 v85, v58, v59
    v_exp_f32 v62, v62
    v_exp_f32 v63, v63
    v_cvt_pk_bf16_f32 v86, v60, v61
    v_cvt_pk_bf16_f32 v87, v62, v63
    v_mfma_f32_32x32x16_bf16 v[48:63], v[128:131], v[32:35], 0
    s_waitcnt vmcnt(23)
    v_exp_f32 v64, v64
    v_exp_f32 v65, v65
    v_exp_f32 v66, v66
    v_exp_f32 v67, v67
    v_cvt_pk_bf16_f32 v88, v64, v65
    v_exp_f32 v68, v68
    v_mfma_f32_32x32x16_bf16 v[48:63], v[132:135], v[36:39], v[48:63]
    global_store_dwordx4 v12, v[244:247], s[70:71] offset:0 nt sc1
    v_exp_f32 v69, v69
    v_cvt_pk_bf16_f32 v89, v66, v67
    v_exp_f32 v70, v70
    v_exp_f32 v71, v71
    v_cvt_pk_bf16_f32 v90, v68, v69
    v_exp_f32 v72, v72
    v_mfma_f32_32x32x16_bf16 v[160:175], v[136:139], v[80:83], v[160:175]
    v_exp_f32 v73, v73
    v_cvt_pk_bf16_f32 v91, v70, v71
    v_exp_f32 v74, v74
    v_exp_f32 v75, v75
    v_cvt_pk_bf16_f32 v92, v72, v73
    v_exp_f32 v76, v76
    v_mfma_f32_32x32x16_bf16 v[160:175], v[140:143], v[84:87], v[160:175]
    global_store_dwordx4 v12, v[244:247], s[70:71] offset:1024 nt sc1
    v_exp_f32 v77, v77
    v_cvt_pk_bf16_f32 v93, v74, v75
    v_exp_f32 v78, v78
    v_exp_f32 v79, v79
    v_cvt_pk_bf16_f32 v94, v76, v77
    v_cvt_pk_bf16_f32 v95, v78, v79
    v_mfma_f32_32x32x16_bf16 v[64:79], v[128:131], v[40:43], 0
    v_exp_f32 v48, v48
    v_exp_f32 v49, v49
    v_exp_f32 v50, v50
    v_exp_f32 v51, v51
    v_cvt_pk_bf16_f32 v80, v48, v49
    v_exp_f32 v52, v52
    v_mfma_f32_32x32x16_bf16 v[64:79], v[132:135], v[44:47], v[64:79]
    global_store_dwordx4 v13, v[244:247], s[70:71] offset:0 nt sc1
    v_exp_f32 v53, v53
    v_cvt_pk_bf16_f32 v81, v50, v51
    v_exp_f32 v54, v54
    v_exp_f32 v55, v55
    v_cvt_pk_bf16_f32 v82, v52, v53
    v_exp_f32 v56, v56
    v_mfma_f32_32x32x16_bf16 v[176:191], v[136:139], v[88:91], v[176:191]
    s_waitcnt vmcnt(19)
    v_exp_f32 v57, v57
    v_cvt_pk_bf16_f32 v83, v54, v55
    v_exp_f32 v58, v58
    v_exp_f32 v59, v59
    v_cvt_pk_bf16_f32 v84, v56, v57
    v_exp_f32 v60, v60
    v_mfma_f32_32x32x16_bf16 v[176:191], v[140:143], v[92:95], v[176:191]
    v_exp_f32 v61, v61
    v_cvt_pk_bf16_f32 v85, v58, v59
    v_exp_f32 v62, v62
    v_exp_f32 v63, v63
    v_cvt_pk_bf16_f32 v86, v60, v61
    v_cvt_pk_bf16_f32 v87, v62, v63
    v_mfma_f32_32x32x16_bf16 v[48:63], v[144:147], v[16:19], 0
    global_store_dwordx4 v13, v[244:247], s[70:71] offset:1024 nt sc1
    v_exp_f32 v64, v64
    v_exp_f32 v65, v65
    v_exp_f32 v66, v66
    v_exp_f32 v67, v67
    v_cvt_pk_bf16_f32 v88, v64, v65
    v_exp_f32 v68, v68
    v_mfma_f32_32x32x16_bf16 v[48:63], v[148:151], v[20:23], v[48:63]
    v_exp_f32 v69, v69
    v_cvt_pk_bf16_f32 v89, v66, v67
    v_exp_f32 v70, v70
    v_exp_f32 v71, v71
    v_cvt_pk_bf16_f32 v90, v68, v69
    v_exp_f32 v72, v72
    v_mfma_f32_32x32x16_bf16 v[192:207], v[136:139], v[80:83], v[192:207]
    global_store_dwordx4 v14, v[244:247], s[70:71] offset:0 nt sc1
    v_exp_f32 v73, v73
    v_cvt_pk_bf16_f32 v91, v70, v71
    v_exp_f32 v74, v74
    v_exp_f32 v75, v75
    v_cvt_pk_bf16_f32 v92, v72, v73
    v_exp_f32 v76, v76
    v_mfma_f32_32x32x16_bf16 v[192:207], v[140:143], v[84:87], v[192:207]
    v_exp_f32 v77, v77
    v_cvt_pk_bf16_f32 v93, v74, v75
    v_exp_f32 v78, v78
    v_exp_f32 v79, v79
    v_cvt_pk_bf16_f32 v94, v76, v77
    v_cvt_pk_bf16_f32 v95, v78, v79
    v_mfma_f32_32x32x16_bf16 v[64:79], v[144:147], v[24:27], 0
    v_exp_f32 v48, v48
    v_exp_f32 v49, v49
    v_exp_f32 v50, v50
    v_exp_f32 v51, v51
    v_cvt_pk_bf16_f32 v80, v48, v49
    v_exp_f32 v52, v52
    v_mfma_f32_32x32x16_bf16 v[64:79], v[148:151], v[28:31], v[64:79]
    global_store_dwordx4 v14, v[244:247], s[70:71] offset:1024 nt sc1
    v_exp_f32 v53, v53
    v_cvt_pk_bf16_f32 v81, v50, v51
    v_exp_f32 v54, v54
    v_exp_f32 v55, v55
    v_cvt_pk_bf16_f32 v82, v52, v53
    v_exp_f32 v56, v56
    v_mfma_f32_32x32x16_bf16 v[208:223], v[136:139], v[88:91], v[208:223]
    v_exp_f32 v57, v57
    v_cvt_pk_bf16_f32 v83, v54, v55
    v_exp_f32 v58, v58
    v_exp_f32 v59, v59
    v_cvt_pk_bf16_f32 v84, v56, v57
    v_exp_f32 v60, v60
    v_mfma_f32_32x32x16_bf16 v[208:223], v[140:143], v[92:95], v[208:223]
    v_exp_f32 v61, v61
    v_cvt_pk_bf16_f32 v85, v58, v59
    v_exp_f32 v62, v62
    v_exp_f32 v63, v63
    v_cvt_pk_bf16_f32 v86, v60, v61
    v_cvt_pk_bf16_f32 v87, v62, v63
    v_mfma_f32_32x32x16_bf16 v[48:63], v[144:147], v[32:35], 0
    s_waitcnt vmcnt(19)
    v_exp_f32 v64, v64
    v_exp_f32 v65, v65
    v_exp_f32 v66, v66
    v_exp_f32 v67, v67
    v_cvt_pk_bf16_f32 v88, v64, v65
    v_exp_f32 v68, v68
    v_mfma_f32_32x32x16_bf16 v[48:63], v[148:151], v[36:39], v[48:63]
    v_exp_f32 v69, v69
    v_cvt_pk_bf16_f32 v89, v66, v67
    v_exp_f32 v70, v70
    v_exp_f32 v71, v71
    v_cvt_pk_bf16_f32 v90, v68, v69
    v_exp_f32 v72, v72
    v_mfma_f32_32x32x16_bf16 v[160:175], v[152:155], v[80:83], v[160:175]
    v_exp_f32 v73, v73
    v_cvt_pk_bf16_f32 v91, v70, v71
    v_exp_f32 v74, v74
    v_exp_f32 v75, v75
    v_cvt_pk_bf16_f32 v92, v72, v73
    v_exp_f32 v76, v76
    v_mfma_f32_32x32x16_bf16 v[160:175], v[156:159], v[84:87], v[160:175]
    v_exp_f32 v77, v77
    v_cvt_pk_bf16_f32 v93, v74, v75
    v_exp_f32 v78, v78
    v_exp_f32 v79, v79
    v_cvt_pk_bf16_f32 v94, v76, v77
    v_cvt_pk_bf16_f32 v95, v78, v79
    v_mfma_f32_32x32x16_bf16 v[64:79], v[144:147], v[40:43], 0
    v_exp_f32 v48, v48
    v_exp_f32 v49, v49
    v_exp_f32 v50, v50
    v_exp_f32 v51, v51
    v_cvt_pk_bf16_f32 v80, v48, v49
    v_exp_f32 v52, v52
    v_mfma_f32_32x32x16_bf16 v[64:79], v[148:151], v[44:47], v[64:79]
    v_exp_f32 v53, v53
    v_cvt_pk_bf16_f32 v81, v50, v51
    v_exp_f32 v54, v54
    v_exp_f32 v55, v55
    v_cvt_pk_bf16_f32 v82, v52, v53
    v_exp_f32 v56, v56
    v_mfma_f32_32x32x16_bf16 v[176:191], v[152:155], v[88:91], v[176:191]
    v_exp_f32 v57, v57
    v_cvt_pk_bf16_f32 v83, v54, v55
    v_exp_f32 v58, v58
    v_exp_f32 v59, v59
    v_cvt_pk_bf16_f32 v84, v56, v57
    v_exp_f32 v60, v60
    v_mfma_f32_32x32x16_bf16 v[176:191], v[156:159], v[92:95], v[176:191]
    v_exp_f32 v61, v61
    v_cvt_pk_bf16_f32 v85, v58, v59
    v_exp_f32 v62, v62
    v_exp_f32 v63, v63
    v_cvt_pk_bf16_f32 v86, v60, v61
    v_cvt_pk_bf16_f32 v87, v62, v63
    v_exp_f32 v64, v64
    v_exp_f32 v65, v65
    v_exp_f32 v66, v66
    v_exp_f32 v67, v67
    v_cvt_pk_bf16_f32 v88, v64, v65
    v_exp_f32 v68, v68
    v_exp_f32 v69, v69
    v_cvt_pk_bf16_f32 v89, v66, v67
    v_exp_f32 v70, v70
    v_exp_f32 v71, v71
    v_cvt_pk_bf16_f32 v90, v68, v69
    v_exp_f32 v72, v72
    v_mfma_f32_32x32x16_bf16 v[192:207], v[152:155], v[80:83], v[192:207]
    v_exp_f32 v73, v73
    v_cvt_pk_bf16_f32 v91, v70, v71
    v_exp_f32 v74, v74
    v_exp_f32 v75, v75
    v_cvt_pk_bf16_f32 v92, v72, v73
    v_exp_f32 v76, v76
    v_mfma_f32_32x32x16_bf16 v[192:207], v[156:159], v[84:87], v[192:207]
    v_exp_f32 v77, v77
    v_cvt_pk_bf16_f32 v93, v74, v75
    v_exp_f32 v78, v78
    v_exp_f32 v79, v79
    v_cvt_pk_bf16_f32 v94, v76, v77
    v_cvt_pk_bf16_f32 v95, v78, v79
    s_nop 0
    v_mfma_f32_32x32x16_bf16 v[208:223], v[152:155], v[88:91], v[208:223]
    v_mfma_f32_32x32x16_bf16 v[208:223], v[156:159], v[92:95], v[208:223]
    s_xor_b32 s26, s30, 1
    s_mul_i32 s26, s26, 12288
    s_add_u32 s26, s26, 0
    v_add_u32 v4, s26, v1
    s_xor_b32 s26, s30, 2
    s_mul_i32 s26, s26, 12288
    s_add_u32 s26, s26, 4096
    v_add_u32 v5, s26, v1
    s_xor_b32 s26, s30, 3
    s_mul_i32 s26, s26, 12288
    s_add_u32 s26, s26, 8192
    v_add_u32 v6, s26, v1
    ds_write_b128 v4, v[176:179] offset:2048
    ds_write_b128 v4, v[180:183] offset:3072
    ds_write_b128 v4, v[184:187] offset:4096
    ds_write_b128 v4, v[188:191] offset:5120
    ds_write_b128 v5, v[192:195] offset:2048
    ds_write_b128 v5, v[196:199] offset:3072
    ds_write_b128 v5, v[200:203] offset:4096
    ds_write_b128 v5, v[204:207] offset:5120
    s_mul_i32 s26, s30, 12288
    v_add_u32 v3, s26, v1
    v_add_f32 v224, v172, v188
    v_add_f32 v224, v224, v204
    s_mov_b32 s37, 0x4e800000
    s_lshl_b32 s26, s30, 2
    v_mov_b32 v225, s26
    ds_write_b128 v6, v[208:211] offset:2048
    ds_write_b128 v6, v[212:215] offset:3072
    ds_write_b128 v6, v[216:219] offset:4096
    ds_write_b128 v6, v[220:223] offset:5120
    v_add_f32 v224, v224, v220
    v_cmp_nlt_f32 s[26:27], v224, s37
    s_nop 1
    v_mov_b32 v224, s27
    ds_write_b32 v225, v224 offset:0
    v_mov_b32 v225, 0
    s_waitcnt lgkmcnt(0)
    s_barrier
    ds_read_b128 v[228:231], v225 offset:0
    ds_read_b128 v[176:179], v3 offset:2048
    ds_read_b128 v[180:183], v3 offset:3072
    ds_read_b128 v[184:187], v3 offset:4096
    ds_read_b128 v[188:191], v3 offset:5120
    ds_read_b128 v[192:195], v3 offset:6144
    ds_read_b128 v[196:199], v3 offset:7168
    ds_read_b128 v[200:203], v3 offset:8192
    ds_read_b128 v[204:207], v3 offset:9216
    ds_read_b128 v[208:211], v3 offset:10240
    ds_read_b128 v[212:215], v3 offset:11264
    ds_read_b128 v[216:219], v3 offset:12288
    ds_read_b128 v[220:223], v3 offset:13312
    s_add_u32 s26, s23, s30
    s_lshl_b32 s26, s26, 4
    s_add_u32 s26, s26, s22
    s_lshl_b32 s37, s26, 11
    s_add_u32 s37, s37, 6291456
    s_lshl_b32 s43, s26, 7
    s_add_u32 s43, s43, 25296924
    s_waitcnt lgkmcnt(12)
    v_or3_b32 v228, v228, v229, v230
    v_or_b32 v228, v228, v231
    s_nop 0
    v_readfirstlane_b32 s26, v228
    s_waitcnt lgkmcnt(4)
    s_cmp_lg_u32 s26, 0
    s_cselect_b32 s26, 1, 0
    s_andn2_b32 s26, s26, s3
    s_cmp_lg_u32 s26, 0
    s_cbranch_scc1 L_att_fallback
    v_add_f32 v176, v176, v192
    v_add_f32 v177, v177, v193
    v_add_f32 v178, v178, v194
    v_add_f32 v179, v179, v195
    v_add_f32 v180, v180, v196
    v_add_f32 v181, v181, v197
    v_add_f32 v182, v182, v198
    v_add_f32 v183, v183, v199
    v_add_f32 v184, v184, v200
    v_add_f32 v185, v185, v201
    v_add_f32 v186, v186, v202
    v_add_f32 v187, v187, v203
    v_add_f32 v188, v188, v204
    v_add_f32 v189, v189, v205
    v_add_f32 v190, v190, v206
    v_add_f32 v191, v191, v207
    s_waitcnt lgkmcnt(0)
    v_add_f32 v172, v172, v220
    v_add_f32 v160, v160, v208
    v_add_f32 v161, v161, v209
    v_add_f32 v162, v162, v210
    v_add_f32 v163, v163, v211
    v_add_f32 v164, v164, v212
    v_add_f32 v165, v165, v213
    v_add_f32 v166, v166, v214
    v_add_f32 v167, v167, v215
    v_add_f32 v168, v168, v216
    v_add_f32 v169, v169, v217
    v_add_f32 v170, v170, v218
    v_add_f32 v171, v171, v219
    v_add_f32 v173, v173, v221
    v_add_f32 v174, v174, v222
    v_add_f32 v175, v175, v223
    v_add_f32 v224, v172, v188
    v_add_f32 v225, v172, v188
    v_add_f32 v160, v160, v176
    v_add_f32 v161, v161, v177
    v_add_f32 v162, v162, v178
    v_add_f32 v163, v163, v179
    v_permlane32_swap_b32 v224, v225
    v_add_f32 v164, v164, v180
    v_add_f32 v165, v165, v181
    v_add_f32 v166, v166, v182
    v_add_f32 v167, v167, v183
    v_rcp_f32 v225, v225
    v_add_f32 v168, v168, v184
    v_add_f32 v169, v169, v185
    v_add_f32 v170, v170, v186
    v_add_f32 v171, v171, v187
    v_add_f32 v172, v172, v188
    v_add_f32 v173, v173, v189
    v_add_f32 v174, v174, v190
    v_add_f32 v175, v175, v191
    v_mul_f32 v160, v160, v225
    v_mul_f32 v161, v161, v225
    v_mul_f32 v162, v162, v225
    v_mul_f32 v163, v163, v225
    v_mul_f32 v164, v164, v225
    v_mul_f32 v165, v165, v225
    v_mul_f32 v166, v166, v225
    v_mul_f32 v167, v167, v225
    v_mul_f32 v168, v168, v225
    v_mul_f32 v169, v169, v225
    v_mul_f32 v170, v170, v225
    v_mul_f32 v171, v171, v225
    v_mul_f32 v172, v172, v225
    v_mul_f32 v173, v173, v225
    v_mul_f32 v174, v174, v225
    v_mul_f32 v175, v175, v225
    v_cvt_pk_bf16_f32 v232, v160, v161
    v_cvt_pk_bf16_f32 v233, v162, v163
    v_cvt_pk_bf16_f32 v234, v164, v165
    v_cvt_pk_bf16_f32 v235, v166, v167
    v_cvt_pk_bf16_f32 v236, v168, v169
    v_cvt_pk_bf16_f32 v237, v170, v171
    v_cvt_pk_bf16_f32 v238, v172, v173
    v_cvt_pk_bf16_f32 v239, v174, v175
    buffer_store_dwordx4 v[232:235], v1, s[8:11], s37 offen sc1
    s_mov_b32 exec_lo, 0
    v_mov_b32 v238, 0
    v_mov_b32 v239, 0
    s_mov_b32 exec_lo, -1
    buffer_store_dwordx4 v[236:239], v1, s[8:11], s37 offen offset:1024 sc1
    s_mov_b64 exec, 1
    buffer_store_dword v10, v8, s[8:11], s43 offen sc1
    s_mov_b64 exec, -1
    v_mfma_f32_32x32x16_bf16 v[144:159], v[240:243], a[0:3], 0
    s_add_u32 s59, s57, 16384
    buffer_load_dwordx4 v[16:19], v1, s[8:11], s59 offen offset:0
    v_mfma_f32_32x32x16_bf16 v[144:159], v[240:243], a[4:7], v[144:159]
    s_add_u32 s59, s58, 16384
    buffer_load_dwordx4 v[20:23], v1, s[8:11], s59 offen offset:0
    v_mfma_f32_32x32x16_bf16 v[144:159], v[240:243], a[8:11], v[144:159]
    s_add_u32 s59, s57, 16384
    buffer_load_dwordx4 v[24:27], v1, s[8:11], s59 offen offset:1024
    v_mfma_f32_32x32x16_bf16 v[144:159], v[240:243], a[12:15], v[144:159]
    s_add_u32 s59, s58, 16384
    buffer_load_dwordx4 v[28:31], v1, s[8:11], s59 offen offset:1024
    v_mfma_f32_32x32x16_bf16 v[144:159], v[240:243], a[16:19], v[144:159]
    s_add_u32 s59, s57, 24576
    buffer_load_dwordx4 v[32:35], v1, s[8:11], s59 offen offset:0
    v_mfma_f32_32x32x16_bf16 v[144:159], v[240:243], a[20:23], v[144:159]
    s_add_u32 s59, s58, 24576
    buffer_load_dwordx4 v[36:39], v1, s[8:11], s59 offen offset:0
    v_mfma_f32_32x32x16_bf16 v[144:159], v[240:243], a[24:27], v[144:159]
    s_add_u32 s59, s57, 24576
    buffer_load_dwordx4 v[40:43], v1, s[8:11], s59 offen offset:1024
    v_mfma_f32_32x32x16_bf16 v[144:159], v[240:243], a[28:31], v[144:159]
    s_add_u32 s59, s58, 24576
    buffer_load_dwordx4 v[44:47], v1, s[8:11], s59 offen offset:1024
    v_mfma_f32_32x32x16_bf16 v[144:159], v[240:243], a[32:35], v[144:159]
    s_add_u32 s59, s57, 32768
    buffer_load_dwordx4 v[48:51], v1, s[8:11], s59 offen offset:0
    v_mfma_f32_32x32x16_bf16 v[144:159], v[240:243], a[36:39], v[144:159]
    s_add_u32 s59, s58, 32768
    buffer_load_dwordx4 v[52:55], v1, s[8:11], s59 offen offset:0
    v_mfma_f32_32x32x16_bf16 v[144:159], v[240:243], a[40:43], v[144:159]
    s_add_u32 s59, s57, 32768
    buffer_load_dwordx4 v[56:59], v1, s[8:11], s59 offen offset:1024
    v_mfma_f32_32x32x16_bf16 v[144:159], v[240:243], a[44:47], v[144:159]
    s_add_u32 s59, s58, 32768
    buffer_load_dwordx4 v[60:63], v1, s[8:11], s59 offen offset:1024
    v_mfma_f32_32x32x16_bf16 v[144:159], v[240:243], a[48:51], v[144:159]
    v_mfma_f32_32x32x16_bf16 v[144:159], v[240:243], a[52:55], v[144:159]
    v_mfma_f32_32x32x16_bf16 v[144:159], v[240:243], a[56:59], v[144:159]
    v_mfma_f32_32x32x16_bf16 v[144:159], v[240:243], a[60:63], v[144:159]
    v_mfma_f32_32x32x16_bf16 v[144:159], v[240:243], a[64:67], v[144:159]
    v_mfma_f32_32x32x16_bf16 v[144:159], v[240:243], a[68:71], v[144:159]
    s_cmp_ge_u32 s29, 14
    s_cbranch_scc1 L_fused_kernel_done
    v_mfma_f32_32x32x16_bf16 v[144:159], v[240:243], a[72:75], v[144:159]
    v_mfma_f32_32x32x16_bf16 v[144:159], v[240:243], a[76:79], v[144:159]
    v_mfma_f32_32x32x16_bf16 v[144:159], v[240:243], a[80:83], v[144:159]
    v_mfma_f32_32x32x16_bf16 v[144:159], v[240:243], a[84:87], v[144:159]
    v_mfma_f32_32x32x16_bf16 v[144:159], v[240:243], a[88:91], v[144:159]
    v_mfma_f32_32x32x16_bf16 v[144:159], v[240:243], a[92:95], v[144:159]
    v_mfma_f32_32x32x16_bf16 v[144:159], v[240:243], a[96:99], v[144:159]
    v_mfma_f32_32x32x16_bf16 v[144:159], v[240:243], a[100:103], v[144:159]
    v_mfma_f32_32x32x16_bf16 v[144:159], v[240:243], a[104:107], v[144:159]
    v_mfma_f32_32x32x16_bf16 v[144:159], v[240:243], a[108:111], v[144:159]
    v_and_b32 v2, 31, v0
    v_lshrrev_b32 v3, 5, v0
    s_lshl_b32 s44, s54, 15
    s_add_u32 s44, s44, 67584
    v_add_u32 v5, s44, v1
    s_lshl_b32 s44, s53, 15
    s_add_u32 s44, s44, 2048
    v_add_u32 v6, s44, v1
    v_min_u32 v7, 55, v0
    v_lshlrev_b32 v7, 2, v7
    v_lshlrev_b32 v9, 3, v2
    v_mov_b32 v168, 0
    v_mov_b32 v169, 0
    v_mov_b32 v170, 0
    v_mov_b32 v171, 0
    v_lshlrev_b32 v96, 16, v248
    v_and_b32 v97, 0xffff0000, v248
    v_lshlrev_b32 v98, 16, v249
    v_and_b32 v99, 0xffff0000, v249
    v_lshlrev_b32 v100, 16, v250
    v_and_b32 v101, 0xffff0000, v250
    v_lshlrev_b32 v102, 16, v251
    v_and_b32 v103, 0xffff0000, v251
    v_lshlrev_b32 v104, 16, v252
    v_and_b32 v105, 0xffff0000, v252
    v_lshlrev_b32 v106, 16, v253
    v_and_b32 v107, 0xffff0000, v253
    v_lshlrev_b32 v108, 16, v254
    v_and_b32 v109, 0xffff0000, v254
    v_lshlrev_b32 v110, 16, v255
    v_and_b32 v111, 0xffff0000, v255
    s_lshl_b32 s43, s54, 1
    s_add_u32 s44, s63, s43
    s_lshl_b32 s44, s44, 4
    s_lshl_b32 s43, s53, 3
    s_add_u32 s44, s44, s43
    v_and_b32 v12, 7, v0
    v_add_u32 v12, s44, v12
    v_lshlrev_b32 v12, 7, v12
    v_cvt_pk_bf16_f32 v172, v144, v144
    v_lshlrev_b32 v172, 16, v172
    v_sub_f32 v173, v144, v172
    v_cvt_pk_bf16_f32 v152, v172, v173
    v_and_b32 v174, 0xffff0000, v152
    v_sub_f32 v173, v173, v174
    v_cvt_pk_bf16_f32 v153, v173, 0
    s_mov_b32 exec_lo, 0
    v_mov_b32 v152, 0
    v_mov_b32 v153, 0
    s_mov_b32 exec_lo, -1
    v_mov_b32 v160, 0
    v_mov_b32 v161, 0
    v_mov_b32 v166, 0
    v_mov_b32 v167, 0
    v_mov_b32 v154, 0
    v_mov_b32 v155, 0
    s_barrier
    s_mov_b32 s52, 0x40000
    s_mov_b64 s[60:61], 0
L_poll_4923:
    buffer_load_dword v11, v12, s[8:11], s62 offen offset:28 sc1
L_poll_4923_w:
    s_waitcnt vmcnt(0)
    v_cmp_ne_u32 vcc, 0, v11
    s_sub_u32 s52, s52, 1
    s_cmp_eq_u32 s52, 0
    s_cbranch_scc1 L_poll_4923_x
    s_or_b64 s[60:61], s[60:61], vcc
    s_cmp_eq_u64 s[60:61], -1
    s_cbranch_scc1 L_poll_4923_x
    s_sleep 1
    s_branch L_poll_4923
L_poll_4923_x:
    s_add_u32 m0, s42, 0
    s_add_u32 s43, s40, 0
    buffer_load_dwordx4 v1, s[8:11], s43 offen offset:0 sc1 lds
    buffer_load_dwordx4 v1, s[8:11], s43 offen offset:1024 sc1 lds
    buffer_load_dwordx4 v1, s[8:11], s43 offen offset:2048 sc1 lds
    buffer_load_dwordx4 v1, s[8:11], s43 offen offset:3072 sc1 lds
    s_add_u32 m0, s42, 4096
    s_add_u32 s43, s40, 4096
    buffer_load_dwordx4 v1, s[8:11], s43 offen offset:0 sc1 lds
    buffer_load_dwordx4 v1, s[8:11], s43 offen offset:1024 sc1 lds
    buffer_load_dwordx4 v1, s[8:11], s43 offen offset:2048 sc1 lds
    buffer_load_dwordx4 v1, s[8:11], s43 offen offset:3072 sc1 lds
    s_add_u32 m0, s42, 8192
    s_add_u32 s43, s40, 8192
    buffer_load_dwordx4 v1, s[8:11], s43 offen offset:0 sc1 lds
    buffer_load_dwordx4 v1, s[8:11], s43 offen offset:1024 sc1 lds
    buffer_load_dwordx4 v1, s[8:11], s43 offen offset:2048 sc1 lds
    buffer_load_dwordx4 v1, s[8:11], s43 offen offset:3072 sc1 lds
    s_add_u32 m0, s42, 12288
    s_add_u32 s43, s40, 12288
    buffer_load_dwordx4 v1, s[8:11], s43 offen offset:0 sc1 lds
    buffer_load_dwordx4 v1, s[8:11], s43 offen offset:1024 sc1 lds
    buffer_load_dwordx4 v1, s[8:11], s43 offen offset:2048 sc1 lds
    buffer_load_dwordx4 v1, s[8:11], s43 offen offset:3072 sc1 lds
    s_mov_b32 s52, 0x4000
    s_waitcnt vmcnt(12)
    s_barrier
    ds_read_b128 v[112:115], v5 offset:0
    ds_read_b128 v[116:119], v6 offset:0
    ds_read_b128 v[120:123], v5 offset:1024
    ds_read_b128 v[124:127], v6 offset:1024
    ds_read_b128 v[128:131], v5 offset:2048
    ds_read_b128 v[132:135], v6 offset:2048
    ds_read_b128 v[136:139], v5 offset:3072
    ds_read_b128 v[140:143], v6 offset:3072
    s_waitcnt lgkmcnt(6)
    v_mfma_f32_32x32x16_bf16 v[96:111], v[112:115], v[116:119], v[96:111]
    ds_read_b128 v[112:115], v5 offset:16384
    ds_read_b128 v[116:119], v6 offset:16384
    s_waitcnt lgkmcnt(6)
    v_mfma_f32_32x32x16_bf16 v[96:111], v[120:123], v[124:127], v[96:111]
    ds_read_b128 v[120:123], v5 offset:17408
    ds_read_b128 v[124:127], v6 offset:17408
    s_waitcnt lgkmcnt(6)
    v_mfma_f32_32x32x16_bf16 v[96:111], v[128:131], v[132:135], v[96:111]
    s_add_u32 s59, s57, 40960
    buffer_load_dwordx4 v[64:67], v1, s[8:11], s59 offen offset:0
    ds_read_b128 v[128:131], v5 offset:18432
    ds_read_b128 v[132:135], v6 offset:18432
    s_waitcnt lgkmcnt(6)
    v_mfma_f32_32x32x16_bf16 v[96:111], v[136:139], v[140:143], v[96:111]
    s_add_u32 s59, s58, 40960
    buffer_load_dwordx4 v[68:71], v1, s[8:11], s59 offen offset:0
    ds_read_b128 v[136:139], v5 offset:19456
    ds_read_b128 v[140:143], v6 offset:19456
    s_waitcnt lgkmcnt(6)
    v_mfma_f32_32x32x16_bf16 v[96:111], v[112:115], v[116:119], v[96:111]
    s_add_u32 s59, s57, 40960
    buffer_load_dwordx4 v[72:75], v1, s[8:11], s59 offen offset:1024
    s_waitcnt vmcnt(11)
    s_barrier
    ds_read_b128 v[112:115], v5 offset:4096
    ds_read_b128 v[116:119], v6 offset:4096
    s_waitcnt lgkmcnt(6)
    v_mfma_f32_32x32x16_bf16 v[96:111], v[120:123], v[124:127], v[96:111]
    s_add_u32 s59, s58, 40960
    buffer_load_dwordx4 v[76:79], v1, s[8:11], s59 offen offset:1024
    ds_read_b128 v[120:123], v5 offset:5120
    ds_read_b128 v[124:127], v6 offset:5120
    s_waitcnt lgkmcnt(6)
    v_mfma_f32_32x32x16_bf16 v[96:111], v[128:131], v[132:135], v[96:111]
    s_add_u32 s59, s57, 49152
    buffer_load_dwordx4 v[80:83], v1, s[8:11], s59 offen offset:0
    ds_read_b128 v[128:131], v5 offset:6144
    ds_read_b128 v[132:135], v6 offset:6144
    s_waitcnt lgkmcnt(6)
    v_mfma_f32_32x32x16_bf16 v[96:111], v[136:139], v[140:143], v[96:111]
    s_add_u32 s59, s58, 49152
    buffer_load_dwordx4 v[84:87], v1, s[8:11], s59 offen offset:0
    ds_read_b128 v[136:139], v5 offset:7168
    ds_read_b128 v[140:143], v6 offset:7168
    s_waitcnt lgkmcnt(6)
    v_mfma_f32_32x32x16_bf16 v[96:111], v[112:115], v[116:119], v[96:111]
    s_add_u32 s59, s57, 49152
    buffer_load_dwordx4 v[88:91], v1, s[8:11], s59 offen offset:1024
    ds_read_b128 v[112:115], v5 offset:20480
    ds_read_b128 v[116:119], v6 offset:20480
    s_waitcnt lgkmcnt(6)
    v_mfma_f32_32x32x16_bf16 v[96:111], v[120:123], v[124:127], v[96:111]
    s_add_u32 s59, s58, 49152
    buffer_load_dwordx4 v[92:95], v1, s[8:11], s59 offen offset:1024
    ds_read_b128 v[120:123], v5 offset:21504
    ds_read_b128 v[124:127], v6 offset:21504
    s_waitcnt lgkmcnt(6)
    v_mfma_f32_32x32x16_bf16 v[96:111], v[128:131], v[132:135], v[96:111]
    ds_read_b128 v[128:131], v5 offset:22528
    ds_read_b128 v[132:135], v6 offset:22528
    s_waitcnt lgkmcnt(6)
    v_mfma_f32_32x32x16_bf16 v[96:111], v[136:139], v[140:143], v[96:111]
    ds_read_b128 v[136:139], v5 offset:23552
    ds_read_b128 v[140:143], v6 offset:23552
    s_waitcnt lgkmcnt(6)
    v_mfma_f32_32x32x16_bf16 v[96:111], v[112:115], v[116:119], v[96:111]
    s_waitcnt vmcnt(12)
    s_barrier
    ds_read_b128 v[112:115], v5 offset:8192
    ds_read_b128 v[116:119], v6 offset:8192
    s_waitcnt lgkmcnt(6)
    v_mfma_f32_32x32x16_bf16 v[96:111], v[120:123], v[124:127], v[96:111]
    ds_read_b128 v[120:123], v5 offset:9216
    ds_read_b128 v[124:127], v6 offset:9216
    s_waitcnt lgkmcnt(6)
    v_mfma_f32_32x32x16_bf16 v[96:111], v[128:131], v[132:135], v[96:111]
    ds_read_b128 v[128:131], v5 offset:10240
    ds_read_b128 v[132:135], v6 offset:10240
    s_waitcnt lgkmcnt(6)
    v_mfma_f32_32x32x16_bf16 v[96:111], v[136:139], v[140:143], v[96:111]
    ds_read_b128 v[136:139], v5 offset:11264
    ds_read_b128 v[140:143], v6 offset:11264
    s_waitcnt lgkmcnt(6)
    v_mfma_f32_32x32x16_bf16 v[96:111], v[112:115], v[116:119], v[96:111]
    ds_read_b128 v[112:115], v5 offset:24576
    ds_read_b128 v[116:119], v6 offset:24576
    s_waitcnt lgkmcnt(6)
    v_mfma_f32_32x32x16_bf16 v[96:111], v[120:123], v[124:127], v[96:111]
    ds_read_b128 v[120:123], v5 offset:25600
    ds_read_b128 v[124:127], v6 offset:25600
    s_waitcnt lgkmcnt(6)
    v_mfma_f32_32x32x16_bf16 v[96:111], v[128:131], v[132:135], v[96:111]
    ds_read_b128 v[128:131], v5 offset:26624
    ds_read_b128 v[132:135], v6 offset:26624
    s_waitcnt lgkmcnt(6)
    v_mfma_f32_32x32x16_bf16 v[96:111], v[136:139], v[140:143], v[96:111]
    ds_read_b128 v[136:139], v5 offset:27648
    ds_read_b128 v[140:143], v6 offset:27648
    s_waitcnt lgkmcnt(6)
    v_mfma_f32_32x32x16_bf16 v[96:111], v[112:115], v[116:119], v[96:111]
    s_waitcnt vmcnt(8)
    s_barrier
    ds_read_b128 v[112:115], v5 offset:12288
    ds_read_b128 v[116:119], v6 offset:12288
    s_waitcnt lgkmcnt(6)
    v_mfma_f32_32x32x16_bf16 v[96:111], v[120:123], v[124:127], v[96:111]
    ds_read_b128 v[120:123], v5 offset:13312
    ds_read_b128 v[124:127], v6 offset:13312
    s_waitcnt lgkmcnt(6)
    v_mfma_f32_32x32x16_bf16 v[96:111], v[128:131], v[132:135], v[96:111]
    ds_read_b128 v[128:131], v5 offset:14336
    ds_read_b128 v[132:135], v6 offset:14336
    s_waitcnt lgkmcnt(6)
    v_mfma_f32_32x32x16_bf16 v[96:111], v[136:139], v[140:143], v[96:111]
    ds_read_b128 v[136:139], v5 offset:15360
    ds_read_b128 v[140:143], v6 offset:15360
    s_waitcnt lgkmcnt(6)
    v_mfma_f32_32x32x16_bf16 v[96:111], v[112:115], v[116:119], v[96:111]
    ds_read_b128 v[112:115], v5 offset:28672
    ds_read_b128 v[116:119], v6 offset:28672
    s_waitcnt lgkmcnt(6)
    v_mfma_f32_32x32x16_bf16 v[96:111], v[120:123], v[124:127], v[96:111]
    ds_read_b128 v[120:123], v5 offset:29696
    ds_read_b128 v[124:127], v6 offset:29696
    s_waitcnt lgkmcnt(6)
    v_mfma_f32_32x32x16_bf16 v[96:111], v[128:131], v[132:135], v[96:111]
    ds_read_b128 v[128:131], v5 offset:30720
    ds_read_b128 v[132:135], v6 offset:30720
    s_waitcnt lgkmcnt(6)
    v_mfma_f32_32x32x16_bf16 v[96:111], v[136:139], v[140:143], v[96:111]
    ds_read_b128 v[136:139], v5 offset:31744
    ds_read_b128 v[140:143], v6 offset:31744
    s_waitcnt lgkmcnt(6)
    v_mfma_f32_32x32x16_bf16 v[96:111], v[112:115], v[116:119], v[96:111]
    s_waitcnt lgkmcnt(4)
    v_mfma_f32_32x32x16_bf16 v[96:111], v[120:123], v[124:127], v[96:111]
    s_waitcnt lgkmcnt(2)
    v_mfma_f32_32x32x16_bf16 v[96:111], v[128:131], v[132:135], v[96:111]
    s_waitcnt lgkmcnt(0)
    v_mfma_f32_32x32x16_bf16 v[96:111], v[136:139], v[140:143], v[96:111]
    s_cmp_ge_u32 s29, 7
    s_cselect_b32 s26, 1, 0
    s_mul_i32 s41, s32, 28672
    s_lshl_b32 s42, s30, 10
    s_add_u32 s41, s41, s42
    s_add_u32 s41, s41, 8388608
    s_mul_i32 s27, s26, 28672
    s_sub_u32 s40, s41, s27
    s_add_u32 s40, s40, 28672
    s_add_u32 s41, s41, s27
    s_add_u32 s42, s42, 2048
    s_nop 0
L_chkO:
    v_cmp_u_f32 vcc, v96, v96
    v_cvt_pk_bf16_f32 v184, v96, v97
    v_cvt_pk_bf16_f32 v185, v98, v99
    v_cvt_pk_bf16_f32 v186, v100, v101
    v_cvt_pk_bf16_f32 v187, v102, v103
    v_cvt_pk_bf16_f32 v188, v104, v105
    v_cvt_pk_bf16_f32 v189, v106, v107
    v_cvt_pk_bf16_f32 v190, v108, v109
    v_cvt_pk_bf16_f32 v191, v110, v111
    s_cbranch_vccnz L_redoO
L_okO:
    buffer_store_dwordx4 v[184:187], v1, s[8:11], s55 offen sc1
    buffer_store_dwordx4 v[188:191], v1, s[8:11], s55 offen offset:1024 sc1
    v_dot2c_f32_bf16 v168, v184, v240
    v_dot2c_f32_bf16 v169, v184, v184
    v_dot2c_f32_bf16 v170, v185, v240
    v_dot2c_f32_bf16 v171, v185, v185
    v_dot2c_f32_bf16 v168, v186, v240
    v_dot2c_f32_bf16 v169, v186, v186
    v_dot2c_f32_bf16 v170, v187, v240
    v_dot2c_f32_bf16 v171, v187, v187
    v_dot2c_f32_bf16 v168, v188, v240
    v_dot2c_f32_bf16 v169, v188, v188
    v_dot2c_f32_bf16 v170, v189, v240
    v_dot2c_f32_bf16 v171, v189, v189
    v_dot2c_f32_bf16 v168, v190, v240
    v_dot2c_f32_bf16 v169, v190, v190
    v_dot2c_f32_bf16 v170, v191, v240
    v_dot2c_f32_bf16 v171, v191, v191
    v_mov_b32 v192, 0
    v_mov_b32 v193, 0
    v_mov_b32 v194, 0
    v_mov_b32 v195, 0
    v_add_f32 v168, v168, v170
    v_add_f32 v169, v169, v171
    v_mov_b32 v170, v168
    v_mov_b32 v171, v169
    v_mov_b32 v196, 0
    v_mov_b32 v197, 0
    v_permlane32_swap_b32 v168, v170
    v_permlane32_swap_b32 v169, v171
    s_nop 0
    v_add_f32 v168, v168, v170
    v_add_f32 v169, v169, v171
    s_mov_b32 exec_hi, 0
    buffer_store_dwordx2 v[168:169], v9, s[8:11], s56 offen sc1
    s_mov_b32 exec_hi, -1
    v_mov_b32 v198, 0
    v_mov_b32 v199, 0
    v_mov_b32 v200, 0
    v_mov_b32 v201, 0
    v_mov_b32 v202, 0
    v_mov_b32 v203, 0
    v_mov_b32 v204, 0
    v_mov_b32 v205, 0
    v_mov_b32 v206, 0
    v_mov_b32 v207, 0
    v_mov_b32 v224, 0
    v_mov_b32 v225, 0
    v_mov_b32 v226, 0
    v_mov_b32 v227, 0
    v_mov_b32 v228, 0
    v_mov_b32 v229, 0
    v_mov_b32 v230, 0
    v_mov_b32 v231, 0
    v_mov_b32 v232, 0
    v_mov_b32 v233, 0
    v_mov_b32 v234, 0
    v_mov_b32 v235, 0
    v_mov_b32 v236, 0
    v_mov_b32 v237, 0
    v_mov_b32 v238, 0
    v_mov_b32 v239, 0
    s_cmp_eq_u32 s53, 0
    s_cselect_b64 exec, -1, 0
    v_lshlrev_b32 v192, 16, v184
    v_and_b32 v193, 0xffff0000, v184
    v_lshlrev_b32 v194, 16, v185
    v_and_b32 v195, 0xffff0000, v185
    v_lshlrev_b32 v196, 16, v186
    v_and_b32 v197, 0xffff0000, v186
    v_lshlrev_b32 v198, 16, v187
    v_and_b32 v199, 0xffff0000, v187
    v_lshlrev_b32 v200, 16, v188
    v_and_b32 v201, 0xffff0000, v188
    v_lshlrev_b32 v202, 16, v189
    v_and_b32 v203, 0xffff0000, v189
    v_lshlrev_b32 v204, 16, v190
    v_and_b32 v205, 0xffff0000, v190
    v_lshlrev_b32 v206, 16, v191
    v_and_b32 v207, 0xffff0000, v191
    s_cselect_b64 exec, 0, -1
    v_lshlrev_b32 v224, 16, v184
    v_and_b32 v225, 0xffff0000, v184
    v_lshlrev_b32 v226, 16, v185
    v_and_b32 v227, 0xffff0000, v185
    v_lshlrev_b32 v228, 16, v186
    v_and_b32 v229, 0xffff0000, v186
    v_lshlrev_b32 v230, 16, v187
    v_and_b32 v231, 0xffff0000, v187
    v_lshlrev_b32 v232, 16, v188
    v_and_b32 v233, 0xffff0000, v188
    v_lshlrev_b32 v234, 16, v189
    v_and_b32 v235, 0xffff0000, v189
    v_lshlrev_b32 v236, 16, v190
    v_and_b32 v237, 0xffff0000, v190
    v_lshlrev_b32 v238, 16, v191
    v_and_b32 v239, 0xffff0000, v191
    s_mov_b64 exec, -1
    s_add_u32 s27, s32, s30
    v_mul_u32_u24 v4, 114688, v3
    v_lshl_add_u32 v4, v2, 3, v4
    s_lshl_b32 s43, s27, 8
    s_add_u32 s43, s43, 10485760
    v_lshlrev_b32 v6, 4, v2
    s_xor_b32 s44, s30, s26
    s_lshl_b32 s44, s44, 9
    v_add_u32 v9, s44, v6
    v_add_u32 v5, 57344, v1
    s_mul_i32 s49, s32, 56
    s_add_u32 s49, s49, s31
    s_lshl_b32 s49, s49, 11
    s_add_u32 s49, s49, 12582912
    s_mul_i32 s27, s26, 114688
    s_sub_u32 s46, s49, s27
    s_add_u32 s46, s46, 114688
    s_add_u32 s49, s49, s27
    v_min_u32 v12, 6, v0
    v_lshlrev_b32 v12, 4, v12
    s_mul_i32 s27, s63, 112
    s_lshl_b32 s44, s30, 2
    s_add_u32 s27, s27, s44
    v_add_u32 v13, s44, v12
    v_add_u32 v12, s27, v12
    s_xor_b32 s27, s63, 1
    s_mul_i32 s27, s27, 112
    v_add_u32 v13, s27, v13
    s_mul_i32 s22, s33, 114688
    s_add_u32 s22, s22, 12582912
    s_add_u32 s23, s22, s39
    s_sub_u32 s27, s57, s47
    s_add_u32 s24, s23, s27
    v_lshrrev_b32 v14, 4, v0
    v_and_b32 v15, 15, v0
    v_lshlrev_b32 v15, 7, v15
    v_lshl_add_u32 v14, v14, 13, v15
    v_add_u32 v15, 32768, v14
    v_min_u32 v15, 51199, v15
    v_and_b32 v15, 0xffffff80, v15
    s_add_u32 s59, s23, 0
    s_add_u32 s6, s4, s59
    s_addc_u32 s7, s5, 0
    s_add_u32 s12, s6, 32768
    s_addc_u32 s13, s7, 0
    s_add_u32 s59, s24, 0
    s_add_u32 s14, s4, s59
    s_addc_u32 s15, s5, 0
    s_add_u32 s20, s14, 32768
    s_addc_u32 s21, s15, 0
    s_add_u32 s59, s23, 229376
    s_add_u32 s64, s4, s59
    s_addc_u32 s65, s5, 0
    s_add_u32 s66, s64, 32768
    s_addc_u32 s67, s65, 0
    s_add_u32 s59, s24, 229376
    s_add_u32 s68, s4, s59
    s_addc_u32 s69, s5, 0
    s_add_u32 s70, s68, 32768
    s_addc_u32 s71, s69, 0
    s_add_u32 s72, s4, s49
    s_addc_u32 s73, s5, 0
    v_add_u32 v12, 8192, v1
    v_add_u32 v13, 16384, v1
    v_add_u32 v14, 24576, v1
    v_add_u32 v15, 229376, v1
    s_waitcnt vmcnt(0)
    s_mov_b64 exec, 1
    buffer_store_dword v10, v8, s[8:11], s51 offen offset:0
    s_mov_b64 exec, -1
    s_mov_b32 s52, 0x40000
    s_mov_b64 s[60:61], 0
L_poll_5308:
    buffer_load_dword v11, v7, s[8:11], s50 offen offset:0 sc1
L_poll_5308_w:
    s_waitcnt vmcnt(0)
    v_cmp_ne_u32 vcc, 0, v11
    s_sub_u32 s52, s52, 1
    s_cmp_eq_u32 s52, 0
    s_cbranch_scc1 L_poll_5308_x
    s_or_b64 s[60:61], s[60:61], vcc
    s_cmp_eq_u64 s[60:61], -1
    s_cbranch_scc1 L_poll_5308_x
    s_sleep 1
    s_and_b32 s59, s52, 15
    s_cbranch_scc1 L_poll_5308
    s_lshl_b32 s59, s31, 7
    s_add_u32 s59, s59, s62
    s_mov_b64 exec, 1
    buffer_store_dword v10, v8, s[8:11], s59 offen offset:0 sc1
    s_mov_b64 exec, -1
    v_lshlrev_b32 v11, 5, v7
    buffer_load_dword v11, v11, s[8:11], s62 offen offset:0 sc1
    s_branch L_poll_5308_w
L_poll_5308_x:
    s_add_u32 s60, s4, s46
    s_addc_u32 s61, s5, 0
    s_add_u32 m0, s42, 0
    s_add_u32 s44, s41, 0
    buffer_load_dwordx4 v1, s[8:11], s44 offen sc1 lds
    s_add_u32 m0, s42, 4096
    s_add_u32 s44, s41, 4096
    buffer_load_dwordx4 v1, s[8:11], s44 offen sc1 lds
    buffer_load_dwordx2 v[168:169], v4, s[8:11], s43 offen sc1
    s_add_u32 s43, s43, 16384
    buffer_load_dwordx2 v[170:171], v4, s[8:11], s43 offen sc1
    s_add_u32 s43, s43, 16384
    buffer_load_dwordx2 v[172:173], v4, s[8:11], s43 offen sc1
    s_add_u32 s43, s43, 16384
    buffer_load_dwordx2 v[174:175], v4, s[8:11], s43 offen sc1
    s_add_u32 s43, s43, 16384
    buffer_load_dwordx2 v[176:177], v4, s[8:11], s43 offen sc1
    s_add_u32 s43, s43, 16384
    buffer_load_dwordx2 v[178:179], v4, s[8:11], s43 offen sc1
    s_add_u32 s43, s43, 16384
    buffer_load_dwordx2 v[180:181], v4, s[8:11], s43 offen sc1
    s_add_u32 m0, s42, 8192
    s_add_u32 s44, s41, 8192
    buffer_load_dwordx4 v1, s[8:11], s44 offen sc1 lds
    s_add_u32 m0, s42, 12288
    s_add_u32 s44, s41, 12288
    buffer_load_dwordx4 v1, s[8:11], s44 offen sc1 lds
    s_add_u32 m0, s42, 16384
    s_add_u32 s44, s41, 16384
    buffer_load_dwordx4 v1, s[8:11], s44 offen sc1 lds
    s_add_u32 m0, s42, 20480
    s_add_u32 s44, s41, 20480
    buffer_load_dwordx4 v1, s[8:11], s44 offen sc1 lds
    s_add_u32 m0, s42, 24576
    s_add_u32 s44, s41, 24576
    buffer_load_dwordx4 v1, s[8:11], s44 offen sc1 lds
    s_waitcnt vmcnt(12)
    s_barrier
    ds_read_b128 v[96:99], v1 offset:2048
    ds_read_b128 v[100:103], v1 offset:3072
    ds_read_b128 v[104:107], v1 offset:4096
    ds_read_b128 v[108:111], v1 offset:5120
    ds_read_b128 v[112:115], v1 offset:6144
    s_waitcnt lgkmcnt(3)
    v_mfma_f32_32x32x16_bf16 v[120:135], a[0:3], v[96:99], 0
    ds_read_b128 v[116:119], v1 offset:7168
    s_add_u32 m0, s42, 28672
    s_add_u32 s44, s40, 0
    buffer_load_dwordx4 v1, s[8:11], s44 offen sc1 lds
    v_mfma_f32_32x32x16_bf16 v[120:135], a[4:7], v[100:103], v[120:135]
    ds_read_b128 v[96:99], v1 offset:8192
    s_waitcnt vmcnt(6)
    v_add_f32 v168, v168, v170
    v_add_f32 v169, v169, v171
    s_waitcnt lgkmcnt(3)
    v_mfma_f32_32x32x16_bf16 v[120:135], a[8:11], v[104:107], v[120:135]
    ds_read_b128 v[100:103], v1 offset:9216
    s_add_u32 m0, s42, 32768
    s_add_u32 s44, s40, 4096
    buffer_load_dwordx4 v1, s[8:11], s44 offen sc1 lds
    v_mfma_f32_32x32x16_bf16 v[120:135], a[12:15], v[108:111], v[120:135]
    s_waitcnt vmcnt(5)
    s_barrier
    ds_read_b128 v[104:107], v1 offset:10240
    v_add_f32 v168, v168, v172
    v_add_f32 v169, v169, v173
    v_add_f32 v168, v168, v174
    s_waitcnt lgkmcnt(3)
    v_mfma_f32_32x32x16_bf16 v[120:135], a[16:19], v[112:115], v[120:135]
    ds_read_b128 v[108:111], v1 offset:11264
    s_add_u32 m0, s42, 36864
    s_add_u32 s44, s40, 8192
    buffer_load_dwordx4 v1, s[8:11], s44 offen sc1 lds
    v_mfma_f32_32x32x16_bf16 v[120:135], a[20:23], v[116:119], v[120:135]
    ds_read_b128 v[112:115], v1 offset:12288
    v_add_f32 v169, v169, v175
    v_add_f32 v168, v168, v176
    v_add_f32 v169, v169, v177
    v_add_f32 v168, v168, v178
    v_add_f32 v169, v169, v179
    s_waitcnt lgkmcnt(3)
    v_mfma_f32_32x32x16_bf16 v[120:135], a[24:27], v[96:99], v[120:135]
    ds_read_b128 v[116:119], v1 offset:13312
    s_add_u32 m0, s42, 40960
    s_add_u32 s44, s40, 12288
    buffer_load_dwordx4 v1, s[8:11], s44 offen sc1 lds
    v_mfma_f32_32x32x16_bf16 v[120:135], a[28:31], v[100:103], v[120:135]
    ds_read_b128 v[96:99], v1 offset:14336
    v_add_f32 v168, v168, v180
    v_add_f32 v169, v169, v181
    v_mov_b32 v184, v168
    v_mov_b32 v185, v169
    s_waitcnt lgkmcnt(3)
    v_mfma_f32_32x32x16_bf16 v[120:135], a[32:35], v[104:107], v[120:135]
    ds_read_b128 v[100:103], v1 offset:15360
    s_add_u32 m0, s42, 45056
    s_add_u32 s44, s40, 16384
    buffer_load_dwordx4 v1, s[8:11], s44 offen sc1 lds
    v_mfma_f32_32x32x16_bf16 v[120:135], a[36:39], v[108:111], v[120:135]
    ds_read_b128 v[104:107], v1 offset:16384
    s_nop 1
    v_permlane32_swap_b32 v168, v184
    v_permlane32_swap_b32 v169, v185
    s_nop 0
    s_waitcnt lgkmcnt(3)
    v_mfma_f32_32x32x16_bf16 v[120:135], a[40:43], v[112:115], v[120:135]
    ds_read_b128 v[108:111], v1 offset:17408
    s_add_u32 m0, s42, 49152
    s_add_u32 s44, s40, 20480
    buffer_load_dwordx4 v1, s[8:11], s44 offen sc1 lds
    v_mfma_f32_32x32x16_bf16 v[120:135], a[44:47], v[116:119], v[120:135]
    s_waitcnt vmcnt(6)
    s_barrier
    ds_read_b128 v[112:115], v1 offset:18432
    v_add_f32 v168, v168, v184
    v_add_f32 v169, v169, v185
    v_mul_f32 v168, 0x3b124925, v168
    s_waitcnt lgkmcnt(3)
    v_mfma_f32_32x32x16_bf16 v[120:135], a[48:51], v[96:99], v[120:135]
    ds_read_b128 v[116:119], v1 offset:19456
    s_add_u32 m0, s42, 53248
    s_add_u32 s44, s40, 24576
    buffer_load_dwordx4 v1, s[8:11], s44 offen sc1 lds
    v_mfma_f32_32x32x16_bf16 v[120:135], a[52:55], v[100:103], v[120:135]
    ds_read_b128 v[96:99], v1 offset:20480
    v_mul_f32 v169, 0x3b124925, v169
    v_fma_f32 v169, -v168, v168, v169
    v_max_f32 v169, 0, v169
    v_cvt_pk_bf16_f32 v190, -v168, -v168
    v_cvt_pk_bf16_f32 v184, v169, v169
    s_waitcnt lgkmcnt(3)
    v_mfma_f32_32x32x16_bf16 v[120:135], a[56:59], v[104:107], v[120:135]
    ds_read_b128 v[100:103], v1 offset:21504
    s_add_u32 m0, s42, 57344
    s_add_u32 s44, s41, 57344
    buffer_load_dwordx4 v1, s[8:11], s44 offen sc1 lds
    v_mfma_f32_32x32x16_bf16 v[120:135], a[60:63], v[108:111], v[120:135]
    ds_read_b128 v[104:107], v1 offset:22528
    v_lshlrev_b32 v169, 16, v184
    v_add_f32 v169, 0x3727c5ac, v169
    v_cvt_pk_bf16_f32 v184, v169, v169
    v_lshlrev_b32 v169, 16, v184
    s_waitcnt lgkmcnt(3)
    v_mfma_f32_32x32x16_bf16 v[120:135], a[64:67], v[112:115], v[120:135]
    ds_read_b128 v[108:111], v1 offset:23552
    s_add_u32 m0, s42, 61440
    s_add_u32 s44, s41, 61440
    buffer_load_dwordx4 v1, s[8:11], s44 offen sc1 lds
    v_mfma_f32_32x32x16_bf16 v[120:135], a[68:71], v[116:119], v[120:135]
    ds_read_b128 v[112:115], v1 offset:24576
    v_sqrt_f32 v169, v169
    v_mov_b32 v191, v190
    v_cvt_pk_bf16_f32 v184, v169, v169
    v_lshlrev_b32 v188, 16, v184
    s_waitcnt lgkmcnt(3)
    v_mfma_f32_32x32x16_bf16 v[120:135], a[72:75], v[96:99], v[120:135]
    ds_read_b128 v[116:119], v1 offset:25600
    s_add_u32 m0, s42, 65536
    s_add_u32 s44, s41, 65536
    buffer_load_dwordx4 v1, s[8:11], s44 offen sc1 lds
    v_mfma_f32_32x32x16_bf16 v[120:135], a[76:79], v[100:103], v[120:135]
    ds_read_b128 v[96:99], v1 offset:26624
    v_rcp_f32 v189, v188
    s_nop 0
    v_mul_f32 v189, 0xbfb8aa3b, v189
    s_waitcnt lgkmcnt(3)
    v_mfma_f32_32x32x16_bf16 v[120:135], a[80:83], v[104:107], v[120:135]
    ds_read_b128 v[100:103], v1 offset:27648
    s_add_u32 m0, s42, 69632
    s_add_u32 s44, s41, 69632
    buffer_load_dwordx4 v1, s[8:11], s44 offen sc1 lds
    v_mfma_f32_32x32x16_bf16 v[120:135], a[84:87], v[108:111], v[120:135]
    ds_read_b128 v[104:107], v1 offset:28672
    ds_write_b128 v9, v[188:191] offset:0
    s_waitcnt lgkmcnt(4)
    v_mfma_f32_32x32x16_bf16 v[120:135], a[88:91], v[112:115], v[120:135]
    ds_read_b128 v[108:111], v1 offset:29696
    s_add_u32 m0, s42, 73728
    s_add_u32 s44, s41, 73728
    buffer_load_dwordx4 v1, s[8:11], s44 offen sc1 lds
    v_mfma_f32_32x32x16_bf16 v[120:135], a[92:95], v[116:119], v[120:135]
    s_waitcnt vmcnt(5) lgkmcnt(0)
    s_barrier
    ds_read_b128 v[112:115], v1 offset:30720
    s_waitcnt lgkmcnt(4)
    v_mfma_f32_32x32x16_bf16 v[120:135], a[96:99], v[96:99], v[120:135]
    ds_read_b128 v[116:119], v1 offset:31744
    ds_read_b128 v[156:159], v6 offset:0
    s_add_u32 m0, s42, 77824
    s_add_u32 s44, s41, 77824
    buffer_load_dwordx4 v1, s[8:11], s44 offen sc1 lds
    v_mfma_f32_32x32x16_bf16 v[120:135], a[100:103], v[100:103], v[120:135]
    ds_read_b128 v[96:99], v1 offset:32768
    s_waitcnt lgkmcnt(4)
    v_mfma_f32_32x32x16_bf16 v[120:135], a[104:107], v[104:107], v[120:135]
    ds_read_b128 v[100:103], v1 offset:33792
    s_add_u32 m0, s42, 81920
    s_add_u32 s44, s41, 81920
    buffer_load_dwordx4 v1, s[8:11], s44 offen sc1 lds
    v_mfma_f32_32x32x16_bf16 v[120:135], a[108:111], v[108:111], v[120:135]
    ds_read_b128 v[104:107], v1 offset:34816
    s_waitcnt lgkmcnt(3)
    v_mfma_f32_32x32x16_bf16 v[120:135], v[152:155], v[158:161], v[120:135]
    s_add_u32 m0, s42, 86016
    s_add_u32 s44, s40, 57344
    buffer_load_dwordx4 v1, s[8:11], s44 offen sc1 lds
    s_waitcnt lgkmcnt(4)
    v_mfma_f32_32x32x16_bf16 v[136:151], a[0:3], v[112:115], 0
    ds_read_b128 v[108:111], v1 offset:35840
    v_mfma_f32_32x32x16_bf16 v[136:151], a[4:7], v[116:119], v[136:151]
    ds_read_b128 v[112:115], v1 offset:36864
    s_add_u32 m0, s42, 90112
    s_add_u32 s44, s40, 61440
    buffer_load_dwordx4 v1, s[8:11], s44 offen sc1 lds
    s_waitcnt lgkmcnt(3)
    v_mfma_f32_32x32x16_bf16 v[136:151], a[8:11], v[96:99], v[136:151]
    ds_read_b128 v[116:119], v1 offset:37888
    s_nop 1
    v_mul_f32 v168, v157, v120
    v_mul_f32 v169, v157, v121
    v_mul_f32 v170, v157, v122
    v_exp_f32 v168, v168
    v_mul_f32 v171, v157, v123
    v_mfma_f32_32x32x16_bf16 v[136:151], a[12:15], v[100:103], v[136:151]
    ds_read_b128 v[96:99], v1 offset:38912
    s_add_u32 m0, s42, 94208
    s_add_u32 s44, s40, 65536
    buffer_load_dwordx4 v1, s[8:11], s44 offen sc1 lds
    s_waitcnt lgkmcnt(3)
    v_mfma_f32_32x32x16_bf16 v[136:151], a[16:19], v[104:107], v[136:151]
    ds_read_b128 v[100:103], v1 offset:39936
    v_exp_f32 v169, v169
    v_mul_f32 v172, v157, v124
    v_exp_f32 v170, v170
    v_fma_f32 v168, v168, v156, v156
    v_mfma_f32_32x32x16_bf16 v[136:151], a[20:23], v[108:111], v[136:151]
    ds_read_b128 v[104:107], v1 offset:40960
    s_add_u32 m0, s42, 98304
    s_add_u32 s44, s40, 69632
    buffer_load_dwordx4 v1, s[8:11], s44 offen sc1 lds
    s_waitcnt lgkmcnt(3)
    v_mfma_f32_32x32x16_bf16 v[136:151], a[24:27], v[112:115], v[136:151]
    ds_read_b128 v[108:111], v1 offset:41984
    v_mul_f32 v173, v157, v125
    v_exp_f32 v171, v171
    v_fma_f32 v169, v169, v156, v156
    v_mul_f32 v174, v157, v126
    v_mfma_f32_32x32x16_bf16 v[136:151], a[28:31], v[116:119], v[136:151]
    ds_read_b128 v[112:115], v1 offset:43008
    s_add_u32 m0, s42, 102400
    s_add_u32 s44, s40, 73728
    buffer_load_dwordx4 v1, s[8:11], s44 offen sc1 lds
    s_waitcnt lgkmcnt(3)
    v_mfma_f32_32x32x16_bf16 v[136:151], a[32:35], v[96:99], v[136:151]
    ds_read_b128 v[116:119], v1 offset:44032
    v_exp_f32 v172, v172
    v_fma_f32 v170, v170, v156, v156
    v_rcp_f32 v168, v168
    v_mul_f32 v175, v157, v127
    v_mfma_f32_32x32x16_bf16 v[136:151], a[36:39], v[100:103], v[136:151]
    ds_read_b128 v[96:99], v1 offset:45056
    s_add_u32 m0, s42, 106496
    s_add_u32 s44, s40, 77824
    buffer_load_dwordx4 v1, s[8:11], s44 offen sc1 lds
    s_waitcnt lgkmcnt(3)
    v_mfma_f32_32x32x16_bf16 v[136:151], a[40:43], v[104:107], v[136:151]
    ds_read_b128 v[100:103], v1 offset:46080
    v_exp_f32 v173, v173
    v_fma_f32 v171, v171, v156, v156
    v_rcp_f32 v169, v169
    v_mul_f32 v176, v157, v128
    v_mfma_f32_32x32x16_bf16 v[136:151], a[44:47], v[108:111], v[136:151]
    ds_read_b128 v[104:107], v1 offset:47104
    s_add_u32 m0, s42, 110592
    s_add_u32 s44, s40, 81920
    buffer_load_dwordx4 v1, s[8:11], s44 offen sc1 lds
    s_lshl_b32 s59, s31, 7
    s_add_u32 s59, s59, s62
    s_mov_b64 exec, 1
    buffer_store_dword v10, v8, s[8:11], s59 offen offset:0 sc1
    s_mov_b64 exec, -1
    s_waitcnt lgkmcnt(3)
    v_mfma_f32_32x32x16_bf16 v[136:151], a[48:51], v[112:115], v[136:151]
    ds_read_b128 v[108:111], v1 offset:48128
    v_exp_f32 v174, v174
    v_fma_f32 v172, v172, v156, v156
    v_rcp_f32 v170, v170
    v_mul_f32 v120, v120, v168
    v_mfma_f32_32x32x16_bf16 v[136:151], a[52:55], v[116:119], v[136:151]
    ds_read_b128 v[112:115], v1 offset:49152
    v_mul_f32 v177, v157, v129
    v_exp_f32 v175, v175
    v_fma_f32 v173, v173, v156, v156
    s_waitcnt lgkmcnt(3)
    v_mfma_f32_32x32x16_bf16 v[136:151], a[56:59], v[96:99], v[136:151]
    ds_read_b128 v[116:119], v1 offset:50176
    v_rcp_f32 v171, v171
    v_mul_f32 v121, v121, v169
    v_mul_f32 v178, v157, v130
    v_exp_f32 v176, v176
    v_mfma_f32_32x32x16_bf16 v[136:151], a[60:63], v[100:103], v[136:151]
    ds_read_b128 v[96:99], v1 offset:51200
    v_fma_f32 v174, v174, v156, v156
    v_rcp_f32 v172, v172
    v_mul_f32 v122, v122, v170
    v_cvt_pk_bf16_f32 v184, v120, v121
    s_waitcnt lgkmcnt(3)
    v_mfma_f32_32x32x16_bf16 v[136:151], a[64:67], v[104:107], v[136:151]
    ds_read_b128 v[100:103], v1 offset:52224
    v_mul_f32 v179, v157, v131
    v_exp_f32 v177, v177
    v_fma_f32 v175, v175, v156, v156
    v_rcp_f32 v173, v173
    v_mfma_f32_32x32x16_bf16 v[136:151], a[68:71], v[108:111], v[136:151]
    ds_read_b128 v[104:107], v1 offset:53248
    v_mul_f32 v123, v123, v171
    v_mul_f32 v180, v157, v132
    v_exp_f32 v178, v178
    v_fma_f32 v176, v176, v156, v156
    s_waitcnt lgkmcnt(3)
    v_mfma_f32_32x32x16_bf16 v[136:151], a[72:75], v[112:115], v[136:151]
    ds_read_b128 v[108:111], v1 offset:54272
    v_rcp_f32 v174, v174
    v_mul_f32 v124, v124, v172
    v_cvt_pk_bf16_f32 v185, v122, v123
    v_mul_f32 v181, v157, v133
    v_mfma_f32_32x32x16_bf16 v[136:151], a[76:79], v[116:119], v[136:151]
    ds_read_b128 v[112:115], v1 offset:55296
    v_exp_f32 v179, v179
    v_fma_f32 v177, v177, v156, v156
    v_rcp_f32 v175, v175
    s_waitcnt lgkmcnt(3)
    v_mfma_f32_32x32x16_bf16 v[136:151], a[80:83], v[96:99], v[136:151]
    ds_read_b128 v[116:119], v1 offset:56320
    v_mul_f32 v125, v125, v173
    v_mul_f32 v182, v157, v134
    v_exp_f32 v180, v180
    v_fma_f32 v178, v178, v156, v156
    v_mfma_f32_32x32x16_bf16 v[136:151], a[84:87], v[100:103], v[136:151]
    ds_read_b128 v[96:99], v1 offset:57344
    v_rcp_f32 v176, v176
    v_mul_f32 v126, v126, v174
    v_cvt_pk_bf16_f32 v186, v124, v125
    v_mul_f32 v183, v157, v135
    s_waitcnt lgkmcnt(3)
    v_mfma_f32_32x32x16_bf16 v[136:151], a[88:91], v[104:107], v[136:151]
    ds_read_b128 v[100:103], v1 offset:58368
    v_exp_f32 v181, v181
    v_fma_f32 v179, v179, v156, v156
    v_rcp_f32 v177, v177
    v_mul_f32 v127, v127, v175
    v_mfma_f32_32x32x16_bf16 v[136:151], a[92:95], v[108:111], v[136:151]
    s_waitcnt vmcnt(8)
    s_barrier
    ds_read_b128 v[104:107], v5 offset:2048
    v_exp_f32 v182, v182
    v_fma_f32 v180, v180, v156, v156
    s_waitcnt lgkmcnt(3)
    v_mfma_f32_32x32x16_bf16 v[136:151], a[96:99], v[112:115], v[136:151]
    ds_read_b128 v[108:111], v5 offset:3072
    ds_read_b128 v[162:165], v6 offset:512
    v_rcp_f32 v178, v178
    v_mul_f32 v128, v128, v176
    v_cvt_pk_bf16_f32 v187, v126, v127
    v_mfma_f32_32x32x16_bf16 v[136:151], a[100:103], v[116:119], v[136:151]
    ds_read_b128 v[112:115], v5 offset:4096
    global_store_dwordx4 v1, v[184:187], s[72:73] offset:0 sc1
    v_exp_f32 v183, v183
    s_waitcnt lgkmcnt(4)
    v_mfma_f32_32x32x16_bf16 v[136:151], a[104:107], v[96:99], v[136:151]
    ds_read_b128 v[116:119], v5 offset:5120
    v_fma_f32 v181, v181, v156, v156
    v_rcp_f32 v179, v179
    v_mul_f32 v129, v129, v177
    v_fma_f32 v182, v182, v156, v156
    v_mfma_f32_32x32x16_bf16 v[136:151], a[108:111], v[100:103], v[136:151]
    ds_read_b128 v[96:99], v5 offset:6144
    v_rcp_f32 v180, v180
    v_mul_f32 v130, v130, v178
    v_cvt_pk_bf16_f32 v188, v128, v129
    v_fma_f32 v183, v183, v156, v156
    s_waitcnt lgkmcnt(3)
    v_mfma_f32_32x32x16_bf16 v[136:151], v[152:155], v[164:167], v[136:151]
    v_rcp_f32 v181, v181
    v_mul_f32 v131, v131, v179
    v_rcp_f32 v182, v182
    v_mul_f32 v132, v132, v180
    v_cvt_pk_bf16_f32 v189, v130, v131
    v_rcp_f32 v183, v183
    v_mul_f32 v133, v133, v181
    v_mul_f32 v134, v134, v182
    v_cvt_pk_bf16_f32 v190, v132, v133
    v_mul_f32 v135, v135, v183
    v_cvt_pk_bf16_f32 v191, v134, v135
    global_store_dwordx4 v1, v[188:191], s[72:73] offset:1024 sc1
    s_waitcnt lgkmcnt(4)
    v_mfma_f32_32x32x16_bf16 v[120:135], a[0:3], v[104:107], 0
    ds_read_b128 v[100:103], v5 offset:7168
    v_mfma_f32_32x32x16_bf16 v[120:135], a[4:7], v[108:111], v[120:135]
    ds_read_b128 v[104:107], v5 offset:8192
    s_waitcnt lgkmcnt(3)
    v_mfma_f32_32x32x16_bf16 v[120:135], a[8:11], v[112:115], v[120:135]
    ds_read_b128 v[108:111], v5 offset:9216
    s_nop 4
    v_mul_f32 v168, v163, v136
    v_mul_f32 v169, v163, v137
    v_mul_f32 v170, v163, v138
    v_exp_f32 v168, v168
    v_mul_f32 v171, v163, v139
    v_mfma_f32_32x32x16_bf16 v[120:135], a[12:15], v[116:119], v[120:135]
    ds_read_b128 v[112:115], v5 offset:10240
    v_exp_f32 v169, v169
    v_mul_f32 v172, v163, v140
    v_exp_f32 v170, v170
    s_waitcnt lgkmcnt(3)
    v_mfma_f32_32x32x16_bf16 v[120:135], a[16:19], v[96:99], v[120:135]
    ds_read_b128 v[116:119], v5 offset:11264
    v_fma_f32 v168, v168, v162, v162
    v_mul_f32 v173, v163, v141
    v_exp_f32 v171, v171
    v_fma_f32 v169, v169, v162, v162
    v_mul_f32 v174, v163, v142
    v_mfma_f32_32x32x16_bf16 v[120:135], a[20:23], v[100:103], v[120:135]
    ds_read_b128 v[96:99], v5 offset:12288
    v_exp_f32 v172, v172
    v_fma_f32 v170, v170, v162, v162
    v_rcp_f32 v168, v168
    s_waitcnt lgkmcnt(3)
    v_mfma_f32_32x32x16_bf16 v[120:135], a[24:27], v[104:107], v[120:135]
    ds_read_b128 v[100:103], v5 offset:13312
    v_mul_f32 v175, v163, v143
    v_exp_f32 v173, v173
    v_fma_f32 v171, v171, v162, v162
    v_rcp_f32 v169, v169
    v_mfma_f32_32x32x16_bf16 v[120:135], a[28:31], v[108:111], v[120:135]
    ds_read_b128 v[104:107], v5 offset:14336
    v_mul_f32 v176, v163, v144
    v_exp_f32 v174, v174
    v_fma_f32 v172, v172, v162, v162
    s_waitcnt lgkmcnt(3)
    v_mfma_f32_32x32x16_bf16 v[120:135], a[32:35], v[112:115], v[120:135]
    ds_read_b128 v[108:111], v5 offset:15360
    v_rcp_f32 v170, v170
    v_mul_f32 v136, v136, v168
    v_mul_f32 v177, v163, v145
    v_exp_f32 v175, v175
    v_mfma_f32_32x32x16_bf16 v[120:135], a[36:39], v[116:119], v[120:135]
    ds_read_b128 v[112:115], v5 offset:16384
    v_fma_f32 v173, v173, v162, v162
    v_rcp_f32 v171, v171
    v_mul_f32 v137, v137, v169
    v_mul_f32 v178, v163, v146
    s_waitcnt lgkmcnt(3)
    v_mfma_f32_32x32x16_bf16 v[120:135], a[40:43], v[96:99], v[120:135]
    ds_read_b128 v[116:119], v5 offset:17408
    v_exp_f32 v176, v176
    v_fma_f32 v174, v174, v162, v162
    v_rcp_f32 v172, v172
    v_mul_f32 v138, v138, v170
    v_mfma_f32_32x32x16_bf16 v[120:135], a[44:47], v[100:103], v[120:135]
    ds_read_b128 v[96:99], v5 offset:18432
    v_cvt_pk_bf16_f32 v184, v136, v137
    v_mul_f32 v179, v163, v147
    v_exp_f32 v177, v177
    v_fma_f32 v175, v175, v162, v162
    s_waitcnt lgkmcnt(3)
    v_mfma_f32_32x32x16_bf16 v[120:135], a[48:51], v[104:107], v[120:135]
    ds_read_b128 v[100:103], v5 offset:19456
    v_rcp_f32 v173, v173
    v_mul_f32 v139, v139, v171
    v_mul_f32 v180, v163, v148
    v_exp_f32 v178, v178
    v_mfma_f32_32x32x16_bf16 v[120:135], a[52:55], v[108:111], v[120:135]
    ds_read_b128 v[104:107], v5 offset:20480
    v_fma_f32 v176, v176, v162, v162
    v_rcp_f32 v174, v174
    v_mul_f32 v140, v140, v172
    v_cvt_pk_bf16_f32 v185, v138, v139
    s_waitcnt lgkmcnt(3)
    v_mfma_f32_32x32x16_bf16 v[120:135], a[56:59], v[112:115], v[120:135]
    ds_read_b128 v[108:111], v5 offset:21504
    v_mul_f32 v181, v163, v149
    v_exp_f32 v179, v179
    v_fma_f32 v177, v177, v162, v162
    v_rcp_f32 v175, v175
    v_mfma_f32_32x32x16_bf16 v[120:135], a[60:63], v[116:119], v[120:135]
    ds_read_b128 v[112:115], v5 offset:22528
    v_mul_f32 v141, v141, v173
    v_mul_f32 v182, v163, v150
    v_exp_f32 v180, v180
    v_fma_f32 v178, v178, v162, v162
    s_waitcnt lgkmcnt(3)
    v_mfma_f32_32x32x16_bf16 v[120:135], a[64:67], v[96:99], v[120:135]
    ds_read_b128 v[116:119], v5 offset:23552
    v_rcp_f32 v176, v176
    v_mul_f32 v142, v142, v174
    v_cvt_pk_bf16_f32 v186, v140, v141
    v_mul_f32 v183, v163, v151
    v_mfma_f32_32x32x16_bf16 v[120:135], a[68:71], v[100:103], v[120:135]
    ds_read_b128 v[96:99], v5 offset:24576
    v_exp_f32 v181, v181
    v_fma_f32 v179, v179, v162, v162
    v_rcp_f32 v177, v177
    s_waitcnt lgkmcnt(3)
    v_mfma_f32_32x32x16_bf16 v[120:135], a[72:75], v[104:107], v[120:135]
    ds_read_b128 v[100:103], v5 offset:25600
    v_mul_f32 v143, v143, v175
    v_exp_f32 v182, v182
    v_fma_f32 v180, v180, v162, v162
    v_rcp_f32 v178, v178
    v_mfma_f32_32x32x16_bf16 v[120:135], a[76:79], v[108:111], v[120:135]
    ds_read_b128 v[104:107], v5 offset:26624
    v_mul_f32 v144, v144, v176
    v_cvt_pk_bf16_f32 v187, v142, v143
    v_exp_f32 v183, v183
    v_fma_f32 v181, v181, v162, v162
    s_waitcnt lgkmcnt(3)
    v_mfma_f32_32x32x16_bf16 v[120:135], a[80:83], v[112:115], v[120:135]
    ds_read_b128 v[108:111], v5 offset:27648
    global_store_dwordx4 v1, v[184:187], s[60:61] offset:0 sc1
    v_rcp_f32 v179, v179
    v_mul_f32 v145, v145, v177
    v_mfma_f32_32x32x16_bf16 v[120:135], a[84:87], v[116:119], v[120:135]
    ds_read_b128 v[112:115], v5 offset:28672
    v_fma_f32 v182, v182, v162, v162
    v_rcp_f32 v180, v180
    v_mul_f32 v146, v146, v178
    v_cvt_pk_bf16_f32 v188, v144, v145
    s_waitcnt lgkmcnt(3)
    v_mfma_f32_32x32x16_bf16 v[120:135], a[88:91], v[96:99], v[120:135]
    ds_read_b128 v[116:119], v5 offset:29696
    v_fma_f32 v183, v183, v162, v162
    v_rcp_f32 v181, v181
    v_mul_f32 v147, v147, v179
    v_rcp_f32 v182, v182
    v_mfma_f32_32x32x16_bf16 v[120:135], a[92:95], v[100:103], v[120:135]
    s_waitcnt vmcnt(4)
    s_barrier
    ds_read_b128 v[96:99], v5 offset:30720
    v_mul_f32 v148, v148, v180
    v_cvt_pk_bf16_f32 v189, v146, v147
    s_waitcnt lgkmcnt(3)
    v_mfma_f32_32x32x16_bf16 v[120:135], a[96:99], v[104:107], v[120:135]
    ds_read_b128 v[100:103], v5 offset:31744
    ds_read_b128 v[156:159], v6 offset:1024
    v_rcp_f32 v183, v183
    v_mul_f32 v149, v149, v181
    v_mul_f32 v150, v150, v182
    v_cvt_pk_bf16_f32 v190, v148, v149
    v_mfma_f32_32x32x16_bf16 v[120:135], a[100:103], v[108:111], v[120:135]
    ds_read_b128 v[104:107], v5 offset:32768
    v_mul_f32 v151, v151, v183
    v_cvt_pk_bf16_f32 v191, v150, v151
    s_waitcnt lgkmcnt(4)
    v_mfma_f32_32x32x16_bf16 v[120:135], a[104:107], v[112:115], v[120:135]
    ds_read_b128 v[108:111], v5 offset:33792
    global_store_dwordx4 v1, v[188:191], s[60:61] offset:1024 sc1
    v_mfma_f32_32x32x16_bf16 v[120:135], a[108:111], v[116:119], v[120:135]
    ds_read_b128 v[112:115], v5 offset:34816
    s_waitcnt lgkmcnt(3)
    v_mfma_f32_32x32x16_bf16 v[120:135], v[152:155], v[158:161], v[120:135]
    s_waitcnt lgkmcnt(4)
    v_mfma_f32_32x32x16_bf16 v[136:151], a[0:3], v[96:99], 0
    ds_read_b128 v[116:119], v5 offset:35840
    v_mfma_f32_32x32x16_bf16 v[136:151], a[4:7], v[100:103], v[136:151]
    ds_read_b128 v[96:99], v5 offset:36864
    global_load_dwordx4 a[0:3], v1, s[6:7] offset:0 sc1
    s_waitcnt lgkmcnt(3)
    v_mfma_f32_32x32x16_bf16 v[136:151], a[8:11], v[104:107], v[136:151]
    ds_read_b128 v[100:103], v5 offset:37888
    s_nop 3
    v_mul_f32 v168, v157, v120
    v_mul_f32 v169, v157, v121
    v_mul_f32 v170, v157, v122
    v_exp_f32 v168, v168
    v_mul_f32 v171, v157, v123
    v_mfma_f32_32x32x16_bf16 v[136:151], a[12:15], v[108:111], v[136:151]
    ds_read_b128 v[104:107], v5 offset:38912
    global_load_dwordx4 a[4:7], v1, s[6:7] offset:1024 sc1
    v_exp_f32 v169, v169
    v_mul_f32 v172, v157, v124
    s_waitcnt lgkmcnt(3)
    v_mfma_f32_32x32x16_bf16 v[136:151], a[16:19], v[112:115], v[136:151]
    ds_read_b128 v[108:111], v5 offset:39936
    v_exp_f32 v170, v170
    v_fma_f32 v168, v168, v156, v156
    v_mul_f32 v173, v157, v125
    v_exp_f32 v171, v171
    v_mfma_f32_32x32x16_bf16 v[136:151], a[20:23], v[116:119], v[136:151]
    ds_read_b128 v[112:115], v5 offset:40960
    global_load_dwordx4 a[8:11], v12, s[6:7] offset:0 sc1
    v_fma_f32 v169, v169, v156, v156
    v_mul_f32 v174, v157, v126
    v_exp_f32 v172, v172
    s_waitcnt lgkmcnt(3)
    v_mfma_f32_32x32x16_bf16 v[136:151], a[24:27], v[96:99], v[136:151]
    ds_read_b128 v[116:119], v5 offset:41984
    v_fma_f32 v170, v170, v156, v156
    v_rcp_f32 v168, v168
    v_mul_f32 v175, v157, v127
    v_exp_f32 v173, v173
    v_mfma_f32_32x32x16_bf16 v[136:151], a[28:31], v[100:103], v[136:151]
    ds_read_b128 v[96:99], v5 offset:43008
    global_load_dwordx4 a[12:15], v12, s[6:7] offset:1024 sc1
    v_fma_f32 v171, v171, v156, v156
    v_rcp_f32 v169, v169
    v_mul_f32 v176, v157, v128
    s_waitcnt lgkmcnt(3)
    v_mfma_f32_32x32x16_bf16 v[136:151], a[32:35], v[104:107], v[136:151]
    ds_read_b128 v[100:103], v5 offset:44032
    v_exp_f32 v174, v174
    v_fma_f32 v172, v172, v156, v156
    v_rcp_f32 v170, v170
    v_mul_f32 v120, v120, v168
    v_mfma_f32_32x32x16_bf16 v[136:151], a[36:39], v[108:111], v[136:151]
    ds_read_b128 v[104:107], v5 offset:45056
    global_load_dwordx4 a[16:19], v13, s[6:7] offset:0 sc1
    v_mul_f32 v177, v157, v129
    v_exp_f32 v175, v175
    v_fma_f32 v173, v173, v156, v156
    s_waitcnt lgkmcnt(3)
    v_mfma_f32_32x32x16_bf16 v[136:151], a[40:43], v[112:115], v[136:151]
    ds_read_b128 v[108:111], v5 offset:46080
    v_rcp_f32 v171, v171
    v_mul_f32 v121, v121, v169
    v_mul_f32 v178, v157, v130
    v_exp_f32 v176, v176
    v_mfma_f32_32x32x16_bf16 v[136:151], a[44:47], v[116:119], v[136:151]
    ds_read_b128 v[112:115], v5 offset:47104
    global_load_dwordx4 a[20:23], v13, s[6:7] offset:1024 sc1
    v_fma_f32 v174, v174, v156, v156
    v_rcp_f32 v172, v172
    v_mul_f32 v122, v122, v170
    s_waitcnt lgkmcnt(3)
    v_mfma_f32_32x32x16_bf16 v[136:151], a[48:51], v[96:99], v[136:151]
    ds_read_b128 v[116:119], v5 offset:48128
    v_cvt_pk_bf16_f32 v184, v120, v121
    v_mul_f32 v179, v157, v131
    v_exp_f32 v177, v177
    v_fma_f32 v175, v175, v156, v156
    v_mfma_f32_32x32x16_bf16 v[136:151], a[52:55], v[100:103], v[136:151]
    ds_read_b128 v[96:99], v5 offset:49152
    global_load_dwordx4 a[24:27], v14, s[6:7] offset:0 sc1
    v_rcp_f32 v173, v173
    v_mul_f32 v123, v123, v171
    v_mul_f32 v180, v157, v132
    s_waitcnt lgkmcnt(3)
    v_mfma_f32_32x32x16_bf16 v[136:151], a[56:59], v[104:107], v[136:151]
    ds_read_b128 v[100:103], v5 offset:50176
    v_exp_f32 v178, v178
    v_fma_f32 v176, v176, v156, v156
    v_rcp_f32 v174, v174
    v_mul_f32 v124, v124, v172
    v_mfma_f32_32x32x16_bf16 v[136:151], a[60:63], v[108:111], v[136:151]
    ds_read_b128 v[104:107], v5 offset:51200
    global_load_dwordx4 a[28:31], v14, s[6:7] offset:1024 sc1
    v_cvt_pk_bf16_f32 v185, v122, v123
    v_mul_f32 v181, v157, v133
    v_exp_f32 v179, v179
    s_waitcnt lgkmcnt(3)
    v_mfma_f32_32x32x16_bf16 v[136:151], a[64:67], v[112:115], v[136:151]
    ds_read_b128 v[108:111], v5 offset:52224
    v_fma_f32 v177, v177, v156, v156
    v_rcp_f32 v175, v175
    v_mul_f32 v125, v125, v173
    v_mul_f32 v182, v157, v134
    v_mfma_f32_32x32x16_bf16 v[136:151], a[68:71], v[116:119], v[136:151]
    ds_read_b128 v[112:115], v5 offset:53248
    global_load_dwordx4 a[32:35], v1, s[12:13] offset:0 sc1
    v_exp_f32 v180, v180
    v_fma_f32 v178, v178, v156, v156
    s_waitcnt lgkmcnt(3)
    v_mfma_f32_32x32x16_bf16 v[136:151], a[72:75], v[96:99], v[136:151]
    ds_read_b128 v[116:119], v5 offset:54272
    v_rcp_f32 v176, v176
    v_mul_f32 v126, v126, v174
    v_cvt_pk_bf16_f32 v186, v124, v125
    v_mul_f32 v183, v157, v135
    v_mfma_f32_32x32x16_bf16 v[136:151], a[76:79], v[100:103], v[136:151]
    ds_read_b128 v[96:99], v5 offset:55296
    global_load_dwordx4 a[36:39], v1, s[12:13] offset:1024 sc1
    v_exp_f32 v181, v181
    v_fma_f32 v179, v179, v156, v156
    s_waitcnt lgkmcnt(3)
    v_mfma_f32_32x32x16_bf16 v[136:151], a[80:83], v[104:107], v[136:151]
    ds_read_b128 v[100:103], v5 offset:56320
    v_rcp_f32 v177, v177
    v_mul_f32 v127, v127, v175
    v_exp_f32 v182, v182
    v_fma_f32 v180, v180, v156, v156
    v_mfma_f32_32x32x16_bf16 v[136:151], a[84:87], v[108:111], v[136:151]
    ds_read_b128 v[104:107], v5 offset:57344
    global_load_dwordx4 a[40:43], v12, s[12:13] offset:0 sc1
    v_rcp_f32 v178, v178
    v_mul_f32 v128, v128, v176
    v_cvt_pk_bf16_f32 v187, v126, v127
    s_waitcnt lgkmcnt(3)
    v_mfma_f32_32x32x16_bf16 v[136:151], a[88:91], v[112:115], v[136:151]
    ds_read_b128 v[108:111], v5 offset:58368
    global_store_dwordx4 v15, v[184:187], s[72:73] offset:0 sc1
    v_exp_f32 v183, v183
    v_fma_f32 v181, v181, v156, v156
    v_mfma_f32_32x32x16_bf16 v[136:151], a[92:95], v[116:119], v[136:151]
    global_load_dwordx4 a[44:47], v12, s[12:13] offset:1024 sc1
    v_rcp_f32 v179, v179
    v_mul_f32 v129, v129, v177
    v_fma_f32 v182, v182, v156, v156
    s_waitcnt lgkmcnt(2)
    v_mfma_f32_32x32x16_bf16 v[136:151], a[96:99], v[96:99], v[136:151]
    ds_read_b128 v[162:165], v6 offset:1536
    v_rcp_f32 v180, v180
    v_mul_f32 v130, v130, v178
    v_cvt_pk_bf16_f32 v188, v128, v129
    v_fma_f32 v183, v183, v156, v156
    v_mfma_f32_32x32x16_bf16 v[136:151], a[100:103], v[100:103], v[136:151]
    global_load_dwordx4 a[48:51], v13, s[12:13] offset:0 sc1
    v_rcp_f32 v181, v181
    v_mul_f32 v131, v131, v179
    v_rcp_f32 v182, v182
    s_waitcnt lgkmcnt(1)
    v_mfma_f32_32x32x16_bf16 v[136:151], a[104:107], v[104:107], v[136:151]
    v_mul_f32 v132, v132, v180
    v_cvt_pk_bf16_f32 v189, v130, v131
    v_rcp_f32 v183, v183
    v_mul_f32 v133, v133, v181
    v_mul_f32 v134, v134, v182
    v_cvt_pk_bf16_f32 v190, v132, v133
    v_mul_f32 v135, v135, v183
    v_mfma_f32_32x32x16_bf16 v[136:151], a[108:111], v[108:111], v[136:151]
    global_load_dwordx4 a[52:55], v13, s[12:13] offset:1024 sc1
    v_cvt_pk_bf16_f32 v191, v134, v135
    s_waitcnt lgkmcnt(0)
    v_mfma_f32_32x32x16_bf16 v[136:151], v[152:155], v[164:167], v[136:151]
    global_store_dwordx4 v15, v[188:191], s[72:73] offset:1024 sc1
    s_lshl_b32 s43, s54, 14
    s_lshl_b32 s44, s30, 12
    s_add_u32 s43, s43, s44
    v_add_u32 v4, s43, v1
    v_xor_b32 v5, 16384, v4
    s_lshl_b32 s43, s54, 14
    s_lshl_b32 s44, s53, 11
    s_add_u32 s43, s43, s44
    v_add_u32 v160, s43, v1
    s_lshl_b32 s44, s33, 5
    v_add_u32 v161, s44, v2
    v_mul_u32_u24 v161, 896, v161
    v_lshl_add_u32 v161, v3, 4, v161
    s_lshl_b32 s44, s53, 5
    s_add_u32 s45, s45, s44
    v_add_u32 v6, 114688, v4
    v_add_u32 v7, 114688, v5
    v_add_u32 v9, 114688, v160
    s_waitcnt vmcnt(15)
    v_mfma_f32_32x32x16_bf16 v[192:207], a[112:115], a[0:3], v[192:207]
    global_load_dwordx4 a[56:59], v1, s[14:15] offset:0 sc1
    v_mul_f32 v168, v163, v136
    v_mul_f32 v169, v163, v137
    v_mul_f32 v170, v163, v138
    v_mfma_f32_32x32x16_bf16 v[208:223], a[116:119], a[0:3], 0
    v_exp_f32 v168, v168
    v_mul_f32 v171, v163, v139
    v_exp_f32 v169, v169
    v_mul_f32 v172, v163, v140
    s_waitcnt vmcnt(15)
    v_mfma_f32_32x32x16_bf16 v[192:207], a[120:123], a[4:7], v[192:207]
    global_load_dwordx4 a[60:63], v1, s[14:15] offset:1024 sc1
    v_exp_f32 v170, v170
    v_fma_f32 v168, v168, v162, v162
    v_mul_f32 v173, v163, v141
    v_mfma_f32_32x32x16_bf16 v[208:223], a[124:127], a[4:7], v[208:223]
    v_exp_f32 v171, v171
    v_fma_f32 v169, v169, v162, v162
    v_mul_f32 v174, v163, v142
    v_exp_f32 v172, v172
    v_fma_f32 v170, v170, v162, v162
    s_waitcnt vmcnt(15)
    v_mfma_f32_32x32x16_bf16 v[192:207], a[128:131], a[8:11], v[192:207]
    global_load_dwordx4 a[64:67], v12, s[14:15] offset:0 sc1
    v_rcp_f32 v168, v168
    v_mul_f32 v175, v163, v143
    v_mfma_f32_32x32x16_bf16 v[208:223], a[132:135], a[8:11], v[208:223]
    v_exp_f32 v173, v173
    v_fma_f32 v171, v171, v162, v162
    v_rcp_f32 v169, v169
    v_mul_f32 v176, v163, v144
    s_waitcnt vmcnt(15)
    v_mfma_f32_32x32x16_bf16 v[192:207], a[136:139], a[12:15], v[192:207]
    global_load_dwordx4 a[68:71], v12, s[14:15] offset:1024 sc1
    v_exp_f32 v174, v174
    v_fma_f32 v172, v172, v162, v162
    v_mfma_f32_32x32x16_bf16 v[208:223], a[140:143], a[12:15], v[208:223]
    v_rcp_f32 v170, v170
    v_mul_f32 v136, v136, v168
    v_mul_f32 v177, v163, v145
    v_exp_f32 v175, v175
    v_fma_f32 v173, v173, v162, v162
    s_waitcnt vmcnt(15)
    v_mfma_f32_32x32x16_bf16 v[192:207], a[144:147], a[16:19], v[192:207]
    global_load_dwordx4 a[72:75], v13, s[14:15] offset:0 sc1
    v_rcp_f32 v171, v171
    v_mul_f32 v137, v137, v169
    v_mul_f32 v178, v163, v146
    v_mfma_f32_32x32x16_bf16 v[208:223], a[148:151], a[16:19], v[208:223]
    v_exp_f32 v176, v176
    v_fma_f32 v174, v174, v162, v162
    v_rcp_f32 v172, v172
    v_mul_f32 v138, v138, v170
    v_cvt_pk_bf16_f32 v184, v136, v137
    s_waitcnt vmcnt(15)
    v_mfma_f32_32x32x16_bf16 v[192:207], a[152:155], a[20:23], v[192:207]
    global_load_dwordx4 a[76:79], v13, s[14:15] offset:1024 sc1
    v_mul_f32 v179, v163, v147
    v_exp_f32 v177, v177
    v_fma_f32 v175, v175, v162, v162
    v_mfma_f32_32x32x16_bf16 v[208:223], a[156:159], a[20:23], v[208:223]
    v_rcp_f32 v173, v173
    v_mul_f32 v139, v139, v171
    v_mul_f32 v180, v163, v148
    v_exp_f32 v178, v178
    v_fma_f32 v176, v176, v162, v162
    s_waitcnt vmcnt(15)
    v_mfma_f32_32x32x16_bf16 v[192:207], a[160:163], a[24:27], v[192:207]
    global_load_dwordx4 a[80:83], v14, s[14:15] offset:0 sc1
    v_rcp_f32 v174, v174
    v_mul_f32 v140, v140, v172
    v_cvt_pk_bf16_f32 v185, v138, v139
    v_mfma_f32_32x32x16_bf16 v[208:223], a[164:167], a[24:27], v[208:223]
    v_mul_f32 v181, v163, v149
    v_exp_f32 v179, v179
    v_fma_f32 v177, v177, v162, v162
    v_rcp_f32 v175, v175
    v_mul_f32 v141, v141, v173
    s_waitcnt vmcnt(15)
    v_mfma_f32_32x32x16_bf16 v[192:207], a[168:171], a[28:31], v[192:207]
    global_load_dwordx4 a[84:87], v14, s[14:15] offset:1024 sc1
    v_mul_f32 v182, v163, v150
    v_exp_f32 v180, v180
    v_fma_f32 v178, v178, v162, v162
    v_mfma_f32_32x32x16_bf16 v[208:223], a[172:175], a[28:31], v[208:223]
    v_rcp_f32 v176, v176
    v_mul_f32 v142, v142, v174
    v_cvt_pk_bf16_f32 v186, v140, v141
    v_mul_f32 v183, v163, v151
    v_exp_f32 v181, v181
    s_waitcnt vmcnt(15)
    v_mfma_f32_32x32x16_bf16 v[192:207], a[176:179], a[32:35], v[192:207]
    global_load_dwordx4 a[88:91], v1, s[20:21] offset:0 sc1
    v_fma_f32 v179, v179, v162, v162
    v_rcp_f32 v177, v177
    v_mul_f32 v143, v143, v175
    v_mfma_f32_32x32x16_bf16 v[208:223], a[180:183], a[32:35], v[208:223]
    v_exp_f32 v182, v182
    v_fma_f32 v180, v180, v162, v162
    v_rcp_f32 v178, v178
    v_mul_f32 v144, v144, v176
    v_cvt_pk_bf16_f32 v187, v142, v143
    s_waitcnt vmcnt(15)
    v_mfma_f32_32x32x16_bf16 v[192:207], a[184:187], a[36:39], v[192:207]
    global_load_dwordx4 a[92:95], v1, s[20:21] offset:1024 sc1
    global_store_dwordx4 v15, v[184:187], s[60:61] offset:0 sc1
    v_mfma_f32_32x32x16_bf16 v[208:223], a[188:191], a[36:39], v[208:223]
    v_exp_f32 v183, v183
    v_fma_f32 v181, v181, v162, v162
    v_rcp_f32 v179, v179
    v_mul_f32 v145, v145, v177
    v_fma_f32 v182, v182, v162, v162
    s_waitcnt vmcnt(16)
    v_mfma_f32_32x32x16_bf16 v[192:207], a[192:195], a[40:43], v[192:207]
    global_load_dwordx4 a[96:99], v12, s[20:21] offset:0 sc1
    v_rcp_f32 v180, v180
    v_mul_f32 v146, v146, v178
    v_cvt_pk_bf16_f32 v188, v144, v145
    v_mfma_f32_32x32x16_bf16 v[208:223], a[196:199], a[40:43], v[208:223]
    v_fma_f32 v183, v183, v162, v162
    v_rcp_f32 v181, v181
    v_mul_f32 v147, v147, v179
    v_rcp_f32 v182, v182
    v_mul_f32 v148, v148, v180
    s_waitcnt vmcnt(15)
    v_mfma_f32_32x32x16_bf16 v[192:207], a[200:203], a[44:47], v[192:207]
    global_load_dwordx4 a[100:103], v12, s[20:21] offset:1024 sc1
    v_cvt_pk_bf16_f32 v189, v146, v147
    v_rcp_f32 v183, v183
    v_mul_f32 v149, v149, v181
    v_mfma_f32_32x32x16_bf16 v[208:223], a[204:207], a[44:47], v[208:223]
    v_mul_f32 v150, v150, v182
    v_cvt_pk_bf16_f32 v190, v148, v149
    v_mul_f32 v151, v151, v183
    v_cvt_pk_bf16_f32 v191, v150, v151
    s_waitcnt vmcnt(15)
    v_mfma_f32_32x32x16_bf16 v[192:207], a[208:211], a[48:51], v[192:207]
    global_load_dwordx4 a[104:107], v13, s[20:21] offset:0 sc1
    global_store_dwordx4 v15, v[188:191], s[60:61] offset:1024 sc1
    v_mfma_f32_32x32x16_bf16 v[208:223], a[212:215], a[48:51], v[208:223]
    s_waitcnt vmcnt(16)
    v_mfma_f32_32x32x16_bf16 v[192:207], a[216:219], a[52:55], v[192:207]
    global_load_dwordx4 a[108:111], v13, s[20:21] offset:1024 sc1
    v_mfma_f32_32x32x16_bf16 v[208:223], a[220:223], a[52:55], v[208:223]
    s_waitcnt vmcnt(15)
    v_mfma_f32_32x32x16_bf16 v[192:207], a[224:227], a[56:59], v[192:207]
    global_load_dwordx4 a[0:3], v1, s[64:65] offset:0 sc1
    v_mfma_f32_32x32x16_bf16 v[208:223], a[228:231], a[56:59], v[208:223]
    s_waitcnt vmcnt(15)
    v_mfma_f32_32x32x16_bf16 v[192:207], a[232:235], a[60:63], v[192:207]
    global_load_dwordx4 a[4:7], v1, s[64:65] offset:1024 sc1
    v_mfma_f32_32x32x16_bf16 v[208:223], a[236:239], a[60:63], v[208:223]
    s_waitcnt vmcnt(15)
    v_mfma_f32_32x32x16_bf16 v[192:207], a[240:243], a[64:67], v[192:207]
    global_load_dwordx4 a[8:11], v12, s[64:65] offset:0 sc1
    v_mfma_f32_32x32x16_bf16 v[208:223], a[244:247], a[64:67], v[208:223]
    s_waitcnt vmcnt(15)
    v_mfma_f32_32x32x16_bf16 v[192:207], a[248:251], a[68:71], v[192:207]
    global_load_dwordx4 a[12:15], v12, s[64:65] offset:1024 sc1
    v_mfma_f32_32x32x16_bf16 v[208:223], a[252:255], a[68:71], v[208:223]
    s_waitcnt vmcnt(15)
    v_mfma_f32_32x32x16_bf16 v[192:207], v[16:19], a[72:75], v[192:207]
    global_load_dwordx4 a[16:19], v13, s[64:65] offset:0 sc1
    v_mfma_f32_32x32x16_bf16 v[208:223], v[20:23], a[72:75], v[208:223]
    s_waitcnt vmcnt(15)
    v_mfma_f32_32x32x16_bf16 v[192:207], v[24:27], a[76:79], v[192:207]
    global_load_dwordx4 a[20:23], v13, s[64:65] offset:1024 sc1
    v_mfma_f32_32x32x16_bf16 v[208:223], v[28:31], a[76:79], v[208:223]
    s_waitcnt vmcnt(15)
    v_mfma_f32_32x32x16_bf16 v[192:207], v[32:35], a[80:83], v[192:207]
    global_load_dwordx4 a[24:27], v14, s[64:65] offset:0 sc1
    v_mfma_f32_32x32x16_bf16 v[208:223], v[36:39], a[80:83], v[208:223]
    s_waitcnt vmcnt(15)
    v_mfma_f32_32x32x16_bf16 v[192:207], v[40:43], a[84:87], v[192:207]
    global_load_dwordx4 a[28:31], v14, s[64:65] offset:1024 sc1
    v_mfma_f32_32x32x16_bf16 v[208:223], v[44:47], a[84:87], v[208:223]
    s_waitcnt vmcnt(15)
    v_mfma_f32_32x32x16_bf16 v[192:207], v[48:51], a[88:91], v[192:207]
    global_load_dwordx4 a[32:35], v1, s[66:67] offset:0 sc1
    v_mfma_f32_32x32x16_bf16 v[208:223], v[52:55], a[88:91], v[208:223]
    s_waitcnt vmcnt(15)
    v_mfma_f32_32x32x16_bf16 v[192:207], v[56:59], a[92:95], v[192:207]
    global_load_dwordx4 a[36:39], v1, s[66:67] offset:1024 sc1
    v_mfma_f32_32x32x16_bf16 v[208:223], v[60:63], a[92:95], v[208:223]
    s_waitcnt vmcnt(14)
    v_mfma_f32_32x32x16_bf16 v[192:207], v[64:67], a[96:99], v[192:207]
    global_load_dwordx4 a[40:43], v12, s[66:67] offset:0 sc1
    v_mfma_f32_32x32x16_bf16 v[208:223], v[68:71], a[96:99], v[208:223]
    s_waitcnt vmcnt(14)
    v_mfma_f32_32x32x16_bf16 v[192:207], v[72:75], a[100:103], v[192:207]
    global_load_dwordx4 a[44:47], v12, s[66:67] offset:1024 sc1
    v_mfma_f32_32x32x16_bf16 v[208:223], v[76:79], a[100:103], v[208:223]
    s_waitcnt vmcnt(14)
    v_mfma_f32_32x32x16_bf16 v[192:207], v[80:83], a[104:107], v[192:207]
    global_load_dwordx4 a[48:51], v13, s[66:67] offset:0 sc1
    v_mfma_f32_32x32x16_bf16 v[208:223], v[84:87], a[104:107], v[208:223]
    s_waitcnt vmcnt(13)
    v_mfma_f32_32x32x16_bf16 v[192:207], v[88:91], a[108:111], v[192:207]
    global_load_dwordx4 a[52:55], v13, s[66:67] offset:1024 sc1
    v_mfma_f32_32x32x16_bf16 v[208:223], v[92:95], a[108:111], v[208:223]
    s_waitcnt vmcnt(13)
    v_mfma_f32_32x32x16_bf16 v[224:239], a[112:115], a[0:3], v[224:239]
    v_mfma_f32_32x32x16_bf16 v[240:255], a[116:119], a[0:3], 0
    s_waitcnt vmcnt(12)
    v_mfma_f32_32x32x16_bf16 v[224:239], a[120:123], a[4:7], v[224:239]
    s_mov_b32 s52, 0x4000
L_chk0:
    v_cmp_u_f32 vcc, v192, v192
    s_nop 3
    s_cbranch_vccnz L_redo0
L_ok0:
    global_load_dwordx4 a[56:59], v1, s[68:69] offset:0 sc1
    v_mfma_f32_32x32x16_bf16 v[240:255], a[124:127], a[4:7], v[240:255]
    ds_write_b128 v4, v[192:195] offset:2048
    s_waitcnt vmcnt(12)
    v_mfma_f32_32x32x16_bf16 v[224:239], a[128:131], a[8:11], v[224:239]
    global_load_dwordx4 a[60:63], v1, s[68:69] offset:1024 sc1
    v_mfma_f32_32x32x16_bf16 v[240:255], a[132:135], a[8:11], v[240:255]
    ds_write_b128 v5, v[208:211] offset:2048
    s_waitcnt vmcnt(12)
    v_mfma_f32_32x32x16_bf16 v[224:239], a[136:139], a[12:15], v[224:239]
    global_load_dwordx4 a[64:67], v12, s[68:69] offset:0 sc1
    v_mfma_f32_32x32x16_bf16 v[240:255], a[140:143], a[12:15], v[240:255]
    ds_write_b128 v4, v[196:199] offset:3072
    s_waitcnt vmcnt(12)
    v_mfma_f32_32x32x16_bf16 v[224:239], a[144:147], a[16:19], v[224:239]
    global_load_dwordx4 a[68:71], v12, s[68:69] offset:1024 sc1
    v_mfma_f32_32x32x16_bf16 v[240:255], a[148:151], a[16:19], v[240:255]
    ds_write_b128 v5, v[212:215] offset:3072
    s_waitcnt vmcnt(12)
    v_mfma_f32_32x32x16_bf16 v[224:239], a[152:155], a[20:23], v[224:239]
    global_load_dwordx4 a[72:75], v13, s[68:69] offset:0 sc1
    v_mfma_f32_32x32x16_bf16 v[240:255], a[156:159], a[20:23], v[240:255]
    ds_write_b128 v4, v[200:203] offset:4096
    s_waitcnt vmcnt(12)
    v_mfma_f32_32x32x16_bf16 v[224:239], a[160:163], a[24:27], v[224:239]
    global_load_dwordx4 a[76:79], v13, s[68:69] offset:1024 sc1
    v_mfma_f32_32x32x16_bf16 v[240:255], a[164:167], a[24:27], v[240:255]
    ds_write_b128 v5, v[216:219] offset:4096
    s_waitcnt vmcnt(12)
    v_mfma_f32_32x32x16_bf16 v[224:239], a[168:171], a[28:31], v[224:239]
    global_load_dwordx4 a[80:83], v14, s[68:69] offset:0 sc1
    v_mfma_f32_32x32x16_bf16 v[240:255], a[172:175], a[28:31], v[240:255]
    ds_write_b128 v4, v[204:207] offset:5120
    s_waitcnt vmcnt(12)
    v_mfma_f32_32x32x16_bf16 v[224:239], a[176:179], a[32:35], v[224:239]
    global_load_dwordx4 a[84:87], v14, s[68:69] offset:1024 sc1
    v_mfma_f32_32x32x16_bf16 v[240:255], a[180:183], a[32:35], v[240:255]
    ds_write_b128 v5, v[220:223] offset:5120
    s_waitcnt vmcnt(12)
    v_mfma_f32_32x32x16_bf16 v[224:239], a[184:187], a[36:39], v[224:239]
    global_load_dwordx4 a[88:91], v1, s[70:71] offset:0 sc1
    v_mfma_f32_32x32x16_bf16 v[240:255], a[188:191], a[36:39], v[240:255]
    s_waitcnt vmcnt(12)
    v_mfma_f32_32x32x16_bf16 v[224:239], a[192:195], a[40:43], v[224:239]
    global_load_dwordx4 a[92:95], v1, s[70:71] offset:1024 sc1
    v_mfma_f32_32x32x16_bf16 v[240:255], a[196:199], a[40:43], v[240:255]
    s_waitcnt vmcnt(12)
    v_mfma_f32_32x32x16_bf16 v[224:239], a[200:203], a[44:47], v[224:239]
    global_load_dwordx4 a[96:99], v12, s[70:71] offset:0 sc1
    v_mfma_f32_32x32x16_bf16 v[240:255], a[204:207], a[44:47], v[240:255]
    s_waitcnt vmcnt(12)
    v_mfma_f32_32x32x16_bf16 v[224:239], a[208:211], a[48:51], v[224:239]
    global_load_dwordx4 a[100:103], v12, s[70:71] offset:1024 sc1
    v_mfma_f32_32x32x16_bf16 v[240:255], a[212:215], a[48:51], v[240:255]
    s_waitcnt vmcnt(12)
    v_mfma_f32_32x32x16_bf16 v[224:239], a[216:219], a[52:55], v[224:239]
    global_load_dwordx4 a[104:107], v13, s[70:71] offset:0 sc1
    v_mfma_f32_32x32x16_bf16 v[240:255], a[220:223], a[52:55], v[240:255]
    s_waitcnt vmcnt(12)
    v_mfma_f32_32x32x16_bf16 v[224:239], a[224:227], a[56:59], v[224:239]
    global_load_dwordx4 a[108:111], v13, s[70:71] offset:1024 sc1
    s_waitcnt lgkmcnt(0)
    s_barrier
    v_mfma_f32_32x32x16_bf16 v[240:255], a[228:231], a[56:59], v[240:255]
    ds_read_b128 v[96:99], v160 offset:2048
    ds_read_b128 v[100:103], v160 offset:3072
    s_waitcnt vmcnt(12)
    v_mfma_f32_32x32x16_bf16 v[224:239], a[232:235], a[60:63], v[224:239]
    ds_read_b128 v[104:107], v160 offset:6144
    ds_read_b128 v[108:111], v160 offset:7168
    v_mfma_f32_32x32x16_bf16 v[240:255], a[236:239], a[60:63], v[240:255]
    ds_read_b128 v[112:115], v160 offset:10240
    ds_read_b128 v[116:119], v160 offset:11264
    s_waitcnt vmcnt(11)
    v_mfma_f32_32x32x16_bf16 v[224:239], a[240:243], a[64:67], v[224:239]
    ds_read_b128 v[120:123], v160 offset:14336
    ds_read_b128 v[124:127], v160 offset:15360
    v_mfma_f32_32x32x16_bf16 v[240:255], a[244:247], a[64:67], v[240:255]
    s_waitcnt lgkmcnt(4)
    v_add_f32 v96, v96, v104
    v_add_f32 v97, v97, v105
    v_add_f32 v98, v98, v106
    v_add_f32 v99, v99, v107
    v_add_f32 v100, v100, v108
    v_add_f32 v101, v101, v109
    s_waitcnt vmcnt(10)
    v_mfma_f32_32x32x16_bf16 v[224:239], a[248:251], a[68:71], v[224:239]
    v_add_f32 v102, v102, v110
    v_add_f32 v103, v103, v111
    s_waitcnt lgkmcnt(0)
    v_add_f32 v112, v112, v120
    v_add_f32 v113, v113, v121
    v_add_f32 v114, v114, v122
    v_mfma_f32_32x32x16_bf16 v[240:255], a[252:255], a[68:71], v[240:255]
    v_add_f32 v115, v115, v123
    v_add_f32 v116, v116, v124
    v_add_f32 v117, v117, v125
    v_add_f32 v118, v118, v126
    v_add_f32 v119, v119, v127
    v_add_f32 v96, v96, v112
    v_add_f32 v97, v97, v113
    s_waitcnt vmcnt(9)
    v_mfma_f32_32x32x16_bf16 v[224:239], v[16:19], a[72:75], v[224:239]
    v_add_f32 v98, v98, v114
    v_add_f32 v99, v99, v115
    v_add_f32 v100, v100, v116
    v_add_f32 v101, v101, v117
    v_add_f32 v102, v102, v118
    v_add_f32 v103, v103, v119
    v_mfma_f32_32x32x16_bf16 v[240:255], v[20:23], a[72:75], v[240:255]
    v_cvt_pk_bf16_f32 v104, v96, v97
    v_cvt_pk_bf16_f32 v105, v98, v99
    v_cvt_pk_bf16_f32 v106, v100, v101
    v_cvt_pk_bf16_f32 v107, v102, v103
    s_nop 1
    v_permlane32_swap_b32 v104, v106
    s_waitcnt vmcnt(8)
    v_mfma_f32_32x32x16_bf16 v[224:239], v[24:27], a[76:79], v[224:239]
    v_permlane32_swap_b32 v105, v107
    s_nop 1
    buffer_store_dwordx4 v[104:107], v161, s[16:19], s45 offen offset:0
    v_mfma_f32_32x32x16_bf16 v[240:255], v[28:31], a[76:79], v[240:255]
    s_add_u32 s45, s45, 57344
    s_waitcnt vmcnt(8)
    v_mfma_f32_32x32x16_bf16 v[224:239], v[32:35], a[80:83], v[224:239]
    v_mfma_f32_32x32x16_bf16 v[240:255], v[36:39], a[80:83], v[240:255]
    s_waitcnt vmcnt(7)
    v_mfma_f32_32x32x16_bf16 v[224:239], v[40:43], a[84:87], v[224:239]
    s_waitcnt vmcnt(6)
    v_mfma_f32_32x32x16_bf16 v[224:239], v[48:51], a[88:91], v[224:239]
    s_waitcnt vmcnt(5)
    v_mfma_f32_32x32x16_bf16 v[224:239], v[56:59], a[92:95], v[224:239]
    s_waitcnt vmcnt(4)
    v_mfma_f32_32x32x16_bf16 v[224:239], v[64:67], a[96:99], v[224:239]
    s_waitcnt vmcnt(3)
    v_mfma_f32_32x32x16_bf16 v[224:239], v[72:75], a[100:103], v[224:239]
    s_waitcnt vmcnt(2)
    v_mfma_f32_32x32x16_bf16 v[224:239], v[80:83], a[104:107], v[224:239]
    s_waitcnt vmcnt(1)
    v_mfma_f32_32x32x16_bf16 v[224:239], v[88:91], a[108:111], v[224:239]
    v_mfma_f32_32x32x16_bf16 v[240:255], v[44:47], a[84:87], v[240:255]
    v_mfma_f32_32x32x16_bf16 v[240:255], v[52:55], a[88:91], v[240:255]
    v_mfma_f32_32x32x16_bf16 v[240:255], v[60:63], a[92:95], v[240:255]
    ds_write_b128 v6, v[224:227] offset:2048
    v_mfma_f32_32x32x16_bf16 v[240:255], v[68:71], a[96:99], v[240:255]
    ds_write_b128 v6, v[228:231] offset:3072
    v_mfma_f32_32x32x16_bf16 v[240:255], v[76:79], a[100:103], v[240:255]
    ds_write_b128 v6, v[232:235] offset:4096
    v_mfma_f32_32x32x16_bf16 v[240:255], v[84:87], a[104:107], v[240:255]
    ds_write_b128 v6, v[236:239] offset:5120
    v_mfma_f32_32x32x16_bf16 v[240:255], v[92:95], a[108:111], v[240:255]
    s_mov_b32 s52, 0x4000
    v_cmp_u_f32 vcc, v224, v224
    s_nop 10
    s_cbranch_vccz L_ok1
    s_branch L_redo1
    s_nop 2
L_chk1:
    v_cmp_u_f32 vcc, v224, v224
    ds_write_b128 v6, v[224:227] offset:2048
    ds_write_b128 v6, v[228:231] offset:3072
    ds_write_b128 v6, v[232:235] offset:4096
    ds_write_b128 v6, v[236:239] offset:5120
    s_nop 5
    s_cbranch_vccnz L_redo1
L_ok1:
    ds_write_b128 v7, v[240:243] offset:2048
    ds_write_b128 v7, v[244:247] offset:3072
    ds_write_b128 v7, v[248:251] offset:4096
    ds_write_b128 v7, v[252:255] offset:5120
    s_waitcnt lgkmcnt(0)
    s_barrier
    ds_read_b128 v[96:99], v9 offset:2048
    ds_read_b128 v[100:103], v9 offset:3072
    ds_read_b128 v[104:107], v9 offset:6144
    ds_read_b128 v[108:111], v9 offset:7168
    ds_read_b128 v[112:115], v9 offset:10240
    ds_read_b128 v[116:119], v9 offset:11264
    ds_read_b128 v[120:123], v9 offset:14336
    ds_read_b128 v[124:127], v9 offset:15360
    s_waitcnt lgkmcnt(4)
    v_add_f32 v96, v96, v104
    v_add_f32 v97, v97, v105
    v_add_f32 v98, v98, v106
    v_add_f32 v99, v99, v107
    v_add_f32 v100, v100, v108
    v_add_f32 v101, v101, v109
    v_add_f32 v102, v102, v110
    v_add_f32 v103, v103, v111
    s_waitcnt lgkmcnt(0)
    v_add_f32 v112, v112, v120
    v_add_f32 v113, v113, v121
    v_add_f32 v114, v114, v122
    v_add_f32 v115, v115, v123
    v_add_f32 v116, v116, v124
    v_add_f32 v117, v117, v125
    v_add_f32 v118, v118, v126
    v_add_f32 v119, v119, v127
    v_add_f32 v96, v96, v112
    v_add_f32 v97, v97, v113
    v_add_f32 v98, v98, v114
    v_add_f32 v99, v99, v115
    v_add_f32 v100, v100, v116
    v_add_f32 v101, v101, v117
    v_add_f32 v102, v102, v118
    v_add_f32 v103, v103, v119
    v_cvt_pk_bf16_f32 v104, v96, v97
    v_cvt_pk_bf16_f32 v105, v98, v99
    v_cvt_pk_bf16_f32 v106, v100, v101
    v_cvt_pk_bf16_f32 v107, v102, v103
    s_nop 1
    v_permlane32_swap_b32 v104, v106
    v_permlane32_swap_b32 v105, v107
    s_nop 1
    buffer_store_dwordx4 v[104:107], v161, s[16:19], s45 offen offset:0
    s_endpgm
L_redo0:
    s_sub_u32 s52, s52, 1
    s_cmp_eq_u32 s52, 0
    s_cbranch_scc1 L_give0
    s_waitcnt vmcnt(0) lgkmcnt(0)
    s_sleep 4
    buffer_load_dwordx4 v[200:203], v1, s[8:11], s55 offen sc1
    buffer_load_dwordx4 v[204:207], v1, s[8:11], s55 offen offset:1024 sc1
    s_add_u32 s59, s23, 0
    buffer_load_dwordx4 a[56:59], v1, s[8:11], s59 offen offset:0 sc1
    buffer_load_dwordx4 a[60:63], v1, s[8:11], s59 offen offset:1024 sc1
    s_add_u32 s59, s23, 8192
    buffer_load_dwordx4 a[64:67], v1, s[8:11], s59 offen offset:0 sc1
    buffer_load_dwordx4 a[68:71], v1, s[8:11], s59 offen offset:1024 sc1
    s_add_u32 s59, s23, 16384
    buffer_load_dwordx4 a[72:75], v1, s[8:11], s59 offen offset:0 sc1
    buffer_load_dwordx4 a[76:79], v1, s[8:11], s59 offen offset:1024 sc1
    s_add_u32 s59, s23, 24576
    buffer_load_dwordx4 a[80:83], v1, s[8:11], s59 offen offset:0 sc1
    buffer_load_dwordx4 a[84:87], v1, s[8:11], s59 offen offset:1024 sc1
    s_add_u32 s59, s23, 32768
    buffer_load_dwordx4 a[88:91], v1, s[8:11], s59 offen offset:0 sc1
    buffer_load_dwordx4 a[92:95], v1, s[8:11], s59 offen offset:1024 sc1
    s_add_u32 s59, s23, 40960
    buffer_load_dwordx4 a[96:99], v1, s[8:11], s59 offen offset:0 sc1
    buffer_load_dwordx4 a[100:103], v1, s[8:11], s59 offen offset:1024 sc1
    s_add_u32 s59, s23, 49152
    buffer_load_dwordx4 a[104:107], v1, s[8:11], s59 offen offset:0 sc1
    buffer_load_dwordx4 a[108:111], v1, s[8:11], s59 offen offset:1024 sc1
    s_waitcnt vmcnt(0)
    v_lshlrev_b32 v192, 16, v200
    v_and_b32 v193, 0xffff0000, v200
    v_lshlrev_b32 v194, 16, v201
    v_and_b32 v195, 0xffff0000, v201
    v_lshlrev_b32 v196, 16, v202
    v_and_b32 v197, 0xffff0000, v202
    v_lshlrev_b32 v198, 16, v203
    v_and_b32 v199, 0xffff0000, v203
    v_lshlrev_b32 v200, 16, v204
    v_and_b32 v201, 0xffff0000, v204
    v_lshlrev_b32 v202, 16, v205
    v_and_b32 v203, 0xffff0000, v205
    v_lshlrev_b32 v204, 16, v206
    v_and_b32 v205, 0xffff0000, v206
    v_lshlrev_b32 v206, 16, v207
    v_and_b32 v207, 0xffff0000, v207
    s_cmp_eq_u32 s53, 0
    s_cselect_b64 exec, 0, -1
    v_mov_b32 v192, 0
    v_mov_b32 v193, 0
    v_mov_b32 v194, 0
    v_mov_b32 v195, 0
    v_mov_b32 v196, 0
    v_mov_b32 v197, 0
    v_mov_b32 v198, 0
    v_mov_b32 v199, 0
    v_mov_b32 v200, 0
    v_mov_b32 v201, 0
    v_mov_b32 v202, 0
    v_mov_b32 v203, 0
    v_mov_b32 v204, 0
    v_mov_b32 v205, 0
    v_mov_b32 v206, 0
    v_mov_b32 v207, 0
    s_mov_b64 exec, -1
    s_nop 1
    v_mfma_f32_32x32x16_bf16 v[192:207], a[112:115], a[56:59], v[192:207]
    v_mfma_f32_32x32x16_bf16 v[208:223], a[116:119], a[56:59], 0
    v_mfma_f32_32x32x16_bf16 v[192:207], a[120:123], a[60:63], v[192:207]
    v_mfma_f32_32x32x16_bf16 v[208:223], a[124:127], a[60:63], v[208:223]
    v_mfma_f32_32x32x16_bf16 v[192:207], a[128:131], a[64:67], v[192:207]
    v_mfma_f32_32x32x16_bf16 v[208:223], a[132:135], a[64:67], v[208:223]
    v_mfma_f32_32x32x16_bf16 v[192:207], a[136:139], a[68:71], v[192:207]
    v_mfma_f32_32x32x16_bf16 v[208:223], a[140:143], a[68:71], v[208:223]
    v_mfma_f32_32x32x16_bf16 v[192:207], a[144:147], a[72:75], v[192:207]
    v_mfma_f32_32x32x16_bf16 v[208:223], a[148:151], a[72:75], v[208:223]
    v_mfma_f32_32x32x16_bf16 v[192:207], a[152:155], a[76:79], v[192:207]
    v_mfma_f32_32x32x16_bf16 v[208:223], a[156:159], a[76:79], v[208:223]
    v_mfma_f32_32x32x16_bf16 v[192:207], a[160:163], a[80:83], v[192:207]
    v_mfma_f32_32x32x16_bf16 v[208:223], a[164:167], a[80:83], v[208:223]
    v_mfma_f32_32x32x16_bf16 v[192:207], a[168:171], a[84:87], v[192:207]
    v_mfma_f32_32x32x16_bf16 v[208:223], a[172:175], a[84:87], v[208:223]
    v_mfma_f32_32x32x16_bf16 v[192:207], a[176:179], a[88:91], v[192:207]
    v_mfma_f32_32x32x16_bf16 v[208:223], a[180:183], a[88:91], v[208:223]
    v_mfma_f32_32x32x16_bf16 v[192:207], a[184:187], a[92:95], v[192:207]
    v_mfma_f32_32x32x16_bf16 v[208:223], a[188:191], a[92:95], v[208:223]
    v_mfma_f32_32x32x16_bf16 v[192:207], a[192:195], a[96:99], v[192:207]
    v_mfma_f32_32x32x16_bf16 v[208:223], a[196:199], a[96:99], v[208:223]
    v_mfma_f32_32x32x16_bf16 v[192:207], a[200:203], a[100:103], v[192:207]
    v_mfma_f32_32x32x16_bf16 v[208:223], a[204:207], a[100:103], v[208:223]
    v_mfma_f32_32x32x16_bf16 v[192:207], a[208:211], a[104:107], v[192:207]
    v_mfma_f32_32x32x16_bf16 v[208:223], a[212:215], a[104:107], v[208:223]
    v_mfma_f32_32x32x16_bf16 v[192:207], a[216:219], a[108:111], v[192:207]
    v_mfma_f32_32x32x16_bf16 v[208:223], a[220:223], a[108:111], v[208:223]
    s_nop 15
    s_add_u32 s59, s24, 0
    buffer_load_dwordx4 a[56:59], v1, s[8:11], s59 offen offset:0 sc1
    buffer_load_dwordx4 a[60:63], v1, s[8:11], s59 offen offset:1024 sc1
    s_add_u32 s59, s24, 8192
    buffer_load_dwordx4 a[64:67], v1, s[8:11], s59 offen offset:0 sc1
    buffer_load_dwordx4 a[68:71], v1, s[8:11], s59 offen offset:1024 sc1
    s_add_u32 s59, s24, 16384
    buffer_load_dwordx4 a[72:75], v1, s[8:11], s59 offen offset:0 sc1
    buffer_load_dwordx4 a[76:79], v1, s[8:11], s59 offen offset:1024 sc1
    s_add_u32 s59, s24, 24576
    buffer_load_dwordx4 a[80:83], v1, s[8:11], s59 offen offset:0 sc1
    buffer_load_dwordx4 a[84:87], v1, s[8:11], s59 offen offset:1024 sc1
    s_add_u32 s59, s24, 32768
    buffer_load_dwordx4 a[88:91], v1, s[8:11], s59 offen offset:0 sc1
    buffer_load_dwordx4 a[92:95], v1, s[8:11], s59 offen offset:1024 sc1
    s_add_u32 s59, s24, 40960
    buffer_load_dwordx4 a[96:99], v1, s[8:11], s59 offen offset:0 sc1
    buffer_load_dwordx4 a[100:103], v1, s[8:11], s59 offen offset:1024 sc1
    s_add_u32 s59, s24, 49152
    buffer_load_dwordx4 a[104:107], v1, s[8:11], s59 offen offset:0 sc1
    buffer_load_dwordx4 a[108:111], v1, s[8:11], s59 offen offset:1024 sc1
    s_waitcnt vmcnt(0)
    v_mfma_f32_32x32x16_bf16 v[192:207], a[224:227], a[56:59], v[192:207]
    v_mfma_f32_32x32x16_bf16 v[208:223], a[228:231], a[56:59], v[208:223]
    v_mfma_f32_32x32x16_bf16 v[192:207], a[232:235], a[60:63], v[192:207]
    v_mfma_f32_32x32x16_bf16 v[208:223], a[236:239], a[60:63], v[208:223]
    v_mfma_f32_32x32x16_bf16 v[192:207], a[240:243], a[64:67], v[192:207]
    v_mfma_f32_32x32x16_bf16 v[208:223], a[244:247], a[64:67], v[208:223]
    v_mfma_f32_32x32x16_bf16 v[192:207], a[248:251], a[68:71], v[192:207]
    v_mfma_f32_32x32x16_bf16 v[208:223], a[252:255], a[68:71], v[208:223]
    v_mfma_f32_32x32x16_bf16 v[192:207], v[16:19], a[72:75], v[192:207]
    v_mfma_f32_32x32x16_bf16 v[208:223], v[20:23], a[72:75], v[208:223]
    v_mfma_f32_32x32x16_bf16 v[192:207], v[24:27], a[76:79], v[192:207]
    v_mfma_f32_32x32x16_bf16 v[208:223], v[28:31], a[76:79], v[208:223]
    v_mfma_f32_32x32x16_bf16 v[192:207], v[32:35], a[80:83], v[192:207]
    v_mfma_f32_32x32x16_bf16 v[208:223], v[36:39], a[80:83], v[208:223]
    v_mfma_f32_32x32x16_bf16 v[192:207], v[40:43], a[84:87], v[192:207]
    v_mfma_f32_32x32x16_bf16 v[208:223], v[44:47], a[84:87], v[208:223]
    v_mfma_f32_32x32x16_bf16 v[192:207], v[48:51], a[88:91], v[192:207]
    v_mfma_f32_32x32x16_bf16 v[208:223], v[52:55], a[88:91], v[208:223]
    v_mfma_f32_32x32x16_bf16 v[192:207], v[56:59], a[92:95], v[192:207]
    v_mfma_f32_32x32x16_bf16 v[208:223], v[60:63], a[92:95], v[208:223]
    v_mfma_f32_32x32x16_bf16 v[192:207], v[64:67], a[96:99], v[192:207]
    v_mfma_f32_32x32x16_bf16 v[208:223], v[68:71], a[96:99], v[208:223]
    v_mfma_f32_32x32x16_bf16 v[192:207], v[72:75], a[100:103], v[192:207]
    v_mfma_f32_32x32x16_bf16 v[208:223], v[76:79], a[100:103], v[208:223]
    v_mfma_f32_32x32x16_bf16 v[192:207], v[80:83], a[104:107], v[192:207]
    v_mfma_f32_32x32x16_bf16 v[208:223], v[84:87], a[104:107], v[208:223]
    v_mfma_f32_32x32x16_bf16 v[192:207], v[88:91], a[108:111], v[192:207]
    v_mfma_f32_32x32x16_bf16 v[208:223], v[92:95], a[108:111], v[208:223]
    s_nop 15
    s_nop 3
    s_branch L_chk0
L_give0:
    s_branch L_ok0
L_redo1:
    s_sub_u32 s52, s52, 1
    s_cmp_eq_u32 s52, 0
    s_cbranch_scc1 L_give1
    s_waitcnt vmcnt(0) lgkmcnt(0)
    s_sleep 4
    buffer_load_dwordx4 v[232:235], v1, s[8:11], s55 offen sc1
    buffer_load_dwordx4 v[236:239], v1, s[8:11], s55 offen offset:1024 sc1
    s_add_u32 s59, s23, 229376
    buffer_load_dwordx4 a[56:59], v1, s[8:11], s59 offen offset:0 sc1
    buffer_load_dwordx4 a[60:63], v1, s[8:11], s59 offen offset:1024 sc1
    s_add_u32 s59, s23, 237568
    buffer_load_dwordx4 a[64:67], v1, s[8:11], s59 offen offset:0 sc1
    buffer_load_dwordx4 a[68:71], v1, s[8:11], s59 offen offset:1024 sc1
    s_add_u32 s59, s23, 245760
    buffer_load_dwordx4 a[72:75], v1, s[8:11], s59 offen offset:0 sc1
    buffer_load_dwordx4 a[76:79], v1, s[8:11], s59 offen offset:1024 sc1
    s_add_u32 s59, s23, 253952
    buffer_load_dwordx4 a[80:83], v1, s[8:11], s59 offen offset:0 sc1
    buffer_load_dwordx4 a[84:87], v1, s[8:11], s59 offen offset:1024 sc1
    s_add_u32 s59, s23, 262144
    buffer_load_dwordx4 a[88:91], v1, s[8:11], s59 offen offset:0 sc1
    buffer_load_dwordx4 a[92:95], v1, s[8:11], s59 offen offset:1024 sc1
    s_add_u32 s59, s23, 270336
    buffer_load_dwordx4 a[96:99], v1, s[8:11], s59 offen offset:0 sc1
    buffer_load_dwordx4 a[100:103], v1, s[8:11], s59 offen offset:1024 sc1
    s_add_u32 s59, s23, 278528
    buffer_load_dwordx4 a[104:107], v1, s[8:11], s59 offen offset:0 sc1
    buffer_load_dwordx4 a[108:111], v1, s[8:11], s59 offen offset:1024 sc1
    s_waitcnt vmcnt(0)
    v_lshlrev_b32 v224, 16, v232
    v_and_b32 v225, 0xffff0000, v232
    v_lshlrev_b32 v226, 16, v233
    v_and_b32 v227, 0xffff0000, v233
    v_lshlrev_b32 v228, 16, v234
    v_and_b32 v229, 0xffff0000, v234
    v_lshlrev_b32 v230, 16, v235
    v_and_b32 v231, 0xffff0000, v235
    v_lshlrev_b32 v232, 16, v236
    v_and_b32 v233, 0xffff0000, v236
    v_lshlrev_b32 v234, 16, v237
    v_and_b32 v235, 0xffff0000, v237
    v_lshlrev_b32 v236, 16, v238
    v_and_b32 v237, 0xffff0000, v238
    v_lshlrev_b32 v238, 16, v239
    v_and_b32 v239, 0xffff0000, v239
    s_cmp_eq_u32 s53, 1
    s_cselect_b64 exec, 0, -1
    v_mov_b32 v224, 0
    v_mov_b32 v225, 0
    v_mov_b32 v226, 0
    v_mov_b32 v227, 0
    v_mov_b32 v228, 0
    v_mov_b32 v229, 0
    v_mov_b32 v230, 0
    v_mov_b32 v231, 0
    v_mov_b32 v232, 0
    v_mov_b32 v233, 0
    v_mov_b32 v234, 0
    v_mov_b32 v235, 0
    v_mov_b32 v236, 0
    v_mov_b32 v237, 0
    v_mov_b32 v238, 0
    v_mov_b32 v239, 0
    s_mov_b64 exec, -1
    s_nop 1
    v_mfma_f32_32x32x16_bf16 v[224:239], a[112:115], a[56:59], v[224:239]
    v_mfma_f32_32x32x16_bf16 v[240:255], a[116:119], a[56:59], 0
    v_mfma_f32_32x32x16_bf16 v[224:239], a[120:123], a[60:63], v[224:239]
    v_mfma_f32_32x32x16_bf16 v[240:255], a[124:127], a[60:63], v[240:255]
    v_mfma_f32_32x32x16_bf16 v[224:239], a[128:131], a[64:67], v[224:239]
    v_mfma_f32_32x32x16_bf16 v[240:255], a[132:135], a[64:67], v[240:255]
    v_mfma_f32_32x32x16_bf16 v[224:239], a[136:139], a[68:71], v[224:239]
    v_mfma_f32_32x32x16_bf16 v[240:255], a[140:143], a[68:71], v[240:255]
    v_mfma_f32_32x32x16_bf16 v[224:239], a[144:147], a[72:75], v[224:239]
    v_mfma_f32_32x32x16_bf16 v[240:255], a[148:151], a[72:75], v[240:255]
    v_mfma_f32_32x32x16_bf16 v[224:239], a[152:155], a[76:79], v[224:239]
    v_mfma_f32_32x32x16_bf16 v[240:255], a[156:159], a[76:79], v[240:255]
    v_mfma_f32_32x32x16_bf16 v[224:239], a[160:163], a[80:83], v[224:239]
    v_mfma_f32_32x32x16_bf16 v[240:255], a[164:167], a[80:83], v[240:255]
    v_mfma_f32_32x32x16_bf16 v[224:239], a[168:171], a[84:87], v[224:239]
    v_mfma_f32_32x32x16_bf16 v[240:255], a[172:175], a[84:87], v[240:255]
    v_mfma_f32_32x32x16_bf16 v[224:239], a[176:179], a[88:91], v[224:239]
    v_mfma_f32_32x32x16_bf16 v[240:255], a[180:183], a[88:91], v[240:255]
    v_mfma_f32_32x32x16_bf16 v[224:239], a[184:187], a[92:95], v[224:239]
    v_mfma_f32_32x32x16_bf16 v[240:255], a[188:191], a[92:95], v[240:255]
    v_mfma_f32_32x32x16_bf16 v[224:239], a[192:195], a[96:99], v[224:239]
    v_mfma_f32_32x32x16_bf16 v[240:255], a[196:199], a[96:99], v[240:255]
    v_mfma_f32_32x32x16_bf16 v[224:239], a[200:203], a[100:103], v[224:239]
    v_mfma_f32_32x32x16_bf16 v[240:255], a[204:207], a[100:103], v[240:255]
    v_mfma_f32_32x32x16_bf16 v[224:239], a[208:211], a[104:107], v[224:239]
    v_mfma_f32_32x32x16_bf16 v[240:255], a[212:215], a[104:107], v[240:255]
    v_mfma_f32_32x32x16_bf16 v[224:239], a[216:219], a[108:111], v[224:239]
    v_mfma_f32_32x32x16_bf16 v[240:255], a[220:223], a[108:111], v[240:255]
    s_nop 15
    s_add_u32 s59, s24, 229376
    buffer_load_dwordx4 a[56:59], v1, s[8:11], s59 offen offset:0 sc1
    buffer_load_dwordx4 a[60:63], v1, s[8:11], s59 offen offset:1024 sc1
    s_add_u32 s59, s24, 237568
    buffer_load_dwordx4 a[64:67], v1, s[8:11], s59 offen offset:0 sc1
    buffer_load_dwordx4 a[68:71], v1, s[8:11], s59 offen offset:1024 sc1
    s_add_u32 s59, s24, 245760
    buffer_load_dwordx4 a[72:75], v1, s[8:11], s59 offen offset:0 sc1
    buffer_load_dwordx4 a[76:79], v1, s[8:11], s59 offen offset:1024 sc1
    s_add_u32 s59, s24, 253952
    buffer_load_dwordx4 a[80:83], v1, s[8:11], s59 offen offset:0 sc1
    buffer_load_dwordx4 a[84:87], v1, s[8:11], s59 offen offset:1024 sc1
    s_add_u32 s59, s24, 262144
    buffer_load_dwordx4 a[88:91], v1, s[8:11], s59 offen offset:0 sc1
    buffer_load_dwordx4 a[92:95], v1, s[8:11], s59 offen offset:1024 sc1
    s_add_u32 s59, s24, 270336
    buffer_load_dwordx4 a[96:99], v1, s[8:11], s59 offen offset:0 sc1
    buffer_load_dwordx4 a[100:103], v1, s[8:11], s59 offen offset:1024 sc1
    s_add_u32 s59, s24, 278528
    buffer_load_dwordx4 a[104:107], v1, s[8:11], s59 offen offset:0 sc1
    buffer_load_dwordx4 a[108:111], v1, s[8:11], s59 offen offset:1024 sc1
    s_waitcnt vmcnt(0)
    v_mfma_f32_32x32x16_bf16 v[224:239], a[224:227], a[56:59], v[224:239]
    v_mfma_f32_32x32x16_bf16 v[240:255], a[228:231], a[56:59], v[240:255]
    v_mfma_f32_32x32x16_bf16 v[224:239], a[232:235], a[60:63], v[224:239]
    v_mfma_f32_32x32x16_bf16 v[240:255], a[236:239], a[60:63], v[240:255]
    v_mfma_f32_32x32x16_bf16 v[224:239], a[240:243], a[64:67], v[224:239]
    v_mfma_f32_32x32x16_bf16 v[240:255], a[244:247], a[64:67], v[240:255]
    v_mfma_f32_32x32x16_bf16 v[224:239], a[248:251], a[68:71], v[224:239]
    v_mfma_f32_32x32x16_bf16 v[240:255], a[252:255], a[68:71], v[240:255]
    v_mfma_f32_32x32x16_bf16 v[224:239], v[16:19], a[72:75], v[224:239]
    v_mfma_f32_32x32x16_bf16 v[240:255], v[20:23], a[72:75], v[240:255]
    v_mfma_f32_32x32x16_bf16 v[224:239], v[24:27], a[76:79], v[224:239]
    v_mfma_f32_32x32x16_bf16 v[240:255], v[28:31], a[76:79], v[240:255]
    v_mfma_f32_32x32x16_bf16 v[224:239], v[32:35], a[80:83], v[224:239]
    v_mfma_f32_32x32x16_bf16 v[240:255], v[36:39], a[80:83], v[240:255]
    v_mfma_f32_32x32x16_bf16 v[224:239], v[40:43], a[84:87], v[224:239]
    v_mfma_f32_32x32x16_bf16 v[240:255], v[44:47], a[84:87], v[240:255]
    v_mfma_f32_32x32x16_bf16 v[224:239], v[48:51], a[88:91], v[224:239]
    v_mfma_f32_32x32x16_bf16 v[240:255], v[52:55], a[88:91], v[240:255]
    v_mfma_f32_32x32x16_bf16 v[224:239], v[56:59], a[92:95], v[224:239]
    v_mfma_f32_32x32x16_bf16 v[240:255], v[60:63], a[92:95], v[240:255]
    v_mfma_f32_32x32x16_bf16 v[224:239], v[64:67], a[96:99], v[224:239]
    v_mfma_f32_32x32x16_bf16 v[240:255], v[68:71], a[96:99], v[240:255]
    v_mfma_f32_32x32x16_bf16 v[224:239], v[72:75], a[100:103], v[224:239]
    v_mfma_f32_32x32x16_bf16 v[240:255], v[76:79], a[100:103], v[240:255]
    v_mfma_f32_32x32x16_bf16 v[224:239], v[80:83], a[104:107], v[224:239]
    v_mfma_f32_32x32x16_bf16 v[240:255], v[84:87], a[104:107], v[240:255]
    v_mfma_f32_32x32x16_bf16 v[224:239], v[88:91], a[108:111], v[224:239]
    v_mfma_f32_32x32x16_bf16 v[240:255], v[92:95], a[108:111], v[240:255]
    s_nop 15
    s_nop 3
    s_branch L_chk1
L_give1:
    s_branch L_ok1
L_redoO:
    s_sub_u32 s52, s52, 1
    s_cmp_eq_u32 s52, 0
    s_cbranch_scc1 L_okO
    s_waitcnt vmcnt(0) lgkmcnt(0)
    s_sleep 4
    s_lshl_b32 s59, s36, 15
    s_add_u32 s59, s59, 6291456
    v_lshlrev_b32 v96, 16, v248
    v_and_b32 v97, 0xffff0000, v248
    v_lshlrev_b32 v98, 16, v249
    v_and_b32 v99, 0xffff0000, v249
    v_lshlrev_b32 v100, 16, v250
    v_and_b32 v101, 0xffff0000, v250
    v_lshlrev_b32 v102, 16, v251
    v_and_b32 v103, 0xffff0000, v251
    v_lshlrev_b32 v104, 16, v252
    v_and_b32 v105, 0xffff0000, v252
    v_lshlrev_b32 v106, 16, v253
    v_and_b32 v107, 0xffff0000, v253
    v_lshlrev_b32 v108, 16, v254
    v_and_b32 v109, 0xffff0000, v254
    v_lshlrev_b32 v110, 16, v255
    v_and_b32 v111, 0xffff0000, v255
    buffer_load_dwordx4 v[192:195], v1, s[8:11], s59 offen offset:0 sc1
    ds_read_b128 v[112:115], v5 offset:0
    buffer_load_dwordx4 v[196:199], v1, s[8:11], s59 offen offset:1024 sc1
    ds_read_b128 v[116:119], v5 offset:1024
    buffer_load_dwordx4 v[200:203], v1, s[8:11], s59 offen offset:2048 sc1
    ds_read_b128 v[120:123], v5 offset:2048
    buffer_load_dwordx4 v[204:207], v1, s[8:11], s59 offen offset:3072 sc1
    ds_read_b128 v[124:127], v5 offset:3072
    s_add_u32 s59, s59, 4096
    buffer_load_dwordx4 v[208:211], v1, s[8:11], s59 offen offset:0 sc1
    ds_read_b128 v[128:131], v5 offset:4096
    buffer_load_dwordx4 v[212:215], v1, s[8:11], s59 offen offset:1024 sc1
    ds_read_b128 v[132:135], v5 offset:5120
    buffer_load_dwordx4 v[216:219], v1, s[8:11], s59 offen offset:2048 sc1
    ds_read_b128 v[136:139], v5 offset:6144
    buffer_load_dwordx4 v[220:223], v1, s[8:11], s59 offen offset:3072 sc1
    ds_read_b128 v[140:143], v5 offset:7168
    s_add_u32 s59, s59, 4096
    s_waitcnt vmcnt(0) lgkmcnt(0)
    v_mfma_f32_32x32x16_bf16 v[96:111], v[112:115], v[192:195], v[96:111]
    v_mfma_f32_32x32x16_bf16 v[96:111], v[116:119], v[196:199], v[96:111]
    v_mfma_f32_32x32x16_bf16 v[96:111], v[120:123], v[200:203], v[96:111]
    v_mfma_f32_32x32x16_bf16 v[96:111], v[124:127], v[204:207], v[96:111]
    v_mfma_f32_32x32x16_bf16 v[96:111], v[128:131], v[208:211], v[96:111]
    v_mfma_f32_32x32x16_bf16 v[96:111], v[132:135], v[212:215], v[96:111]
    v_mfma_f32_32x32x16_bf16 v[96:111], v[136:139], v[216:219], v[96:111]
    v_mfma_f32_32x32x16_bf16 v[96:111], v[140:143], v[220:223], v[96:111]
    s_nop 15
    buffer_load_dwordx4 v[192:195], v1, s[8:11], s59 offen offset:0 sc1
    ds_read_b128 v[112:115], v5 offset:8192
    buffer_load_dwordx4 v[196:199], v1, s[8:11], s59 offen offset:1024 sc1
    ds_read_b128 v[116:119], v5 offset:9216
    buffer_load_dwordx4 v[200:203], v1, s[8:11], s59 offen offset:2048 sc1
    ds_read_b128 v[120:123], v5 offset:10240
    buffer_load_dwordx4 v[204:207], v1, s[8:11], s59 offen offset:3072 sc1
    ds_read_b128 v[124:127], v5 offset:11264
    s_add_u32 s59, s59, 4096
    buffer_load_dwordx4 v[208:211], v1, s[8:11], s59 offen offset:0 sc1
    ds_read_b128 v[128:131], v5 offset:12288
    buffer_load_dwordx4 v[212:215], v1, s[8:11], s59 offen offset:1024 sc1
    ds_read_b128 v[132:135], v5 offset:13312
    buffer_load_dwordx4 v[216:219], v1, s[8:11], s59 offen offset:2048 sc1
    ds_read_b128 v[136:139], v5 offset:14336
    buffer_load_dwordx4 v[220:223], v1, s[8:11], s59 offen offset:3072 sc1
    ds_read_b128 v[140:143], v5 offset:15360
    s_add_u32 s59, s59, 4096
    s_waitcnt vmcnt(0) lgkmcnt(0)
    v_mfma_f32_32x32x16_bf16 v[96:111], v[112:115], v[192:195], v[96:111]
    v_mfma_f32_32x32x16_bf16 v[96:111], v[116:119], v[196:199], v[96:111]
    v_mfma_f32_32x32x16_bf16 v[96:111], v[120:123], v[200:203], v[96:111]
    v_mfma_f32_32x32x16_bf16 v[96:111], v[124:127], v[204:207], v[96:111]
    v_mfma_f32_32x32x16_bf16 v[96:111], v[128:131], v[208:211], v[96:111]
    v_mfma_f32_32x32x16_bf16 v[96:111], v[132:135], v[212:215], v[96:111]
    v_mfma_f32_32x32x16_bf16 v[96:111], v[136:139], v[216:219], v[96:111]
    v_mfma_f32_32x32x16_bf16 v[96:111], v[140:143], v[220:223], v[96:111]
    s_nop 15
    buffer_load_dwordx4 v[192:195], v1, s[8:11], s59 offen offset:0 sc1
    ds_read_b128 v[112:115], v5 offset:16384
    buffer_load_dwordx4 v[196:199], v1, s[8:11], s59 offen offset:1024 sc1
    ds_read_b128 v[116:119], v5 offset:17408
    buffer_load_dwordx4 v[200:203], v1, s[8:11], s59 offen offset:2048 sc1
    ds_read_b128 v[120:123], v5 offset:18432
    buffer_load_dwordx4 v[204:207], v1, s[8:11], s59 offen offset:3072 sc1
    ds_read_b128 v[124:127], v5 offset:19456
    s_add_u32 s59, s59, 4096
    buffer_load_dwordx4 v[208:211], v1, s[8:11], s59 offen offset:0 sc1
    ds_read_b128 v[128:131], v5 offset:20480
    buffer_load_dwordx4 v[212:215], v1, s[8:11], s59 offen offset:1024 sc1
    ds_read_b128 v[132:135], v5 offset:21504
    buffer_load_dwordx4 v[216:219], v1, s[8:11], s59 offen offset:2048 sc1
    ds_read_b128 v[136:139], v5 offset:22528
    buffer_load_dwordx4 v[220:223], v1, s[8:11], s59 offen offset:3072 sc1
    ds_read_b128 v[140:143], v5 offset:23552
    s_add_u32 s59, s59, 4096
    s_waitcnt vmcnt(0) lgkmcnt(0)
    v_mfma_f32_32x32x16_bf16 v[96:111], v[112:115], v[192:195], v[96:111]
    v_mfma_f32_32x32x16_bf16 v[96:111], v[116:119], v[196:199], v[96:111]
    v_mfma_f32_32x32x16_bf16 v[96:111], v[120:123], v[200:203], v[96:111]
    v_mfma_f32_32x32x16_bf16 v[96:111], v[124:127], v[204:207], v[96:111]
    v_mfma_f32_32x32x16_bf16 v[96:111], v[128:131], v[208:211], v[96:111]
    v_mfma_f32_32x32x16_bf16 v[96:111], v[132:135], v[212:215], v[96:111]
    v_mfma_f32_32x32x16_bf16 v[96:111], v[136:139], v[216:219], v[96:111]
    v_mfma_f32_32x32x16_bf16 v[96:111], v[140:143], v[220:223], v[96:111]
    s_nop 15
    buffer_load_dwordx4 v[192:195], v1, s[8:11], s59 offen offset:0 sc1
    ds_read_b128 v[112:115], v5 offset:24576
    buffer_load_dwordx4 v[196:199], v1, s[8:11], s59 offen offset:1024 sc1
    ds_read_b128 v[116:119], v5 offset:25600
    buffer_load_dwordx4 v[200:203], v1, s[8:11], s59 offen offset:2048 sc1
    ds_read_b128 v[120:123], v5 offset:26624
    buffer_load_dwordx4 v[204:207], v1, s[8:11], s59 offen offset:3072 sc1
    ds_read_b128 v[124:127], v5 offset:27648
    s_add_u32 s59, s59, 4096
    buffer_load_dwordx4 v[208:211], v1, s[8:11], s59 offen offset:0 sc1
    ds_read_b128 v[128:131], v5 offset:28672
    buffer_load_dwordx4 v[212:215], v1, s[8:11], s59 offen offset:1024 sc1
    ds_read_b128 v[132:135], v5 offset:29696
    buffer_load_dwordx4 v[216:219], v1, s[8:11], s59 offen offset:2048 sc1
    ds_read_b128 v[136:139], v5 offset:30720
    buffer_load_dwordx4 v[220:223], v1, s[8:11], s59 offen offset:3072 sc1
    ds_read_b128 v[140:143], v5 offset:31744
    s_add_u32 s59, s59, 4096
    s_waitcnt vmcnt(0) lgkmcnt(0)
    v_mfma_f32_32x32x16_bf16 v[96:111], v[112:115], v[192:195], v[96:111]
    v_mfma_f32_32x32x16_bf16 v[96:111], v[116:119], v[196:199], v[96:111]
    v_mfma_f32_32x32x16_bf16 v[96:111], v[120:123], v[200:203], v[96:111]
    v_mfma_f32_32x32x16_bf16 v[96:111], v[124:127], v[204:207], v[96:111]
    v_mfma_f32_32x32x16_bf16 v[96:111], v[128:131], v[208:211], v[96:111]
    v_mfma_f32_32x32x16_bf16 v[96:111], v[132:135], v[212:215], v[96:111]
    v_mfma_f32_32x32x16_bf16 v[96:111], v[136:139], v[216:219], v[96:111]
    v_mfma_f32_32x32x16_bf16 v[96:111], v[140:143], v[220:223], v[96:111]
    s_nop 15
    s_nop 3
    s_branch L_chkO
L_att_fallback:
    s_waitcnt vmcnt(0) lgkmcnt(0)
    buffer_load_dwordx4 v[16:19], v1, s[8:11], s24 offen
    buffer_load_dwordx4 v[20:23], v1, s[8:11], s24 offen offset:1024
    s_xor_b32 s37, s24, 2048
    buffer_load_dwordx4 v[24:27], v1, s[8:11], s37 offen
    buffer_load_dwordx4 v[28:31], v1, s[8:11], s37 offen offset:1024
    s_xor_b32 s37, s24, 4096
    buffer_load_dwordx4 v[32:35], v1, s[8:11], s37 offen
    buffer_load_dwordx4 v[36:39], v1, s[8:11], s37 offen offset:1024
    s_xor_b32 s37, s24, 6144
    buffer_load_dwordx4 v[40:43], v1, s[8:11], s37 offen
    buffer_load_dwordx4 v[44:47], v1, s[8:11], s37 offen offset:1024
    s_waitcnt vmcnt(0)
    s_mov_b32 exec_lo, 0
    v_mov_b32 v22, 0
    v_mov_b32 v30, 0
    v_mov_b32 v38, 0
    v_mov_b32 v46, 0
    s_mov_b32 exec_lo, -1
    v_mov_b32 v224, 0xff800000
    v_mov_b32 v225, 0xff800000
    v_mov_b32 v226, 0xff800000
    v_mov_b32 v227, 0xff800000
    s_mov_b32 s26, 0
    s_mov_b32 s37, s25
L_att_fbloop:
    buffer_load_dwordx4 v[96:99], v1, s[8:11], s37 offen offset:0
    buffer_load_dwordx4 v[100:103], v1, s[8:11], s37 offen offset:1024
    s_waitcnt vmcnt(0)
    v_mfma_f32_32x32x16_bf16 v[160:175], v[96:99], v[16:19], 0
    v_mfma_f32_32x32x16_bf16 v[160:175], v[100:103], v[20:23], v[160:175]
    v_mfma_f32_32x32x16_bf16 v[176:191], v[96:99], v[24:27], 0
    v_mfma_f32_32x32x16_bf16 v[176:191], v[100:103], v[28:31], v[176:191]
    v_mfma_f32_32x32x16_bf16 v[192:207], v[96:99], v[32:35], 0
    v_mfma_f32_32x32x16_bf16 v[192:207], v[100:103], v[36:39], v[192:207]
    v_mfma_f32_32x32x16_bf16 v[208:223], v[96:99], v[40:43], 0
    v_mfma_f32_32x32x16_bf16 v[208:223], v[100:103], v[44:47], v[208:223]
    s_nop 11
    v_max3_f32 v224, v224, v160, v161
    v_max3_f32 v224, v224, v162, v163
    v_max3_f32 v224, v224, v164, v165
    v_max3_f32 v224, v224, v166, v167
    v_max3_f32 v224, v224, v168, v169
    v_max3_f32 v224, v224, v170, v171
    v_max3_f32 v224, v224, v172, v173
    v_max3_f32 v224, v224, v174, v175
    v_max3_f32 v225, v225, v176, v177
    v_max3_f32 v225, v225, v178, v179
    v_max3_f32 v225, v225, v180, v181
    v_max3_f32 v225, v225, v182, v183
    v_max3_f32 v225, v225, v184, v185
    v_max3_f32 v225, v225, v186, v187
    v_max3_f32 v225, v225, v188, v189
    v_max3_f32 v225, v225, v190, v191
    v_max3_f32 v226, v226, v192, v193
    v_max3_f32 v226, v226, v194, v195
    v_max3_f32 v226, v226, v196, v197
    v_max3_f32 v226, v226, v198, v199
    v_max3_f32 v226, v226, v200, v201
    v_max3_f32 v226, v226, v202, v203
    v_max3_f32 v226, v226, v204, v205
    v_max3_f32 v226, v226, v206, v207
    v_max3_f32 v227, v227, v208, v209
    v_max3_f32 v227, v227, v210, v211
    v_max3_f32 v227, v227, v212, v213
    v_max3_f32 v227, v227, v214, v215
    v_max3_f32 v227, v227, v216, v217
    v_max3_f32 v227, v227, v218, v219
    v_max3_f32 v227, v227, v220, v221
    v_max3_f32 v227, v227, v222, v223
    s_add_u32 s37, s37, 2048
    s_add_u32 s26, s26, 1
    s_cmp_lt_u32 s26, 16
    s_cbranch_scc1 L_att_fbloop
    v_mov_b32 v228, v224
    v_mov_b32 v229, v225
    v_mov_b32 v230, v226
    v_mov_b32 v231, v227
    s_nop 1
    v_permlane32_swap_b32 v224, v228
    v_permlane32_swap_b32 v225, v229
    v_permlane32_swap_b32 v226, v230
    v_permlane32_swap_b32 v227, v231
    s_nop 0
    v_max_f32 v224, v224, v228
    v_max_f32 v225, v225, v229
    v_max_f32 v226, v226, v230
    v_max_f32 v227, v227, v231
    s_barrier
    v_and_b32 v4, 31, v0
    v_lshlrev_b32 v4, 2, v4
    s_lshl_b32 s27, s30, 7
    s_xor_b32 s26, s30, 0
    s_lshl_b32 s26, s26, 9
    v_add_u32 v232, s26, v4
    v_add_u32 v3, s27, v232
    ds_write_b32 v3, v224 offset:2048
    s_xor_b32 s26, s30, 1
    s_lshl_b32 s26, s26, 9
    v_add_u32 v233, s26, v4
    v_add_u32 v3, s27, v233
    ds_write_b32 v3, v225 offset:2048
    s_xor_b32 s26, s30, 2
    s_lshl_b32 s26, s26, 9
    v_add_u32 v234, s26, v4
    v_add_u32 v3, s27, v234
    ds_write_b32 v3, v226 offset:2048
    s_xor_b32 s26, s30, 3
    s_lshl_b32 s26, s26, 9
    v_add_u32 v235, s26, v4
    v_add_u32 v3, s27, v235
    ds_write_b32 v3, v227 offset:2048
    s_waitcnt lgkmcnt(0)
    s_barrier
    ds_read_b32 v48, v232 offset:2048
    ds_read_b32 v49, v232 offset:2176
    ds_read_b32 v50, v232 offset:2304
    ds_read_b32 v51, v232 offset:2432
    s_waitcnt lgkmcnt(0)
    v_max3_f32 v224, v48, v49, v50
    v_max_f32 v224, v224, v51
    ds_read_b32 v52, v233 offset:2048
    ds_read_b32 v53, v233 offset:2176
    ds_read_b32 v54, v233 offset:2304
    ds_read_b32 v55, v233 offset:2432
    s_waitcnt lgkmcnt(0)
    v_max3_f32 v225, v52, v53, v54
    v_max_f32 v225, v225, v55
    ds_read_b32 v56, v234 offset:2048
    ds_read_b32 v57, v234 offset:2176
    ds_read_b32 v58, v234 offset:2304
    ds_read_b32 v59, v234 offset:2432
    s_waitcnt lgkmcnt(0)
    v_max3_f32 v226, v56, v57, v58
    v_max_f32 v226, v226, v59
    ds_read_b32 v60, v235 offset:2048
    ds_read_b32 v61, v235 offset:2176
    ds_read_b32 v62, v235 offset:2304
    ds_read_b32 v63, v235 offset:2432
    s_waitcnt lgkmcnt(0)
    v_max3_f32 v227, v60, v61, v62
    v_max_f32 v227, v227, v63
    s_mov_b32 exec_lo, 0
    v_cvt_pk_bf16_f32 v22, -v224, 0
    v_cvt_pk_bf16_f32 v30, -v225, 0
    v_cvt_pk_bf16_f32 v38, -v226, 0
    v_cvt_pk_bf16_f32 v46, -v227, 0
    s_mov_b32 exec_lo, -1
    s_mov_b32 s3, 1
    s_add_u32 s37, s25, 0
    buffer_load_dwordx4 v[96:99], v1, s[8:11], s37 offen offset:0
    buffer_load_dwordx4 v[100:103], v1, s[8:11], s37 offen offset:1024
    buffer_load_dwordx4 v[104:107], v15, s[8:11], s37 offen offset:0
    buffer_load_dwordx4 v[108:111], v15, s[8:11], s37 offen offset:1024
    s_add_u32 s37, s25, 2048
    buffer_load_dwordx4 v[112:115], v1, s[8:11], s37 offen offset:0
    buffer_load_dwordx4 v[116:119], v1, s[8:11], s37 offen offset:1024
    buffer_load_dwordx4 v[120:123], v15, s[8:11], s37 offen offset:0
    buffer_load_dwordx4 v[124:127], v15, s[8:11], s37 offen offset:1024
    s_add_u32 s37, s25, 4096
    buffer_load_dwordx4 v[128:131], v1, s[8:11], s37 offen offset:0
    buffer_load_dwordx4 v[132:135], v1, s[8:11], s37 offen offset:1024
    buffer_load_dwordx4 v[136:139], v15, s[8:11], s37 offen offset:0
    buffer_load_dwordx4 v[140:143], v15, s[8:11], s37 offen offset:1024
    s_waitcnt vmcnt(0)
    s_barrier
    v_add_u32 v4, 8192, v1
    v_add_u32 v5, 16384, v1
    v_add_u32 v6, 24576, v1
    v_add_u32 v7, 32768, v1
    v_add_u32 v9, 40960, v1
    v_add_u32 v11, 49152, v1
    v_add_u32 v12, 114688, v1
    v_add_u32 v13, 229376, v1
    v_add_u32 v14, 344064, v1
    v_mfma_f32_32x32x16_bf16 v[48:63], v[96:99], v[16:19], 0
    v_mfma_f32_32x32x16_bf16 v[48:63], v[100:103], v[20:23], v[48:63]
    s_nop 13
    s_branch L_att_loop
L_fused_kernel_done:
    s_endpgm
L_code_end:
.section .rodata,"a"
.p2align 6
.amdhsa_kernel qkv_kernel
  .amdhsa_next_free_vgpr 168
  .amdhsa_next_free_sgpr 96
  .amdhsa_accum_offset 168
  .amdhsa_group_segment_fixed_size 0
  .amdhsa_kernarg_size 72
  .amdhsa_user_sgpr_count 2
  .amdhsa_user_sgpr_kernarg_segment_ptr 1
  .amdhsa_system_sgpr_workgroup_id_x 1
.end_amdhsa_kernel
.p2align 6
.amdhsa_kernel fused_kernel
  .amdhsa_next_free_vgpr 512
  .amdhsa_next_free_sgpr 102
  .amdhsa_accum_offset 256
  .amdhsa_group_segment_fixed_size 0
  .amdhsa_kernarg_size 72
  .amdhsa_user_sgpr_count 2
  .amdhsa_user_sgpr_kernarg_segment_ptr 1
  .amdhsa_system_sgpr_workgroup_id_x 1
.end_amdhsa_kernel
```
